```python
import torch

def _softmax(x, axis=-1):
    return torch.softmax(x, dim=axis)

def _gelu(x):
    return torch.nn.functional.gelu(x, approximate='tanh')

def _silu(x):
    return torch.nn.functional.silu(x)

def _sigmoid(x):
    return torch.sigmoid(x)

def _layernorm(x, axis=-1, eps=1e-05):
    m = x.mean(dim=axis, keepdim=True)
    v = x.var(dim=axis, keepdim=True, unbiased=False)
    return (x - m) / torch.sqrt(v + eps)

def _scatter_add(tgt, idx, src, axis=0):
    return tgt.clone().index_add_(axis, idx, src)

def _segment_sum(src, seg, n):
    out = torch.zeros((n,) + src.shape[1:], dtype=src.dtype)
    return out.index_add_(0, seg, src)

def _pad(x, pw):
    flat = tuple((v for pair in reversed(pw) for v in pair))
    return torch.nn.functional.pad(x, flat)
kernel_name = 'gated_mix__softmax_full_mha__mixer_gmlp__prompt'

def setup_inputs():

    _w = lambda a: (lambda t: t.to(torch.bfloat16) if t.is_floating_point() else t)(torch.as_tensor(a))

    def _A_setup():
        B, S, D = (1, 2048, 576)
        return {'x': _w((lambda *s: torch.randn(*s, dtype=torch.bfloat16) * 0.05)(B, S, D)), 'wqkv': _w((lambda *s: torch.randn(*s, dtype=torch.bfloat16) * 1.6)(D, 3 * D)), 'wo': _w((lambda *s: torch.randn(*s, dtype=torch.bfloat16) * 0.1)(D, D))}
    _A_in = _A_setup()

    def _B_setup():
        B, S, D, F = (1, 2048, 576, 4608)
        Fh = F // 2
        return {'x': _w((lambda *s: torch.randn(*s, dtype=torch.bfloat16) * 0.05)(B, S, D)), 'w_in': _w((lambda *s: torch.randn(*s, dtype=torch.bfloat16) * 1.6)(D, 2 * Fh)), 'w_sp': _w(0.01 * (lambda *s: torch.randn(*s, dtype=torch.bfloat16) * 1.6)(S, S)), 'b_sp': _w(1.0 + 0.01 * (lambda *s: torch.randn(*s, dtype=torch.bfloat16) * 0.05)(S)), 'w_out': _w((lambda *s: torch.randn(*s, dtype=torch.bfloat16) * 0.05)(Fh, D))}
    _B_in = _B_setup()
    return {'A_x': _A_in['x'], 'A_wqkv': _A_in['wqkv'], 'A_wo': _A_in['wo'], 'B_x': _B_in['x'], 'B_w_in': _B_in['w_in'], 'B_w_sp': _B_in['w_sp'], 'B_b_sp': _B_in['b_sp'], 'B_w_out': _B_in['w_out'], 'gate_w': _w((lambda *s: torch.randn(*s, dtype=torch.bfloat16) * 0.05)(576) * 16.0)}

def reference(A_x, A_wqkv, A_wo, B_x, B_w_in, B_w_sp, B_b_sp, B_w_out, gate_w):

    def _A_ref(x, wqkv, wo):
        B, S, D = x.shape
        H = 32
        Dh = D // H
        qkv = (lambda x, *d: x.permute(*d))((x @ wqkv).reshape(B, S, 3, H, Dh), 2, 0, 3, 1, 4)
        q, k, v = (qkv[0], qkv[1], qkv[2])
        scale = Dh ** (-0.5)
        scores = torch.einsum('bhqd,bhkd->bhqk', q, k) * scale
        p = _softmax(scores, axis=-1)
        o = torch.einsum('bhqk,bhkd->bhqd', p, v)
        return (lambda x, *d: x.permute(*d))(o, 0, 2, 1, 3).reshape(B, S, D) @ wo

    def _B_ref(x, w_in, w_sp, b_sp, w_out):
        B, S, D = x.shape
        F = w_in.shape[-1]
        Fh = F // 2
        z = _gelu(torch.einsum('bsd,df->bsf', x, w_in))
        z1 = z[..., :Fh].clone()
        z2 = _layernorm(z[..., Fh:], axis=-1)
        g = torch.einsum('ts,bsf->btf', w_sp, z2) + b_sp[None, :, None]
        return torch.einsum('bsf,fd->bsd', z1 * g, w_out)
    x = A_x
    g = _sigmoid((x * gate_w).sum(-1, keepdims=True))
    a = _A_ref(x, A_wqkv, A_wo)
    b = _B_ref(x, B_w_in, B_w_sp, B_b_sp, B_w_out)
    return g * a + (1 - g) * b
```

```asm
; @launch kernel=k1_kernel grid=(256,1,1) block=(512,1,1) lds=153600
; @launch kernel=k2_kernel grid=(512,1,1) block=(256,1,1) lds=81920
.amdgcn_target "amdgcn-amd-amdhsa--gfx950"
.text
.globl k1_kernel
.p2align 8
.type k1_kernel,@function
k1_kernel:
    s_cmp_ge_u32 s2, 256
    s_cbranch_scc1 L_k1_end
    s_load_dwordx2 s[4:5], s[0:1], 0
    s_load_dwordx2 s[6:7], s[0:1], 8
    s_load_dwordx2 s[8:9], s[0:1], 88
    s_load_dwordx2 s[10:11], s[0:1], 32
    s_load_dwordx2 s[12:13], s[0:1], 40
    s_load_dwordx2 s[14:15], s[0:1], 64
    v_lshrrev_b32 v1, 6, v0
    v_and_b32 v2, 63, v0
    s_and_b32 s40, s2, 7
    s_lshr_b32 s41, s2, 3
    v_readfirstlane_b32 s36, v1
    s_and_b32 s42, s40, 1
    s_lshr_b32 s43, s40, 1
    s_and_b32 s44, s41, 3
    s_lshl_b32 s42, s42, 2
    s_add_u32 s37, s42, s44
    s_lshr_b32 s44, s41, 2
    s_mul_i32 s43, s43, 7
    s_add_u32 s38, s43, s44
    s_waitcnt lgkmcnt(0)
    s_mov_b32 s24, s8
    s_and_b32 s25, s9, 0xffff
    s_mov_b32 s26, 0x3d00000
    s_mov_b32 s27, 0x20000
    s_cmp_ge_u32 s41, 28
    s_cbranch_scc1 L_k1_spare
    s_cmp_lt_u32 s36, 4
    s_cbranch_scc1 L_k1_compute
L_k1_loader:
    s_mov_b32 s16, s4
    s_and_b32 s17, s5, 0xffff
    s_mov_b32 s18, 0x240000
    s_mov_b32 s19, 0x20000
    s_sub_u32 s39, s36, 4
    s_cmp_lt_u32 s38, 12
    s_cselect_b32 s6, s6, s10
    s_cselect_b32 s7, s7, s11
    s_mov_b32 s47, 5308416
    s_cselect_b32 s47, 1990656, s47
    s_mov_b32 s45, 9216
    s_cselect_b32 s45, 3456, s45
    s_mul_i32 s46, s38, 288
    s_cselect_b32 s48, 0, 1152
    s_add_u32 s46, s46, s48
    s_mov_b32 s20, s6
    s_and_b32 s21, s7, 0xffff
    s_mov_b32 s22, s47
    s_mov_b32 s23, 0x20000
    v_lshrrev_b32 v10, 3, v2
    v_and_b32 v11, 7, v2
    v_xor_b32 v11, v11, v10
    v_lshlrev_b32 v11, 4, v11
    s_lshl_b32 s48, s37, 8
    s_lshl_b32 s49, s39, 6
    s_add_u32 s48, s48, s49
    v_add_u32 v12, s48, v10
    v_mul_u32_u24 v12, 1152, v12
    v_add_u32 v3, v12, v11
    s_mov_b32 s50, 0
    s_mov_b32 s51, 0
    s_lshl_b32 s52, s45, 6
    s_mov_b32 s54, 0
    s_lshl_b32 s56, s39, 13
    s_lshl_b32 s57, s39, 10
    s_add_u32 s57, s57, 32768
    s_add_u32 s58, s54, s56
    s_add_u32 m0, s58, 0
    s_add_u32 s59, s50, 0
    buffer_load_dwordx4 v3, s[16:19], s59 offen lds
    s_add_u32 m0, s58, 1024
    s_add_u32 s59, s50, 9216
    buffer_load_dwordx4 v3, s[16:19], s59 offen lds
    s_add_u32 m0, s58, 2048
    s_add_u32 s59, s50, 18432
    buffer_load_dwordx4 v3, s[16:19], s59 offen lds
    s_add_u32 m0, s58, 3072
    s_add_u32 s59, s50, 27648
    buffer_load_dwordx4 v3, s[16:19], s59 offen lds
    s_add_u32 m0, s58, 4096
    s_add_u32 s59, s50, 36864
    buffer_load_dwordx4 v3, s[16:19], s59 offen lds
    s_add_u32 m0, s58, 5120
    s_add_u32 s59, s50, 46080
    buffer_load_dwordx4 v3, s[16:19], s59 offen lds
    s_add_u32 m0, s58, 6144
    s_add_u32 s59, s50, 55296
    buffer_load_dwordx4 v3, s[16:19], s59 offen lds
    s_add_u32 m0, s58, 7168
    s_add_u32 s59, s50, 64512
    buffer_load_dwordx4 v3, s[16:19], s59 offen lds
    s_add_u32 s48, s39, 0
    s_lshl_b32 s48, s48, 6
    v_add_u32 v10, s48, v2
    v_mul_u32_u24 v11, 3641, v10
    v_lshrrev_b32 v11, 16, v11
    v_mul_u32_u24 v12, 18, v11
    v_sub_u32 v12, v10, v12
    v_lshl_add_u32 v12, v12, 4, s46
    v_and_b32 v13, 32, v11
    v_bfe_u32 v14, v11, 2, 2
    v_lshl_add_u32 v13, v14, 3, v13
    v_bfe_u32 v14, v11, 4, 1
    v_lshl_add_u32 v13, v14, 2, v13
    v_and_b32 v14, 3, v11
    v_add_u32 v13, v13, v14
    v_mul_lo_u32 v13, v13, s45
    v_add_u32 v4, v13, v12
    s_add_u32 s48, s39, 4
    s_lshl_b32 s48, s48, 6
    v_add_u32 v10, s48, v2
    v_mul_u32_u24 v11, 3641, v10
    v_lshrrev_b32 v11, 16, v11
    v_mul_u32_u24 v12, 18, v11
    v_sub_u32 v12, v10, v12
    v_lshl_add_u32 v12, v12, 4, s46
    v_and_b32 v13, 32, v11
    v_bfe_u32 v14, v11, 2, 2
    v_lshl_add_u32 v13, v14, 3, v13
    v_bfe_u32 v14, v11, 4, 1
    v_lshl_add_u32 v13, v14, 2, v13
    v_and_b32 v14, 3, v11
    v_add_u32 v13, v13, v14
    v_mul_lo_u32 v13, v13, s45
    v_add_u32 v5, v13, v12
    s_add_u32 s48, s39, 8
    s_lshl_b32 s48, s48, 6
    v_add_u32 v10, s48, v2
    v_mul_u32_u24 v11, 3641, v10
    v_lshrrev_b32 v11, 16, v11
    v_mul_u32_u24 v12, 18, v11
    v_sub_u32 v12, v10, v12
    v_lshl_add_u32 v12, v12, 4, s46
    v_and_b32 v13, 32, v11
    v_bfe_u32 v14, v11, 2, 2
    v_lshl_add_u32 v13, v14, 3, v13
    v_bfe_u32 v14, v11, 4, 1
    v_lshl_add_u32 v13, v14, 2, v13
    v_and_b32 v14, 3, v11
    v_add_u32 v13, v13, v14
    v_mul_lo_u32 v13, v13, s45
    v_add_u32 v6, v13, v12
    s_add_u32 s48, s39, 12
    s_lshl_b32 s48, s48, 6
    v_add_u32 v10, s48, v2
    v_mul_u32_u24 v11, 3641, v10
    v_lshrrev_b32 v11, 16, v11
    v_mul_u32_u24 v12, 18, v11
    v_sub_u32 v12, v10, v12
    v_lshl_add_u32 v12, v12, 4, s46
    v_and_b32 v13, 32, v11
    v_bfe_u32 v14, v11, 2, 2
    v_lshl_add_u32 v13, v14, 3, v13
    v_bfe_u32 v14, v11, 4, 1
    v_lshl_add_u32 v13, v14, 2, v13
    v_and_b32 v14, 3, v11
    v_add_u32 v13, v13, v14
    v_mul_lo_u32 v13, v13, s45
    v_add_u32 v7, v13, v12
    s_add_u32 s48, s39, 16
    s_lshl_b32 s48, s48, 6
    v_add_u32 v10, s48, v2
    v_mul_u32_u24 v11, 3641, v10
    v_lshrrev_b32 v11, 16, v11
    v_mul_u32_u24 v12, 18, v11
    v_sub_u32 v12, v10, v12
    v_lshl_add_u32 v12, v12, 4, s46
    v_and_b32 v13, 32, v11
    v_bfe_u32 v14, v11, 2, 2
    v_lshl_add_u32 v13, v14, 3, v13
    v_bfe_u32 v14, v11, 4, 1
    v_lshl_add_u32 v13, v14, 2, v13
    v_and_b32 v14, 3, v11
    v_add_u32 v13, v13, v14
    v_mul_lo_u32 v13, v13, s45
    v_add_u32 v8, v13, v12
    s_add_u32 s58, s54, s57
    s_add_u32 m0, s58, 0
    s_nop 0
    buffer_load_dwordx4 v4, s[20:23], s51 offen lds
    s_add_u32 m0, s58, 4096
    s_nop 0
    buffer_load_dwordx4 v5, s[20:23], s51 offen lds
    s_add_u32 m0, s58, 8192
    s_nop 0
    buffer_load_dwordx4 v6, s[20:23], s51 offen lds
    s_add_u32 m0, s58, 12288
    s_nop 0
    buffer_load_dwordx4 v7, s[20:23], s51 offen lds
    s_cmp_ge_u32 s39, 2
    s_cbranch_scc1 L_k1_skipw_22
    s_add_u32 m0, s58, 16384
    s_nop 0
    buffer_load_dwordx4 v8, s[20:23], s51 offen lds
L_k1_skipw_22:
    s_add_u32 s50, s50, 128
    s_add_u32 s51, s51, s52
    s_add_u32 s54, s54, 51200
    s_cmp_ge_u32 s54, 153600
    s_cselect_b32 s54, 0, s54
    s_mov_b32 s53, 1
.p2align 6
L_k1_ldloop:
    s_cmp_lt_u32 s53, 2
    s_cbranch_scc1 L_k1_nobar_23
    s_cmp_eq_u32 s53, 10
    s_cbranch_scc1 L_k1_w0_24
    s_waitcnt vmcnt(12)
    s_branch L_k1_go_26
L_k1_w0_24:
    s_waitcnt vmcnt(0)
L_k1_go_26:
    s_barrier
L_k1_nobar_23:
    s_cmp_ge_u32 s53, 9
    s_cbranch_scc1 L_k1_noiss_27
    s_add_u32 s58, s54, s56
    s_add_u32 m0, s58, 0
    s_add_u32 s59, s50, 0
    buffer_load_dwordx4 v3, s[16:19], s59 offen lds
    s_add_u32 m0, s58, 1024
    s_add_u32 s59, s50, 9216
    buffer_load_dwordx4 v3, s[16:19], s59 offen lds
    s_add_u32 m0, s58, 2048
    s_add_u32 s59, s50, 18432
    buffer_load_dwordx4 v3, s[16:19], s59 offen lds
    s_add_u32 m0, s58, 3072
    s_add_u32 s59, s50, 27648
    buffer_load_dwordx4 v3, s[16:19], s59 offen lds
    s_add_u32 m0, s58, 4096
    s_add_u32 s59, s50, 36864
    buffer_load_dwordx4 v3, s[16:19], s59 offen lds
    s_add_u32 m0, s58, 5120
    s_add_u32 s59, s50, 46080
    buffer_load_dwordx4 v3, s[16:19], s59 offen lds
    s_add_u32 m0, s58, 6144
    s_add_u32 s59, s50, 55296
    buffer_load_dwordx4 v3, s[16:19], s59 offen lds
    s_add_u32 m0, s58, 7168
    s_add_u32 s59, s50, 64512
    buffer_load_dwordx4 v3, s[16:19], s59 offen lds
    s_add_u32 s58, s54, s57
    s_add_u32 m0, s58, 0
    s_nop 0
    buffer_load_dwordx4 v4, s[20:23], s51 offen lds
    s_add_u32 m0, s58, 4096
    s_nop 0
    buffer_load_dwordx4 v5, s[20:23], s51 offen lds
    s_add_u32 m0, s58, 8192
    s_nop 0
    buffer_load_dwordx4 v6, s[20:23], s51 offen lds
    s_add_u32 m0, s58, 12288
    s_nop 0
    buffer_load_dwordx4 v7, s[20:23], s51 offen lds
    s_cmp_ge_u32 s39, 2
    s_cbranch_scc1 L_k1_skipw_28
    s_add_u32 m0, s58, 16384
    s_nop 0
    buffer_load_dwordx4 v8, s[20:23], s51 offen lds
L_k1_skipw_28:
    s_add_u32 s50, s50, 128
    s_add_u32 s51, s51, s52
    s_add_u32 s54, s54, 51200
    s_cmp_ge_u32 s54, 153600
    s_cselect_b32 s54, 0, s54
L_k1_noiss_27:
    s_add_u32 s53, s53, 1
    s_cmp_lt_u32 s53, 11
    s_cbranch_scc1 L_k1_ldloop
    s_branch L_k1_fin
L_k1_compute:
    s_cmp_lt_u32 s38, 8
    s_cselect_b32 s58, 72, 8
    v_and_b32 v12, 15, v2
    v_lshrrev_b32 v13, 4, v2
    v_and_b32 v14, 7, v12
    v_xor_b32 v14, v14, v13
    v_lshlrev_b32 v14, 4, v14
    s_lshl_b32 s48, s36, 13
    v_lshl_add_u32 v15, v12, 7, v14
    v_add_u32 v3, s48, v15
    v_xor_b32 v4, 64, v3
    v_add_u32 v5, 51200, v3
    v_add_u32 v6, 51200, v4
    v_add_u32 v7, 102400, v3
    v_add_u32 v8, 102400, v4
    v_bfe_u32 v14, v2, 2, 2
    v_lshl_add_u32 v14, v13, 2, v14
    v_mul_u32_u24 v14, 288, v14
    v_and_b32 v15, 3, v2
    v_mul_u32_u24 v15, s58, v15
    v_add_u32 v14, v14, v15
    v_add_u32 v9, 32768, v14
    v_add_u32 v10, 83968, v14
    v_add_u32 v11, 135168, v14
    s_cmp_lt_u32 s38, 18
    s_cselect_b32 s66, s38, 200
    s_and_b32 s67, s66, 1
    s_lshr_b32 s66, s66, 1
    s_lshl_b32 s58, s37, 4
    s_lshl_b32 s59, s36, 2
    s_add_u32 s58, s58, s59
    s_mul_i32 s58, s58, 18432
    s_lshl_b32 s59, s38, 10
    s_add_u32 s58, s58, s59
    s_add_u32 s68, s58, 18874368
    v_lshlrev_b32 v12, 4, v2
    v_mov_b64 v[48:49], 0
    v_mov_b64 v[50:51], 0
    v_mov_b64 v[52:53], 0
    v_mov_b64 v[54:55], 0
    v_mov_b64 v[56:57], 0
    v_mov_b64 v[58:59], 0
    v_mov_b64 v[60:61], 0
    v_mov_b64 v[62:63], 0
    v_mov_b64 v[64:65], 0
    v_mov_b64 v[66:67], 0
    v_mov_b64 v[68:69], 0
    v_mov_b64 v[70:71], 0
    v_mov_b64 v[72:73], 0
    v_mov_b64 v[74:75], 0
    v_mov_b64 v[76:77], 0
    v_mov_b64 v[78:79], 0
    v_mov_b64 v[80:81], 0
    v_mov_b64 v[82:83], 0
    v_mov_b64 v[84:85], 0
    v_mov_b64 v[86:87], 0
    v_mov_b64 v[88:89], 0
    v_mov_b64 v[90:91], 0
    v_mov_b64 v[92:93], 0
    v_mov_b64 v[94:95], 0
    v_mov_b64 v[96:97], 0
    v_mov_b64 v[98:99], 0
    v_mov_b64 v[100:101], 0
    v_mov_b64 v[102:103], 0
    v_mov_b64 v[104:105], 0
    v_mov_b64 v[106:107], 0
    v_mov_b64 v[108:109], 0
    v_mov_b64 v[110:111], 0
    v_mov_b64 v[112:113], 0
    v_mov_b64 v[114:115], 0
    v_mov_b64 v[116:117], 0
    v_mov_b64 v[118:119], 0
    v_mov_b64 v[120:121], 0
    v_mov_b64 v[122:123], 0
    v_mov_b64 v[124:125], 0
    v_mov_b64 v[126:127], 0
    v_mov_b64 v[128:129], 0
    v_mov_b64 v[130:131], 0
    v_mov_b64 v[132:133], 0
    v_mov_b64 v[134:135], 0
    v_mov_b64 v[136:137], 0
    v_mov_b64 v[138:139], 0
    v_mov_b64 v[140:141], 0
    v_mov_b64 v[142:143], 0
    v_mov_b64 v[144:145], 0
    v_mov_b64 v[146:147], 0
    v_mov_b64 v[148:149], 0
    v_mov_b64 v[150:151], 0
    v_mov_b64 v[152:153], 0
    v_mov_b64 v[154:155], 0
    v_mov_b64 v[156:157], 0
    v_mov_b64 v[158:159], 0
    v_mov_b64 v[160:161], 0
    v_mov_b64 v[162:163], 0
    v_mov_b64 v[164:165], 0
    v_mov_b64 v[166:167], 0
    v_mov_b64 v[168:169], 0
    v_mov_b64 v[170:171], 0
    v_mov_b64 v[172:173], 0
    v_mov_b64 v[174:175], 0
    v_mov_b64 v[176:177], 0
    v_mov_b64 v[178:179], 0
    v_mov_b64 v[180:181], 0
    v_mov_b64 v[182:183], 0
    v_mov_b64 v[184:185], 0
    v_mov_b64 v[186:187], 0
    v_mov_b64 v[188:189], 0
    v_mov_b64 v[190:191], 0
    s_mov_b32 s28, s12
    s_and_b32 s29, s13, 0xffff
    s_mov_b32 s30, 0x800000
    s_mov_b32 s31, 0x20000
    s_mov_b32 s32, s10
    s_and_b32 s33, s11, 0xffff
    s_mov_b32 s34, 0x510000
    s_mov_b32 s35, 0x20000
    s_mul_i32 s42, s40, 28
    s_add_u32 s42, s42, s41
    s_lshl_b32 s42, s42, 2
    s_add_u32 s42, s42, s36
    s_cmp_ge_u32 s38, 12
    s_cbranch_scc1 L_k1_Z
    s_cmp_ge_u32 s38, 8
    s_cbranch_scc1 L_k1_V
    s_mov_b32 s53, 0
    s_barrier
    ds_read_b128 v[16:19], v3 offset:0
    ds_read_b128 v[20:23], v3 offset:2048
    ds_read_b128 v[24:27], v3 offset:4096
    ds_read_b128 v[28:31], v3 offset:6144
    ds_read_b64_tr_b16 v[208:209], v9 offset:0
    ds_read_b64_tr_b16 v[210:211], v9 offset:4608
    ds_read_b64_tr_b16 v[212:213], v9 offset:8
    ds_read_b64_tr_b16 v[214:215], v9 offset:4616
    ds_read_b64_tr_b16 v[216:217], v9 offset:16
    ds_read_b64_tr_b16 v[218:219], v9 offset:4624
    ds_read_b64_tr_b16 v[220:221], v9 offset:24
    ds_read_b64_tr_b16 v[222:223], v9 offset:4632
    s_waitcnt lgkmcnt(8)
    s_waitcnt lgkmcnt(6)
.p2align 6
L_k1_loop_qk:
    v_mfma_f32_16x16x32_bf16 v[48:51], v[208:211], v[16:19], v[48:51]
    ds_read_b64_tr_b16 v[224:225], v9 offset:32
    v_mfma_f32_16x16x32_bf16 v[52:55], v[208:211], v[20:23], v[52:55]
    ds_read_b64_tr_b16 v[226:227], v9 offset:4640
    v_mfma_f32_16x16x32_bf16 v[56:59], v[208:211], v[24:27], v[56:59]
    v_mfma_f32_16x16x32_bf16 v[60:63], v[208:211], v[28:31], v[60:63]
    s_waitcnt lgkmcnt(6)
    v_mfma_f32_16x16x32_bf16 v[64:67], v[212:215], v[16:19], v[64:67]
    ds_read_b64_tr_b16 v[228:229], v9 offset:40
    v_mfma_f32_16x16x32_bf16 v[68:71], v[212:215], v[20:23], v[68:71]
    ds_read_b64_tr_b16 v[230:231], v9 offset:4648
    v_mfma_f32_16x16x32_bf16 v[72:75], v[212:215], v[24:27], v[72:75]
    v_mfma_f32_16x16x32_bf16 v[76:79], v[212:215], v[28:31], v[76:79]
    s_waitcnt lgkmcnt(6)
    v_mfma_f32_16x16x32_bf16 v[80:83], v[216:219], v[16:19], v[80:83]
    ds_read_b64_tr_b16 v[232:233], v9 offset:48
    v_mfma_f32_16x16x32_bf16 v[84:87], v[216:219], v[20:23], v[84:87]
    ds_read_b64_tr_b16 v[234:235], v9 offset:4656
    v_mfma_f32_16x16x32_bf16 v[88:91], v[216:219], v[24:27], v[88:91]
    ds_read_b128 v[32:35], v4 offset:0
    v_mfma_f32_16x16x32_bf16 v[92:95], v[216:219], v[28:31], v[92:95]
    s_waitcnt lgkmcnt(7)
    v_mfma_f32_16x16x32_bf16 v[96:99], v[220:223], v[16:19], v[96:99]
    ds_read_b64_tr_b16 v[236:237], v9 offset:56
    v_mfma_f32_16x16x32_bf16 v[100:103], v[220:223], v[20:23], v[100:103]
    ds_read_b64_tr_b16 v[238:239], v9 offset:4664
    v_mfma_f32_16x16x32_bf16 v[104:107], v[220:223], v[24:27], v[104:107]
    ds_read_b128 v[36:39], v4 offset:2048
    v_mfma_f32_16x16x32_bf16 v[108:111], v[220:223], v[28:31], v[108:111]
    s_waitcnt lgkmcnt(8)
    v_mfma_f32_16x16x32_bf16 v[112:115], v[224:227], v[16:19], v[112:115]
    ds_read_b64_tr_b16 v[240:241], v9 offset:64
    v_mfma_f32_16x16x32_bf16 v[116:119], v[224:227], v[20:23], v[116:119]
    ds_read_b64_tr_b16 v[242:243], v9 offset:4672
    v_mfma_f32_16x16x32_bf16 v[120:123], v[224:227], v[24:27], v[120:123]
    ds_read_b128 v[40:43], v4 offset:4096
    v_mfma_f32_16x16x32_bf16 v[124:127], v[224:227], v[28:31], v[124:127]
    s_waitcnt lgkmcnt(9)
    v_mfma_f32_16x16x32_bf16 v[128:131], v[228:231], v[16:19], v[128:131]
    ds_read_b64_tr_b16 v[208:209], v9 offset:9216
    v_mfma_f32_16x16x32_bf16 v[132:135], v[228:231], v[20:23], v[132:135]
    ds_read_b64_tr_b16 v[210:211], v9 offset:13824
    v_mfma_f32_16x16x32_bf16 v[136:139], v[228:231], v[24:27], v[136:139]
    ds_read_b128 v[44:47], v4 offset:6144
    v_mfma_f32_16x16x32_bf16 v[140:143], v[228:231], v[28:31], v[140:143]
    s_waitcnt lgkmcnt(10)
    v_mfma_f32_16x16x32_bf16 v[144:147], v[232:235], v[16:19], v[144:147]
    ds_read_b64_tr_b16 v[212:213], v9 offset:9224
    v_mfma_f32_16x16x32_bf16 v[148:151], v[232:235], v[20:23], v[148:151]
    ds_read_b64_tr_b16 v[214:215], v9 offset:13832
    v_mfma_f32_16x16x32_bf16 v[152:155], v[232:235], v[24:27], v[152:155]
    v_mfma_f32_16x16x32_bf16 v[156:159], v[232:235], v[28:31], v[156:159]
    s_waitcnt lgkmcnt(9)
    v_mfma_f32_16x16x32_bf16 v[160:163], v[236:239], v[16:19], v[160:163]
    ds_read_b64_tr_b16 v[216:217], v9 offset:9232
    v_mfma_f32_16x16x32_bf16 v[164:167], v[236:239], v[20:23], v[164:167]
    ds_read_b64_tr_b16 v[218:219], v9 offset:13840
    v_mfma_f32_16x16x32_bf16 v[168:171], v[236:239], v[24:27], v[168:171]
    v_mfma_f32_16x16x32_bf16 v[172:175], v[236:239], v[28:31], v[172:175]
    s_waitcnt lgkmcnt(8)
    v_mfma_f32_16x16x32_bf16 v[176:179], v[240:243], v[16:19], v[176:179]
    ds_read_b64_tr_b16 v[220:221], v9 offset:9240
    v_mfma_f32_16x16x32_bf16 v[180:183], v[240:243], v[20:23], v[180:183]
    ds_read_b64_tr_b16 v[222:223], v9 offset:13848
    v_mfma_f32_16x16x32_bf16 v[184:187], v[240:243], v[24:27], v[184:187]
    v_mfma_f32_16x16x32_bf16 v[188:191], v[240:243], v[28:31], v[188:191]
    s_waitcnt lgkmcnt(6)
    s_mul_i32 s58, s53, 3
    s_add_u32 s58, s58, 0
    s_cmp_lg_u32 s58, s66
    s_cbranch_scc1 L_k1_xf_1
    s_cmp_eq_u32 s67, 1
    s_cbranch_scc1 L_k1_xf1_2
    s_add_u32 s58, s68, 0
    buffer_store_dwordx4 v[16:19], v12, s[24:27], s58 offen sc1
    s_add_u32 s58, s68, 18432
    buffer_store_dwordx4 v[20:23], v12, s[24:27], s58 offen sc1
    s_add_u32 s58, s68, 36864
    buffer_store_dwordx4 v[24:27], v12, s[24:27], s58 offen sc1
    s_add_u32 s58, s68, 55296
    buffer_store_dwordx4 v[28:31], v12, s[24:27], s58 offen sc1
    s_branch L_k1_xf_1
L_k1_xf1_2:
    s_add_u32 s58, s68, 0
    buffer_store_dwordx4 v[32:35], v12, s[24:27], s58 offen sc1
    s_add_u32 s58, s68, 18432
    buffer_store_dwordx4 v[36:39], v12, s[24:27], s58 offen sc1
    s_add_u32 s58, s68, 36864
    buffer_store_dwordx4 v[40:43], v12, s[24:27], s58 offen sc1
    s_add_u32 s58, s68, 55296
    buffer_store_dwordx4 v[44:47], v12, s[24:27], s58 offen sc1
L_k1_xf_1:
    v_mfma_f32_16x16x32_bf16 v[48:51], v[208:211], v[32:35], v[48:51]
    ds_read_b64_tr_b16 v[224:225], v9 offset:9248
    v_mfma_f32_16x16x32_bf16 v[52:55], v[208:211], v[36:39], v[52:55]
    ds_read_b64_tr_b16 v[226:227], v9 offset:13856
    v_mfma_f32_16x16x32_bf16 v[56:59], v[208:211], v[40:43], v[56:59]
    v_mfma_f32_16x16x32_bf16 v[60:63], v[208:211], v[44:47], v[60:63]
    s_waitcnt lgkmcnt(6)
    v_mfma_f32_16x16x32_bf16 v[64:67], v[212:215], v[32:35], v[64:67]
    ds_read_b64_tr_b16 v[228:229], v9 offset:9256
    v_mfma_f32_16x16x32_bf16 v[68:71], v[212:215], v[36:39], v[68:71]
    ds_read_b64_tr_b16 v[230:231], v9 offset:13864
    v_mfma_f32_16x16x32_bf16 v[72:75], v[212:215], v[40:43], v[72:75]
    v_mfma_f32_16x16x32_bf16 v[76:79], v[212:215], v[44:47], v[76:79]
    s_waitcnt lgkmcnt(6)
    v_mfma_f32_16x16x32_bf16 v[80:83], v[216:219], v[32:35], v[80:83]
    ds_read_b64_tr_b16 v[232:233], v9 offset:9264
    v_mfma_f32_16x16x32_bf16 v[84:87], v[216:219], v[36:39], v[84:87]
    ds_read_b64_tr_b16 v[234:235], v9 offset:13872
    v_mfma_f32_16x16x32_bf16 v[88:91], v[216:219], v[40:43], v[88:91]
    v_mfma_f32_16x16x32_bf16 v[92:95], v[216:219], v[44:47], v[92:95]
    s_waitcnt lgkmcnt(6)
    v_mfma_f32_16x16x32_bf16 v[96:99], v[220:223], v[32:35], v[96:99]
    ds_read_b64_tr_b16 v[236:237], v9 offset:9272
    v_mfma_f32_16x16x32_bf16 v[100:103], v[220:223], v[36:39], v[100:103]
    ds_read_b64_tr_b16 v[238:239], v9 offset:13880
    v_mfma_f32_16x16x32_bf16 v[104:107], v[220:223], v[40:43], v[104:107]
    v_mfma_f32_16x16x32_bf16 v[108:111], v[220:223], v[44:47], v[108:111]
    s_waitcnt lgkmcnt(6)
    v_mfma_f32_16x16x32_bf16 v[112:115], v[224:227], v[32:35], v[112:115]
    ds_read_b64_tr_b16 v[240:241], v9 offset:9280
    v_mfma_f32_16x16x32_bf16 v[116:119], v[224:227], v[36:39], v[116:119]
    ds_read_b64_tr_b16 v[242:243], v9 offset:13888
    v_mfma_f32_16x16x32_bf16 v[120:123], v[224:227], v[40:43], v[120:123]
    v_mfma_f32_16x16x32_bf16 v[124:127], v[224:227], v[44:47], v[124:127]
    s_waitcnt lgkmcnt(0)
    s_barrier
    ds_read_b128 v[16:19], v5 offset:0
    ds_read_b128 v[20:23], v5 offset:2048
    ds_read_b128 v[24:27], v5 offset:4096
    ds_read_b128 v[28:31], v5 offset:6144
    ds_read_b64_tr_b16 v[208:209], v10 offset:0
    ds_read_b64_tr_b16 v[210:211], v10 offset:4608
    ds_read_b64_tr_b16 v[212:213], v10 offset:8
    ds_read_b64_tr_b16 v[214:215], v10 offset:4616
    ds_read_b64_tr_b16 v[216:217], v10 offset:16
    ds_read_b64_tr_b16 v[218:219], v10 offset:4624
    ds_read_b64_tr_b16 v[220:221], v10 offset:24
    ds_read_b64_tr_b16 v[222:223], v10 offset:4632
    v_mfma_f32_16x16x32_bf16 v[128:131], v[228:231], v[32:35], v[128:131]
    v_mfma_f32_16x16x32_bf16 v[132:135], v[228:231], v[36:39], v[132:135]
    v_mfma_f32_16x16x32_bf16 v[136:139], v[228:231], v[40:43], v[136:139]
    v_mfma_f32_16x16x32_bf16 v[140:143], v[228:231], v[44:47], v[140:143]
    v_mfma_f32_16x16x32_bf16 v[144:147], v[232:235], v[32:35], v[144:147]
    v_mfma_f32_16x16x32_bf16 v[148:151], v[232:235], v[36:39], v[148:151]
    v_mfma_f32_16x16x32_bf16 v[152:155], v[232:235], v[40:43], v[152:155]
    v_mfma_f32_16x16x32_bf16 v[156:159], v[232:235], v[44:47], v[156:159]
    v_mfma_f32_16x16x32_bf16 v[160:163], v[236:239], v[32:35], v[160:163]
    v_mfma_f32_16x16x32_bf16 v[164:167], v[236:239], v[36:39], v[164:167]
    v_mfma_f32_16x16x32_bf16 v[168:171], v[236:239], v[40:43], v[168:171]
    v_mfma_f32_16x16x32_bf16 v[172:175], v[236:239], v[44:47], v[172:175]
    v_mfma_f32_16x16x32_bf16 v[176:179], v[240:243], v[32:35], v[176:179]
    v_mfma_f32_16x16x32_bf16 v[180:183], v[240:243], v[36:39], v[180:183]
    v_mfma_f32_16x16x32_bf16 v[184:187], v[240:243], v[40:43], v[184:187]
    v_mfma_f32_16x16x32_bf16 v[188:191], v[240:243], v[44:47], v[188:191]
    s_waitcnt lgkmcnt(8)
    s_waitcnt lgkmcnt(6)
    v_mfma_f32_16x16x32_bf16 v[48:51], v[208:211], v[16:19], v[48:51]
    ds_read_b64_tr_b16 v[224:225], v10 offset:32
    v_mfma_f32_16x16x32_bf16 v[52:55], v[208:211], v[20:23], v[52:55]
    ds_read_b64_tr_b16 v[226:227], v10 offset:4640
    v_mfma_f32_16x16x32_bf16 v[56:59], v[208:211], v[24:27], v[56:59]
    v_mfma_f32_16x16x32_bf16 v[60:63], v[208:211], v[28:31], v[60:63]
    s_waitcnt lgkmcnt(6)
    v_mfma_f32_16x16x32_bf16 v[64:67], v[212:215], v[16:19], v[64:67]
    ds_read_b64_tr_b16 v[228:229], v10 offset:40
    v_mfma_f32_16x16x32_bf16 v[68:71], v[212:215], v[20:23], v[68:71]
    ds_read_b64_tr_b16 v[230:231], v10 offset:4648
    v_mfma_f32_16x16x32_bf16 v[72:75], v[212:215], v[24:27], v[72:75]
    v_mfma_f32_16x16x32_bf16 v[76:79], v[212:215], v[28:31], v[76:79]
    s_waitcnt lgkmcnt(6)
    v_mfma_f32_16x16x32_bf16 v[80:83], v[216:219], v[16:19], v[80:83]
    ds_read_b64_tr_b16 v[232:233], v10 offset:48
    v_mfma_f32_16x16x32_bf16 v[84:87], v[216:219], v[20:23], v[84:87]
    ds_read_b64_tr_b16 v[234:235], v10 offset:4656
    v_mfma_f32_16x16x32_bf16 v[88:91], v[216:219], v[24:27], v[88:91]
    ds_read_b128 v[32:35], v6 offset:0
    v_mfma_f32_16x16x32_bf16 v[92:95], v[216:219], v[28:31], v[92:95]
    s_waitcnt lgkmcnt(7)
    v_mfma_f32_16x16x32_bf16 v[96:99], v[220:223], v[16:19], v[96:99]
    ds_read_b64_tr_b16 v[236:237], v10 offset:56
    v_mfma_f32_16x16x32_bf16 v[100:103], v[220:223], v[20:23], v[100:103]
    ds_read_b64_tr_b16 v[238:239], v10 offset:4664
    v_mfma_f32_16x16x32_bf16 v[104:107], v[220:223], v[24:27], v[104:107]
    ds_read_b128 v[36:39], v6 offset:2048
    v_mfma_f32_16x16x32_bf16 v[108:111], v[220:223], v[28:31], v[108:111]
    s_waitcnt lgkmcnt(8)
    v_mfma_f32_16x16x32_bf16 v[112:115], v[224:227], v[16:19], v[112:115]
    ds_read_b64_tr_b16 v[240:241], v10 offset:64
    v_mfma_f32_16x16x32_bf16 v[116:119], v[224:227], v[20:23], v[116:119]
    ds_read_b64_tr_b16 v[242:243], v10 offset:4672
    v_mfma_f32_16x16x32_bf16 v[120:123], v[224:227], v[24:27], v[120:123]
    ds_read_b128 v[40:43], v6 offset:4096
    v_mfma_f32_16x16x32_bf16 v[124:127], v[224:227], v[28:31], v[124:127]
    s_waitcnt lgkmcnt(9)
    v_mfma_f32_16x16x32_bf16 v[128:131], v[228:231], v[16:19], v[128:131]
    ds_read_b64_tr_b16 v[208:209], v10 offset:9216
    v_mfma_f32_16x16x32_bf16 v[132:135], v[228:231], v[20:23], v[132:135]
    ds_read_b64_tr_b16 v[210:211], v10 offset:13824
    v_mfma_f32_16x16x32_bf16 v[136:139], v[228:231], v[24:27], v[136:139]
    ds_read_b128 v[44:47], v6 offset:6144
    v_mfma_f32_16x16x32_bf16 v[140:143], v[228:231], v[28:31], v[140:143]
    s_waitcnt lgkmcnt(10)
    v_mfma_f32_16x16x32_bf16 v[144:147], v[232:235], v[16:19], v[144:147]
    ds_read_b64_tr_b16 v[212:213], v10 offset:9224
    v_mfma_f32_16x16x32_bf16 v[148:151], v[232:235], v[20:23], v[148:151]
    ds_read_b64_tr_b16 v[214:215], v10 offset:13832
    v_mfma_f32_16x16x32_bf16 v[152:155], v[232:235], v[24:27], v[152:155]
    v_mfma_f32_16x16x32_bf16 v[156:159], v[232:235], v[28:31], v[156:159]
    s_waitcnt lgkmcnt(9)
    v_mfma_f32_16x16x32_bf16 v[160:163], v[236:239], v[16:19], v[160:163]
    ds_read_b64_tr_b16 v[216:217], v10 offset:9232
    v_mfma_f32_16x16x32_bf16 v[164:167], v[236:239], v[20:23], v[164:167]
    ds_read_b64_tr_b16 v[218:219], v10 offset:13840
    v_mfma_f32_16x16x32_bf16 v[168:171], v[236:239], v[24:27], v[168:171]
    v_mfma_f32_16x16x32_bf16 v[172:175], v[236:239], v[28:31], v[172:175]
    s_waitcnt lgkmcnt(8)
    v_mfma_f32_16x16x32_bf16 v[176:179], v[240:243], v[16:19], v[176:179]
    ds_read_b64_tr_b16 v[220:221], v10 offset:9240
    v_mfma_f32_16x16x32_bf16 v[180:183], v[240:243], v[20:23], v[180:183]
    ds_read_b64_tr_b16 v[222:223], v10 offset:13848
    v_mfma_f32_16x16x32_bf16 v[184:187], v[240:243], v[24:27], v[184:187]
    v_mfma_f32_16x16x32_bf16 v[188:191], v[240:243], v[28:31], v[188:191]
    s_waitcnt lgkmcnt(6)
    s_mul_i32 s58, s53, 3
    s_add_u32 s58, s58, 1
    s_cmp_lg_u32 s58, s66
    s_cbranch_scc1 L_k1_xf_3
    s_cmp_eq_u32 s67, 1
    s_cbranch_scc1 L_k1_xf1_4
    s_add_u32 s58, s68, 0
    buffer_store_dwordx4 v[16:19], v12, s[24:27], s58 offen sc1
    s_add_u32 s58, s68, 18432
    buffer_store_dwordx4 v[20:23], v12, s[24:27], s58 offen sc1
    s_add_u32 s58, s68, 36864
    buffer_store_dwordx4 v[24:27], v12, s[24:27], s58 offen sc1
    s_add_u32 s58, s68, 55296
    buffer_store_dwordx4 v[28:31], v12, s[24:27], s58 offen sc1
    s_branch L_k1_xf_3
L_k1_xf1_4:
    s_add_u32 s58, s68, 0
    buffer_store_dwordx4 v[32:35], v12, s[24:27], s58 offen sc1
    s_add_u32 s58, s68, 18432
    buffer_store_dwordx4 v[36:39], v12, s[24:27], s58 offen sc1
    s_add_u32 s58, s68, 36864
    buffer_store_dwordx4 v[40:43], v12, s[24:27], s58 offen sc1
    s_add_u32 s58, s68, 55296
    buffer_store_dwordx4 v[44:47], v12, s[24:27], s58 offen sc1
L_k1_xf_3:
    v_mfma_f32_16x16x32_bf16 v[48:51], v[208:211], v[32:35], v[48:51]
    ds_read_b64_tr_b16 v[224:225], v10 offset:9248
    v_mfma_f32_16x16x32_bf16 v[52:55], v[208:211], v[36:39], v[52:55]
    ds_read_b64_tr_b16 v[226:227], v10 offset:13856
    v_mfma_f32_16x16x32_bf16 v[56:59], v[208:211], v[40:43], v[56:59]
    v_mfma_f32_16x16x32_bf16 v[60:63], v[208:211], v[44:47], v[60:63]
    s_waitcnt lgkmcnt(6)
    v_mfma_f32_16x16x32_bf16 v[64:67], v[212:215], v[32:35], v[64:67]
    ds_read_b64_tr_b16 v[228:229], v10 offset:9256
    v_mfma_f32_16x16x32_bf16 v[68:71], v[212:215], v[36:39], v[68:71]
    ds_read_b64_tr_b16 v[230:231], v10 offset:13864
    v_mfma_f32_16x16x32_bf16 v[72:75], v[212:215], v[40:43], v[72:75]
    v_mfma_f32_16x16x32_bf16 v[76:79], v[212:215], v[44:47], v[76:79]
    s_waitcnt lgkmcnt(6)
    v_mfma_f32_16x16x32_bf16 v[80:83], v[216:219], v[32:35], v[80:83]
    ds_read_b64_tr_b16 v[232:233], v10 offset:9264
    v_mfma_f32_16x16x32_bf16 v[84:87], v[216:219], v[36:39], v[84:87]
    ds_read_b64_tr_b16 v[234:235], v10 offset:13872
    v_mfma_f32_16x16x32_bf16 v[88:91], v[216:219], v[40:43], v[88:91]
    v_mfma_f32_16x16x32_bf16 v[92:95], v[216:219], v[44:47], v[92:95]
    s_waitcnt lgkmcnt(6)
    v_mfma_f32_16x16x32_bf16 v[96:99], v[220:223], v[32:35], v[96:99]
    ds_read_b64_tr_b16 v[236:237], v10 offset:9272
    v_mfma_f32_16x16x32_bf16 v[100:103], v[220:223], v[36:39], v[100:103]
    ds_read_b64_tr_b16 v[238:239], v10 offset:13880
    v_mfma_f32_16x16x32_bf16 v[104:107], v[220:223], v[40:43], v[104:107]
    v_mfma_f32_16x16x32_bf16 v[108:111], v[220:223], v[44:47], v[108:111]
    s_waitcnt lgkmcnt(6)
    v_mfma_f32_16x16x32_bf16 v[112:115], v[224:227], v[32:35], v[112:115]
    ds_read_b64_tr_b16 v[240:241], v10 offset:9280
    v_mfma_f32_16x16x32_bf16 v[116:119], v[224:227], v[36:39], v[116:119]
    ds_read_b64_tr_b16 v[242:243], v10 offset:13888
    v_mfma_f32_16x16x32_bf16 v[120:123], v[224:227], v[40:43], v[120:123]
    v_mfma_f32_16x16x32_bf16 v[124:127], v[224:227], v[44:47], v[124:127]
    s_waitcnt lgkmcnt(0)
    s_barrier
    ds_read_b128 v[16:19], v7 offset:0
    ds_read_b128 v[20:23], v7 offset:2048
    ds_read_b128 v[24:27], v7 offset:4096
    ds_read_b128 v[28:31], v7 offset:6144
    ds_read_b64_tr_b16 v[208:209], v11 offset:0
    ds_read_b64_tr_b16 v[210:211], v11 offset:4608
    ds_read_b64_tr_b16 v[212:213], v11 offset:8
    ds_read_b64_tr_b16 v[214:215], v11 offset:4616
    ds_read_b64_tr_b16 v[216:217], v11 offset:16
    ds_read_b64_tr_b16 v[218:219], v11 offset:4624
    ds_read_b64_tr_b16 v[220:221], v11 offset:24
    ds_read_b64_tr_b16 v[222:223], v11 offset:4632
    v_mfma_f32_16x16x32_bf16 v[128:131], v[228:231], v[32:35], v[128:131]
    v_mfma_f32_16x16x32_bf16 v[132:135], v[228:231], v[36:39], v[132:135]
    v_mfma_f32_16x16x32_bf16 v[136:139], v[228:231], v[40:43], v[136:139]
    v_mfma_f32_16x16x32_bf16 v[140:143], v[228:231], v[44:47], v[140:143]
    v_mfma_f32_16x16x32_bf16 v[144:147], v[232:235], v[32:35], v[144:147]
    v_mfma_f32_16x16x32_bf16 v[148:151], v[232:235], v[36:39], v[148:151]
    v_mfma_f32_16x16x32_bf16 v[152:155], v[232:235], v[40:43], v[152:155]
    v_mfma_f32_16x16x32_bf16 v[156:159], v[232:235], v[44:47], v[156:159]
    v_mfma_f32_16x16x32_bf16 v[160:163], v[236:239], v[32:35], v[160:163]
    v_mfma_f32_16x16x32_bf16 v[164:167], v[236:239], v[36:39], v[164:167]
    v_mfma_f32_16x16x32_bf16 v[168:171], v[236:239], v[40:43], v[168:171]
    v_mfma_f32_16x16x32_bf16 v[172:175], v[236:239], v[44:47], v[172:175]
    v_mfma_f32_16x16x32_bf16 v[176:179], v[240:243], v[32:35], v[176:179]
    v_mfma_f32_16x16x32_bf16 v[180:183], v[240:243], v[36:39], v[180:183]
    v_mfma_f32_16x16x32_bf16 v[184:187], v[240:243], v[40:43], v[184:187]
    v_mfma_f32_16x16x32_bf16 v[188:191], v[240:243], v[44:47], v[188:191]
    s_waitcnt lgkmcnt(8)
    s_waitcnt lgkmcnt(6)
    v_mfma_f32_16x16x32_bf16 v[48:51], v[208:211], v[16:19], v[48:51]
    ds_read_b64_tr_b16 v[224:225], v11 offset:32
    v_mfma_f32_16x16x32_bf16 v[52:55], v[208:211], v[20:23], v[52:55]
    ds_read_b64_tr_b16 v[226:227], v11 offset:4640
    v_mfma_f32_16x16x32_bf16 v[56:59], v[208:211], v[24:27], v[56:59]
    v_mfma_f32_16x16x32_bf16 v[60:63], v[208:211], v[28:31], v[60:63]
    s_waitcnt lgkmcnt(6)
    v_mfma_f32_16x16x32_bf16 v[64:67], v[212:215], v[16:19], v[64:67]
    ds_read_b64_tr_b16 v[228:229], v11 offset:40
    v_mfma_f32_16x16x32_bf16 v[68:71], v[212:215], v[20:23], v[68:71]
    ds_read_b64_tr_b16 v[230:231], v11 offset:4648
    v_mfma_f32_16x16x32_bf16 v[72:75], v[212:215], v[24:27], v[72:75]
    v_mfma_f32_16x16x32_bf16 v[76:79], v[212:215], v[28:31], v[76:79]
    s_waitcnt lgkmcnt(6)
    v_mfma_f32_16x16x32_bf16 v[80:83], v[216:219], v[16:19], v[80:83]
    ds_read_b64_tr_b16 v[232:233], v11 offset:48
    v_mfma_f32_16x16x32_bf16 v[84:87], v[216:219], v[20:23], v[84:87]
    ds_read_b64_tr_b16 v[234:235], v11 offset:4656
    v_mfma_f32_16x16x32_bf16 v[88:91], v[216:219], v[24:27], v[88:91]
    ds_read_b128 v[32:35], v8 offset:0
    v_mfma_f32_16x16x32_bf16 v[92:95], v[216:219], v[28:31], v[92:95]
    s_waitcnt lgkmcnt(7)
    v_mfma_f32_16x16x32_bf16 v[96:99], v[220:223], v[16:19], v[96:99]
    ds_read_b64_tr_b16 v[236:237], v11 offset:56
    v_mfma_f32_16x16x32_bf16 v[100:103], v[220:223], v[20:23], v[100:103]
    ds_read_b64_tr_b16 v[238:239], v11 offset:4664
    v_mfma_f32_16x16x32_bf16 v[104:107], v[220:223], v[24:27], v[104:107]
    ds_read_b128 v[36:39], v8 offset:2048
    v_mfma_f32_16x16x32_bf16 v[108:111], v[220:223], v[28:31], v[108:111]
    s_waitcnt lgkmcnt(8)
    v_mfma_f32_16x16x32_bf16 v[112:115], v[224:227], v[16:19], v[112:115]
    ds_read_b64_tr_b16 v[240:241], v11 offset:64
    v_mfma_f32_16x16x32_bf16 v[116:119], v[224:227], v[20:23], v[116:119]
    ds_read_b64_tr_b16 v[242:243], v11 offset:4672
    v_mfma_f32_16x16x32_bf16 v[120:123], v[224:227], v[24:27], v[120:123]
    ds_read_b128 v[40:43], v8 offset:4096
    v_mfma_f32_16x16x32_bf16 v[124:127], v[224:227], v[28:31], v[124:127]
    s_waitcnt lgkmcnt(9)
    v_mfma_f32_16x16x32_bf16 v[128:131], v[228:231], v[16:19], v[128:131]
    ds_read_b64_tr_b16 v[208:209], v11 offset:9216
    v_mfma_f32_16x16x32_bf16 v[132:135], v[228:231], v[20:23], v[132:135]
    ds_read_b64_tr_b16 v[210:211], v11 offset:13824
    v_mfma_f32_16x16x32_bf16 v[136:139], v[228:231], v[24:27], v[136:139]
    ds_read_b128 v[44:47], v8 offset:6144
    v_mfma_f32_16x16x32_bf16 v[140:143], v[228:231], v[28:31], v[140:143]
    s_waitcnt lgkmcnt(10)
    v_mfma_f32_16x16x32_bf16 v[144:147], v[232:235], v[16:19], v[144:147]
    ds_read_b64_tr_b16 v[212:213], v11 offset:9224
    v_mfma_f32_16x16x32_bf16 v[148:151], v[232:235], v[20:23], v[148:151]
    ds_read_b64_tr_b16 v[214:215], v11 offset:13832
    v_mfma_f32_16x16x32_bf16 v[152:155], v[232:235], v[24:27], v[152:155]
    v_mfma_f32_16x16x32_bf16 v[156:159], v[232:235], v[28:31], v[156:159]
    s_waitcnt lgkmcnt(9)
    v_mfma_f32_16x16x32_bf16 v[160:163], v[236:239], v[16:19], v[160:163]
    ds_read_b64_tr_b16 v[216:217], v11 offset:9232
    v_mfma_f32_16x16x32_bf16 v[164:167], v[236:239], v[20:23], v[164:167]
    ds_read_b64_tr_b16 v[218:219], v11 offset:13840
    v_mfma_f32_16x16x32_bf16 v[168:171], v[236:239], v[24:27], v[168:171]
    v_mfma_f32_16x16x32_bf16 v[172:175], v[236:239], v[28:31], v[172:175]
    s_waitcnt lgkmcnt(8)
    v_mfma_f32_16x16x32_bf16 v[176:179], v[240:243], v[16:19], v[176:179]
    ds_read_b64_tr_b16 v[220:221], v11 offset:9240
    v_mfma_f32_16x16x32_bf16 v[180:183], v[240:243], v[20:23], v[180:183]
    ds_read_b64_tr_b16 v[222:223], v11 offset:13848
    v_mfma_f32_16x16x32_bf16 v[184:187], v[240:243], v[24:27], v[184:187]
    v_mfma_f32_16x16x32_bf16 v[188:191], v[240:243], v[28:31], v[188:191]
    s_waitcnt lgkmcnt(6)
    s_mul_i32 s58, s53, 3
    s_add_u32 s58, s58, 2
    s_cmp_lg_u32 s58, s66
    s_cbranch_scc1 L_k1_xf_5
    s_cmp_eq_u32 s67, 1
    s_cbranch_scc1 L_k1_xf1_6
    s_add_u32 s58, s68, 0
    buffer_store_dwordx4 v[16:19], v12, s[24:27], s58 offen sc1
    s_add_u32 s58, s68, 18432
    buffer_store_dwordx4 v[20:23], v12, s[24:27], s58 offen sc1
    s_add_u32 s58, s68, 36864
    buffer_store_dwordx4 v[24:27], v12, s[24:27], s58 offen sc1
    s_add_u32 s58, s68, 55296
    buffer_store_dwordx4 v[28:31], v12, s[24:27], s58 offen sc1
    s_branch L_k1_xf_5
L_k1_xf1_6:
    s_add_u32 s58, s68, 0
    buffer_store_dwordx4 v[32:35], v12, s[24:27], s58 offen sc1
    s_add_u32 s58, s68, 18432
    buffer_store_dwordx4 v[36:39], v12, s[24:27], s58 offen sc1
    s_add_u32 s58, s68, 36864
    buffer_store_dwordx4 v[40:43], v12, s[24:27], s58 offen sc1
    s_add_u32 s58, s68, 55296
    buffer_store_dwordx4 v[44:47], v12, s[24:27], s58 offen sc1
L_k1_xf_5:
    v_mfma_f32_16x16x32_bf16 v[48:51], v[208:211], v[32:35], v[48:51]
    ds_read_b64_tr_b16 v[224:225], v11 offset:9248
    v_mfma_f32_16x16x32_bf16 v[52:55], v[208:211], v[36:39], v[52:55]
    ds_read_b64_tr_b16 v[226:227], v11 offset:13856
    v_mfma_f32_16x16x32_bf16 v[56:59], v[208:211], v[40:43], v[56:59]
    v_mfma_f32_16x16x32_bf16 v[60:63], v[208:211], v[44:47], v[60:63]
    s_waitcnt lgkmcnt(6)
    v_mfma_f32_16x16x32_bf16 v[64:67], v[212:215], v[32:35], v[64:67]
    ds_read_b64_tr_b16 v[228:229], v11 offset:9256
    v_mfma_f32_16x16x32_bf16 v[68:71], v[212:215], v[36:39], v[68:71]
    ds_read_b64_tr_b16 v[230:231], v11 offset:13864
    v_mfma_f32_16x16x32_bf16 v[72:75], v[212:215], v[40:43], v[72:75]
    v_mfma_f32_16x16x32_bf16 v[76:79], v[212:215], v[44:47], v[76:79]
    s_waitcnt lgkmcnt(6)
    v_mfma_f32_16x16x32_bf16 v[80:83], v[216:219], v[32:35], v[80:83]
    ds_read_b64_tr_b16 v[232:233], v11 offset:9264
    v_mfma_f32_16x16x32_bf16 v[84:87], v[216:219], v[36:39], v[84:87]
    ds_read_b64_tr_b16 v[234:235], v11 offset:13872
    v_mfma_f32_16x16x32_bf16 v[88:91], v[216:219], v[40:43], v[88:91]
    v_mfma_f32_16x16x32_bf16 v[92:95], v[216:219], v[44:47], v[92:95]
    s_waitcnt lgkmcnt(6)
    v_mfma_f32_16x16x32_bf16 v[96:99], v[220:223], v[32:35], v[96:99]
    ds_read_b64_tr_b16 v[236:237], v11 offset:9272
    v_mfma_f32_16x16x32_bf16 v[100:103], v[220:223], v[36:39], v[100:103]
    ds_read_b64_tr_b16 v[238:239], v11 offset:13880
    v_mfma_f32_16x16x32_bf16 v[104:107], v[220:223], v[40:43], v[104:107]
    v_mfma_f32_16x16x32_bf16 v[108:111], v[220:223], v[44:47], v[108:111]
    s_waitcnt lgkmcnt(6)
    v_mfma_f32_16x16x32_bf16 v[112:115], v[224:227], v[32:35], v[112:115]
    ds_read_b64_tr_b16 v[240:241], v11 offset:9280
    v_mfma_f32_16x16x32_bf16 v[116:119], v[224:227], v[36:39], v[116:119]
    ds_read_b64_tr_b16 v[242:243], v11 offset:13888
    v_mfma_f32_16x16x32_bf16 v[120:123], v[224:227], v[40:43], v[120:123]
    v_mfma_f32_16x16x32_bf16 v[124:127], v[224:227], v[44:47], v[124:127]
    s_waitcnt lgkmcnt(0)
    s_cmp_eq_u32 s53, 2
    s_cbranch_scc1 L_k1_last_7
    s_barrier
    ds_read_b128 v[16:19], v3 offset:0
    ds_read_b128 v[20:23], v3 offset:2048
    ds_read_b128 v[24:27], v3 offset:4096
    ds_read_b128 v[28:31], v3 offset:6144
    ds_read_b64_tr_b16 v[208:209], v9 offset:0
    ds_read_b64_tr_b16 v[210:211], v9 offset:4608
    ds_read_b64_tr_b16 v[212:213], v9 offset:8
    ds_read_b64_tr_b16 v[214:215], v9 offset:4616
    ds_read_b64_tr_b16 v[216:217], v9 offset:16
    ds_read_b64_tr_b16 v[218:219], v9 offset:4624
    ds_read_b64_tr_b16 v[220:221], v9 offset:24
    ds_read_b64_tr_b16 v[222:223], v9 offset:4632
L_k1_last_7:
    v_mfma_f32_16x16x32_bf16 v[128:131], v[228:231], v[32:35], v[128:131]
    v_mfma_f32_16x16x32_bf16 v[132:135], v[228:231], v[36:39], v[132:135]
    v_mfma_f32_16x16x32_bf16 v[136:139], v[228:231], v[40:43], v[136:139]
    v_mfma_f32_16x16x32_bf16 v[140:143], v[228:231], v[44:47], v[140:143]
    v_mfma_f32_16x16x32_bf16 v[144:147], v[232:235], v[32:35], v[144:147]
    v_mfma_f32_16x16x32_bf16 v[148:151], v[232:235], v[36:39], v[148:151]
    v_mfma_f32_16x16x32_bf16 v[152:155], v[232:235], v[40:43], v[152:155]
    v_mfma_f32_16x16x32_bf16 v[156:159], v[232:235], v[44:47], v[156:159]
    v_mfma_f32_16x16x32_bf16 v[160:163], v[236:239], v[32:35], v[160:163]
    v_mfma_f32_16x16x32_bf16 v[164:167], v[236:239], v[36:39], v[164:167]
    v_mfma_f32_16x16x32_bf16 v[168:171], v[236:239], v[40:43], v[168:171]
    v_mfma_f32_16x16x32_bf16 v[172:175], v[236:239], v[44:47], v[172:175]
    v_mfma_f32_16x16x32_bf16 v[176:179], v[240:243], v[32:35], v[176:179]
    v_mfma_f32_16x16x32_bf16 v[180:183], v[240:243], v[36:39], v[180:183]
    v_mfma_f32_16x16x32_bf16 v[184:187], v[240:243], v[40:43], v[184:187]
    v_mfma_f32_16x16x32_bf16 v[188:191], v[240:243], v[44:47], v[188:191]
    s_waitcnt lgkmcnt(8)
    s_waitcnt lgkmcnt(6)
    s_add_u32 s53, s53, 1
    s_cmp_lt_u32 s53, 3
    s_cbranch_scc1 L_k1_loop_qk
    s_cmp_lt_u32 s38, 4
    s_mov_b32 s60, 155648
    s_cselect_b32 s60, 73728, s60
    s_mov_b32 s64, 2432
    s_cselect_b32 s64, 1152, s64
    s_cselect_b32 s61, 5242880, 0
    s_cselect_b32 s62, 0x3eae1a93, 1.0
    s_cselect_b32 s63, 0, 1
    s_mov_b32 s62, s62
    s_and_b32 s59, s38, 3
    s_lshl_b32 s59, s59, 3
    s_mul_i32 s59, s59, s60
    s_add_u32 s61, s61, s59
    s_lshl_b32 s59, s37, 3
    s_lshl_b32 s58, s36, 1
    s_add_u32 s59, s59, s58
    s_mul_i32 s59, s59, s64
    s_add_u32 s61, s61, s59
    s_add_u32 s65, s61, s64
    v_and_b32 v12, 15, v2
    v_lshrrev_b32 v13, 4, v2
    v_and_b32 v14, 8, v12
    v_add_u32 v14, v14, v12
    s_cmp_eq_u32 s63, 1
    s_cselect_b64 vcc, -1, 0
    s_cselect_b32 s58, 8, 16
    v_cndmask_b32 v14, v12, v14, vcc
    v_add_u32 v15, s58, v14
    s_lshl_b32 s58, s60, 1
    v_mul_lo_u32 v13, v13, s58
    v_lshl_add_u32 v16, v14, 4, v13
    v_lshl_add_u32 v17, v15, 4, v13
    v_add_u32 v18, s60, v16
    v_add_u32 v19, s60, v17
    v_lshl_add_u32 v20, v14, 2, v13
    v_lshl_add_u32 v21, v15, 2, v13
    v_add_u32 v22, s60, v20
    v_add_u32 v23, s60, v21
    v_mov_b32 v24, s62
    v_mov_b32 v25, s62
    v_pk_mul_f32 v[48:49], v[48:49], v[24:25]
    v_pk_mul_f32 v[50:51], v[50:51], v[24:25]
    v_pk_mul_f32 v[64:65], v[64:65], v[24:25]
    v_pk_mul_f32 v[66:67], v[66:67], v[24:25]
    v_pk_mul_f32 v[80:81], v[80:81], v[24:25]
    v_pk_mul_f32 v[82:83], v[82:83], v[24:25]
    v_pk_mul_f32 v[96:97], v[96:97], v[24:25]
    v_pk_mul_f32 v[98:99], v[98:99], v[24:25]
    v_pk_mul_f32 v[112:113], v[112:113], v[24:25]
    v_pk_mul_f32 v[114:115], v[114:115], v[24:25]
    v_pk_mul_f32 v[128:129], v[128:129], v[24:25]
    v_pk_mul_f32 v[130:131], v[130:131], v[24:25]
    v_pk_mul_f32 v[144:145], v[144:145], v[24:25]
    v_pk_mul_f32 v[146:147], v[146:147], v[24:25]
    v_pk_mul_f32 v[160:161], v[160:161], v[24:25]
    v_pk_mul_f32 v[162:163], v[162:163], v[24:25]
    v_pk_mul_f32 v[176:177], v[176:177], v[24:25]
    v_pk_mul_f32 v[178:179], v[178:179], v[24:25]
    v_cvt_pk_bf16_f32 v208, v48, v49
    v_cvt_pk_bf16_f32 v209, v50, v51
    v_cvt_pk_bf16_f32 v210, v64, v65
    v_cvt_pk_bf16_f32 v211, v66, v67
    buffer_store_dwordx4 v[208:211], v16, s[24:27], s61 offen offset:0
    v_cvt_pk_bf16_f32 v212, v80, v81
    v_cvt_pk_bf16_f32 v213, v82, v83
    v_cvt_pk_bf16_f32 v214, v96, v97
    v_cvt_pk_bf16_f32 v215, v98, v99
    buffer_store_dwordx4 v[212:215], v16, s[24:27], s61 offen offset:512
    v_cvt_pk_bf16_f32 v216, v128, v129
    v_cvt_pk_bf16_f32 v217, v130, v131
    v_cvt_pk_bf16_f32 v218, v144, v145
    v_cvt_pk_bf16_f32 v219, v146, v147
    buffer_store_dwordx4 v[216:219], v18, s[24:27], s61 offen offset:0
    v_cvt_pk_bf16_f32 v220, v160, v161
    v_cvt_pk_bf16_f32 v221, v162, v163
    v_cvt_pk_bf16_f32 v222, v176, v177
    v_cvt_pk_bf16_f32 v223, v178, v179
    buffer_store_dwordx4 v[220:223], v18, s[24:27], s61 offen offset:512
    v_cvt_pk_bf16_f32 v224, v112, v113
    v_cvt_pk_bf16_f32 v225, v114, v115
    buffer_store_dword v224, v20, s[24:27], s61 offen offset:1024
    buffer_store_dword v225, v22, s[24:27], s61 offen offset:1024
    v_pk_mul_f32 v[52:53], v[52:53], v[24:25]
    v_pk_mul_f32 v[54:55], v[54:55], v[24:25]
    v_pk_mul_f32 v[68:69], v[68:69], v[24:25]
    v_pk_mul_f32 v[70:71], v[70:71], v[24:25]
    v_pk_mul_f32 v[84:85], v[84:85], v[24:25]
    v_pk_mul_f32 v[86:87], v[86:87], v[24:25]
    v_pk_mul_f32 v[100:101], v[100:101], v[24:25]
    v_pk_mul_f32 v[102:103], v[102:103], v[24:25]
    v_pk_mul_f32 v[116:117], v[116:117], v[24:25]
    v_pk_mul_f32 v[118:119], v[118:119], v[24:25]
    v_pk_mul_f32 v[132:133], v[132:133], v[24:25]
    v_pk_mul_f32 v[134:135], v[134:135], v[24:25]
    v_pk_mul_f32 v[148:149], v[148:149], v[24:25]
    v_pk_mul_f32 v[150:151], v[150:151], v[24:25]
    v_pk_mul_f32 v[164:165], v[164:165], v[24:25]
    v_pk_mul_f32 v[166:167], v[166:167], v[24:25]
    v_pk_mul_f32 v[180:181], v[180:181], v[24:25]
    v_pk_mul_f32 v[182:183], v[182:183], v[24:25]
    v_cvt_pk_bf16_f32 v228, v52, v53
    v_cvt_pk_bf16_f32 v229, v54, v55
    v_cvt_pk_bf16_f32 v230, v68, v69
    v_cvt_pk_bf16_f32 v231, v70, v71
    buffer_store_dwordx4 v[228:231], v17, s[24:27], s61 offen offset:0
    v_cvt_pk_bf16_f32 v232, v84, v85
    v_cvt_pk_bf16_f32 v233, v86, v87
    v_cvt_pk_bf16_f32 v234, v100, v101
    v_cvt_pk_bf16_f32 v235, v102, v103
    buffer_store_dwordx4 v[232:235], v17, s[24:27], s61 offen offset:512
    v_cvt_pk_bf16_f32 v236, v132, v133
    v_cvt_pk_bf16_f32 v237, v134, v135
    v_cvt_pk_bf16_f32 v238, v148, v149
    v_cvt_pk_bf16_f32 v239, v150, v151
    buffer_store_dwordx4 v[236:239], v19, s[24:27], s61 offen offset:0
    v_cvt_pk_bf16_f32 v208, v164, v165
    v_cvt_pk_bf16_f32 v209, v166, v167
    v_cvt_pk_bf16_f32 v210, v180, v181
    v_cvt_pk_bf16_f32 v211, v182, v183
    buffer_store_dwordx4 v[208:211], v19, s[24:27], s61 offen offset:512
    v_cvt_pk_bf16_f32 v212, v116, v117
    v_cvt_pk_bf16_f32 v213, v118, v119
    buffer_store_dword v212, v21, s[24:27], s61 offen offset:1024
    buffer_store_dword v213, v23, s[24:27], s61 offen offset:1024
    v_pk_mul_f32 v[56:57], v[56:57], v[24:25]
    v_pk_mul_f32 v[58:59], v[58:59], v[24:25]
    v_pk_mul_f32 v[72:73], v[72:73], v[24:25]
    v_pk_mul_f32 v[74:75], v[74:75], v[24:25]
    v_pk_mul_f32 v[88:89], v[88:89], v[24:25]
    v_pk_mul_f32 v[90:91], v[90:91], v[24:25]
    v_pk_mul_f32 v[104:105], v[104:105], v[24:25]
    v_pk_mul_f32 v[106:107], v[106:107], v[24:25]
    v_pk_mul_f32 v[120:121], v[120:121], v[24:25]
    v_pk_mul_f32 v[122:123], v[122:123], v[24:25]
    v_pk_mul_f32 v[136:137], v[136:137], v[24:25]
    v_pk_mul_f32 v[138:139], v[138:139], v[24:25]
    v_pk_mul_f32 v[152:153], v[152:153], v[24:25]
    v_pk_mul_f32 v[154:155], v[154:155], v[24:25]
    v_pk_mul_f32 v[168:169], v[168:169], v[24:25]
    v_pk_mul_f32 v[170:171], v[170:171], v[24:25]
    v_pk_mul_f32 v[184:185], v[184:185], v[24:25]
    v_pk_mul_f32 v[186:187], v[186:187], v[24:25]
    v_cvt_pk_bf16_f32 v216, v56, v57
    v_cvt_pk_bf16_f32 v217, v58, v59
    v_cvt_pk_bf16_f32 v218, v72, v73
    v_cvt_pk_bf16_f32 v219, v74, v75
    buffer_store_dwordx4 v[216:219], v16, s[24:27], s65 offen offset:0
    v_cvt_pk_bf16_f32 v220, v88, v89
    v_cvt_pk_bf16_f32 v221, v90, v91
    v_cvt_pk_bf16_f32 v222, v104, v105
    v_cvt_pk_bf16_f32 v223, v106, v107
    buffer_store_dwordx4 v[220:223], v16, s[24:27], s65 offen offset:512
    v_cvt_pk_bf16_f32 v224, v136, v137
    v_cvt_pk_bf16_f32 v225, v138, v139
    v_cvt_pk_bf16_f32 v226, v152, v153
    v_cvt_pk_bf16_f32 v227, v154, v155
    buffer_store_dwordx4 v[224:227], v18, s[24:27], s65 offen offset:0
    v_cvt_pk_bf16_f32 v228, v168, v169
    v_cvt_pk_bf16_f32 v229, v170, v171
    v_cvt_pk_bf16_f32 v230, v184, v185
    v_cvt_pk_bf16_f32 v231, v186, v187
    buffer_store_dwordx4 v[228:231], v18, s[24:27], s65 offen offset:512
    v_cvt_pk_bf16_f32 v232, v120, v121
    v_cvt_pk_bf16_f32 v233, v122, v123
    buffer_store_dword v232, v20, s[24:27], s65 offen offset:1024
    buffer_store_dword v233, v22, s[24:27], s65 offen offset:1024
    v_pk_mul_f32 v[60:61], v[60:61], v[24:25]
    v_pk_mul_f32 v[62:63], v[62:63], v[24:25]
    v_pk_mul_f32 v[76:77], v[76:77], v[24:25]
    v_pk_mul_f32 v[78:79], v[78:79], v[24:25]
    v_pk_mul_f32 v[92:93], v[92:93], v[24:25]
    v_pk_mul_f32 v[94:95], v[94:95], v[24:25]
    v_pk_mul_f32 v[108:109], v[108:109], v[24:25]
    v_pk_mul_f32 v[110:111], v[110:111], v[24:25]
    v_pk_mul_f32 v[124:125], v[124:125], v[24:25]
    v_pk_mul_f32 v[126:127], v[126:127], v[24:25]
    v_pk_mul_f32 v[140:141], v[140:141], v[24:25]
    v_pk_mul_f32 v[142:143], v[142:143], v[24:25]
    v_pk_mul_f32 v[156:157], v[156:157], v[24:25]
    v_pk_mul_f32 v[158:159], v[158:159], v[24:25]
    v_pk_mul_f32 v[172:173], v[172:173], v[24:25]
    v_pk_mul_f32 v[174:175], v[174:175], v[24:25]
    v_pk_mul_f32 v[188:189], v[188:189], v[24:25]
    v_pk_mul_f32 v[190:191], v[190:191], v[24:25]
    v_cvt_pk_bf16_f32 v236, v60, v61
    v_cvt_pk_bf16_f32 v237, v62, v63
    v_cvt_pk_bf16_f32 v238, v76, v77
    v_cvt_pk_bf16_f32 v239, v78, v79
    buffer_store_dwordx4 v[236:239], v17, s[24:27], s65 offen offset:0
    v_cvt_pk_bf16_f32 v208, v92, v93
    v_cvt_pk_bf16_f32 v209, v94, v95
    v_cvt_pk_bf16_f32 v210, v108, v109
    v_cvt_pk_bf16_f32 v211, v110, v111
    buffer_store_dwordx4 v[208:211], v17, s[24:27], s65 offen offset:512
    v_cvt_pk_bf16_f32 v212, v140, v141
    v_cvt_pk_bf16_f32 v213, v142, v143
    v_cvt_pk_bf16_f32 v214, v156, v157
    v_cvt_pk_bf16_f32 v215, v158, v159
    buffer_store_dwordx4 v[212:215], v19, s[24:27], s65 offen offset:0
    v_cvt_pk_bf16_f32 v216, v172, v173
    v_cvt_pk_bf16_f32 v217, v174, v175
    v_cvt_pk_bf16_f32 v218, v188, v189
    v_cvt_pk_bf16_f32 v219, v190, v191
    buffer_store_dwordx4 v[216:219], v19, s[24:27], s65 offen offset:512
    v_cvt_pk_bf16_f32 v220, v124, v125
    v_cvt_pk_bf16_f32 v221, v126, v127
    buffer_store_dword v220, v21, s[24:27], s65 offen offset:1024
    buffer_store_dword v221, v23, s[24:27], s65 offen offset:1024
    s_branch L_k1_fin
L_k1_Z:
    s_mov_b32 s53, 0
    s_barrier
    ds_read_b128 v[16:19], v3 offset:0
    ds_read_b128 v[20:23], v3 offset:2048
    ds_read_b128 v[24:27], v3 offset:4096
    ds_read_b128 v[28:31], v3 offset:6144
    ds_read_b64_tr_b16 v[208:209], v9 offset:0
    ds_read_b64_tr_b16 v[210:211], v9 offset:4608
    ds_read_b64_tr_b16 v[212:213], v9 offset:32
    ds_read_b64_tr_b16 v[214:215], v9 offset:4640
    ds_read_b64_tr_b16 v[216:217], v9 offset:64
    ds_read_b64_tr_b16 v[218:219], v9 offset:4672
    ds_read_b64_tr_b16 v[220:221], v9 offset:96
    ds_read_b64_tr_b16 v[222:223], v9 offset:4704
    s_waitcnt lgkmcnt(8)
    s_waitcnt lgkmcnt(6)
.p2align 6
L_k1_loop_z:
    v_mfma_f32_16x16x32_bf16 v[48:51], v[208:211], v[16:19], v[48:51]
    ds_read_b64_tr_b16 v[224:225], v9 offset:128
    v_mfma_f32_16x16x32_bf16 v[52:55], v[208:211], v[20:23], v[52:55]
    ds_read_b64_tr_b16 v[226:227], v9 offset:4736
    v_mfma_f32_16x16x32_bf16 v[56:59], v[208:211], v[24:27], v[56:59]
    v_mfma_f32_16x16x32_bf16 v[60:63], v[208:211], v[28:31], v[60:63]
    s_waitcnt lgkmcnt(6)
    v_mfma_f32_16x16x32_bf16 v[64:67], v[212:215], v[16:19], v[64:67]
    ds_read_b64_tr_b16 v[228:229], v9 offset:160
    v_mfma_f32_16x16x32_bf16 v[68:71], v[212:215], v[20:23], v[68:71]
    ds_read_b64_tr_b16 v[230:231], v9 offset:4768
    v_mfma_f32_16x16x32_bf16 v[72:75], v[212:215], v[24:27], v[72:75]
    v_mfma_f32_16x16x32_bf16 v[76:79], v[212:215], v[28:31], v[76:79]
    s_waitcnt lgkmcnt(6)
    v_mfma_f32_16x16x32_bf16 v[80:83], v[216:219], v[16:19], v[80:83]
    ds_read_b64_tr_b16 v[232:233], v9 offset:192
    v_mfma_f32_16x16x32_bf16 v[84:87], v[216:219], v[20:23], v[84:87]
    ds_read_b64_tr_b16 v[234:235], v9 offset:4800
    v_mfma_f32_16x16x32_bf16 v[88:91], v[216:219], v[24:27], v[88:91]
    ds_read_b128 v[32:35], v4 offset:0
    v_mfma_f32_16x16x32_bf16 v[92:95], v[216:219], v[28:31], v[92:95]
    s_waitcnt lgkmcnt(7)
    v_mfma_f32_16x16x32_bf16 v[96:99], v[220:223], v[16:19], v[96:99]
    ds_read_b64_tr_b16 v[236:237], v9 offset:224
    v_mfma_f32_16x16x32_bf16 v[100:103], v[220:223], v[20:23], v[100:103]
    ds_read_b64_tr_b16 v[238:239], v9 offset:4832
    v_mfma_f32_16x16x32_bf16 v[104:107], v[220:223], v[24:27], v[104:107]
    ds_read_b128 v[36:39], v4 offset:2048
    v_mfma_f32_16x16x32_bf16 v[108:111], v[220:223], v[28:31], v[108:111]
    s_waitcnt lgkmcnt(8)
    v_mfma_f32_16x16x32_bf16 v[112:115], v[224:227], v[16:19], v[112:115]
    ds_read_b64_tr_b16 v[240:241], v9 offset:256
    v_mfma_f32_16x16x32_bf16 v[116:119], v[224:227], v[20:23], v[116:119]
    ds_read_b64_tr_b16 v[242:243], v9 offset:4864
    v_mfma_f32_16x16x32_bf16 v[120:123], v[224:227], v[24:27], v[120:123]
    ds_read_b128 v[40:43], v4 offset:4096
    v_mfma_f32_16x16x32_bf16 v[124:127], v[224:227], v[28:31], v[124:127]
    s_waitcnt lgkmcnt(9)
    v_mfma_f32_16x16x32_bf16 v[128:131], v[228:231], v[16:19], v[128:131]
    ds_read_b64_tr_b16 v[208:209], v9 offset:9216
    v_mfma_f32_16x16x32_bf16 v[132:135], v[228:231], v[20:23], v[132:135]
    ds_read_b64_tr_b16 v[210:211], v9 offset:13824
    v_mfma_f32_16x16x32_bf16 v[136:139], v[228:231], v[24:27], v[136:139]
    ds_read_b128 v[44:47], v4 offset:6144
    v_mfma_f32_16x16x32_bf16 v[140:143], v[228:231], v[28:31], v[140:143]
    s_waitcnt lgkmcnt(10)
    v_mfma_f32_16x16x32_bf16 v[144:147], v[232:235], v[16:19], v[144:147]
    ds_read_b64_tr_b16 v[212:213], v9 offset:9248
    v_mfma_f32_16x16x32_bf16 v[148:151], v[232:235], v[20:23], v[148:151]
    ds_read_b64_tr_b16 v[214:215], v9 offset:13856
    v_mfma_f32_16x16x32_bf16 v[152:155], v[232:235], v[24:27], v[152:155]
    v_mfma_f32_16x16x32_bf16 v[156:159], v[232:235], v[28:31], v[156:159]
    s_waitcnt lgkmcnt(9)
    v_mfma_f32_16x16x32_bf16 v[160:163], v[236:239], v[16:19], v[160:163]
    ds_read_b64_tr_b16 v[216:217], v9 offset:9280
    v_mfma_f32_16x16x32_bf16 v[164:167], v[236:239], v[20:23], v[164:167]
    ds_read_b64_tr_b16 v[218:219], v9 offset:13888
    v_mfma_f32_16x16x32_bf16 v[168:171], v[236:239], v[24:27], v[168:171]
    v_mfma_f32_16x16x32_bf16 v[172:175], v[236:239], v[28:31], v[172:175]
    s_waitcnt lgkmcnt(8)
    v_mfma_f32_16x16x32_bf16 v[176:179], v[240:243], v[16:19], v[176:179]
    ds_read_b64_tr_b16 v[220:221], v9 offset:9312
    v_mfma_f32_16x16x32_bf16 v[180:183], v[240:243], v[20:23], v[180:183]
    ds_read_b64_tr_b16 v[222:223], v9 offset:13920
    v_mfma_f32_16x16x32_bf16 v[184:187], v[240:243], v[24:27], v[184:187]
    v_mfma_f32_16x16x32_bf16 v[188:191], v[240:243], v[28:31], v[188:191]
    s_waitcnt lgkmcnt(6)
    s_mul_i32 s58, s53, 3
    s_add_u32 s58, s58, 0
    s_cmp_lg_u32 s58, s66
    s_cbranch_scc1 L_k1_xf_8
    s_cmp_eq_u32 s67, 1
    s_cbranch_scc1 L_k1_xf1_9
    s_add_u32 s58, s68, 0
    buffer_store_dwordx4 v[16:19], v12, s[24:27], s58 offen sc1
    s_add_u32 s58, s68, 18432
    buffer_store_dwordx4 v[20:23], v12, s[24:27], s58 offen sc1
    s_add_u32 s58, s68, 36864
    buffer_store_dwordx4 v[24:27], v12, s[24:27], s58 offen sc1
    s_add_u32 s58, s68, 55296
    buffer_store_dwordx4 v[28:31], v12, s[24:27], s58 offen sc1
    s_branch L_k1_xf_8
L_k1_xf1_9:
    s_add_u32 s58, s68, 0
    buffer_store_dwordx4 v[32:35], v12, s[24:27], s58 offen sc1
    s_add_u32 s58, s68, 18432
    buffer_store_dwordx4 v[36:39], v12, s[24:27], s58 offen sc1
    s_add_u32 s58, s68, 36864
    buffer_store_dwordx4 v[40:43], v12, s[24:27], s58 offen sc1
    s_add_u32 s58, s68, 55296
    buffer_store_dwordx4 v[44:47], v12, s[24:27], s58 offen sc1
L_k1_xf_8:
    v_mfma_f32_16x16x32_bf16 v[48:51], v[208:211], v[32:35], v[48:51]
    ds_read_b64_tr_b16 v[224:225], v9 offset:9344
    v_mfma_f32_16x16x32_bf16 v[52:55], v[208:211], v[36:39], v[52:55]
    ds_read_b64_tr_b16 v[226:227], v9 offset:13952
    v_mfma_f32_16x16x32_bf16 v[56:59], v[208:211], v[40:43], v[56:59]
    v_mfma_f32_16x16x32_bf16 v[60:63], v[208:211], v[44:47], v[60:63]
    s_waitcnt lgkmcnt(6)
    v_mfma_f32_16x16x32_bf16 v[64:67], v[212:215], v[32:35], v[64:67]
    ds_read_b64_tr_b16 v[228:229], v9 offset:9376
    v_mfma_f32_16x16x32_bf16 v[68:71], v[212:215], v[36:39], v[68:71]
    ds_read_b64_tr_b16 v[230:231], v9 offset:13984
    v_mfma_f32_16x16x32_bf16 v[72:75], v[212:215], v[40:43], v[72:75]
    v_mfma_f32_16x16x32_bf16 v[76:79], v[212:215], v[44:47], v[76:79]
    s_waitcnt lgkmcnt(6)
    v_mfma_f32_16x16x32_bf16 v[80:83], v[216:219], v[32:35], v[80:83]
    ds_read_b64_tr_b16 v[232:233], v9 offset:9408
    v_mfma_f32_16x16x32_bf16 v[84:87], v[216:219], v[36:39], v[84:87]
    ds_read_b64_tr_b16 v[234:235], v9 offset:14016
    v_mfma_f32_16x16x32_bf16 v[88:91], v[216:219], v[40:43], v[88:91]
    v_mfma_f32_16x16x32_bf16 v[92:95], v[216:219], v[44:47], v[92:95]
    s_waitcnt lgkmcnt(6)
    v_mfma_f32_16x16x32_bf16 v[96:99], v[220:223], v[32:35], v[96:99]
    ds_read_b64_tr_b16 v[236:237], v9 offset:9440
    v_mfma_f32_16x16x32_bf16 v[100:103], v[220:223], v[36:39], v[100:103]
    ds_read_b64_tr_b16 v[238:239], v9 offset:14048
    v_mfma_f32_16x16x32_bf16 v[104:107], v[220:223], v[40:43], v[104:107]
    v_mfma_f32_16x16x32_bf16 v[108:111], v[220:223], v[44:47], v[108:111]
    s_waitcnt lgkmcnt(6)
    v_mfma_f32_16x16x32_bf16 v[112:115], v[224:227], v[32:35], v[112:115]
    ds_read_b64_tr_b16 v[240:241], v9 offset:9472
    v_mfma_f32_16x16x32_bf16 v[116:119], v[224:227], v[36:39], v[116:119]
    ds_read_b64_tr_b16 v[242:243], v9 offset:14080
    v_mfma_f32_16x16x32_bf16 v[120:123], v[224:227], v[40:43], v[120:123]
    v_mfma_f32_16x16x32_bf16 v[124:127], v[224:227], v[44:47], v[124:127]
    s_waitcnt lgkmcnt(0)
    s_barrier
    ds_read_b128 v[16:19], v5 offset:0
    ds_read_b128 v[20:23], v5 offset:2048
    ds_read_b128 v[24:27], v5 offset:4096
    ds_read_b128 v[28:31], v5 offset:6144
    ds_read_b64_tr_b16 v[208:209], v10 offset:0
    ds_read_b64_tr_b16 v[210:211], v10 offset:4608
    ds_read_b64_tr_b16 v[212:213], v10 offset:32
    ds_read_b64_tr_b16 v[214:215], v10 offset:4640
    ds_read_b64_tr_b16 v[216:217], v10 offset:64
    ds_read_b64_tr_b16 v[218:219], v10 offset:4672
    ds_read_b64_tr_b16 v[220:221], v10 offset:96
    ds_read_b64_tr_b16 v[222:223], v10 offset:4704
    v_mfma_f32_16x16x32_bf16 v[128:131], v[228:231], v[32:35], v[128:131]
    v_mfma_f32_16x16x32_bf16 v[132:135], v[228:231], v[36:39], v[132:135]
    v_mfma_f32_16x16x32_bf16 v[136:139], v[228:231], v[40:43], v[136:139]
    v_mfma_f32_16x16x32_bf16 v[140:143], v[228:231], v[44:47], v[140:143]
    v_mfma_f32_16x16x32_bf16 v[144:147], v[232:235], v[32:35], v[144:147]
    v_mfma_f32_16x16x32_bf16 v[148:151], v[232:235], v[36:39], v[148:151]
    v_mfma_f32_16x16x32_bf16 v[152:155], v[232:235], v[40:43], v[152:155]
    v_mfma_f32_16x16x32_bf16 v[156:159], v[232:235], v[44:47], v[156:159]
    v_mfma_f32_16x16x32_bf16 v[160:163], v[236:239], v[32:35], v[160:163]
    v_mfma_f32_16x16x32_bf16 v[164:167], v[236:239], v[36:39], v[164:167]
    v_mfma_f32_16x16x32_bf16 v[168:171], v[236:239], v[40:43], v[168:171]
    v_mfma_f32_16x16x32_bf16 v[172:175], v[236:239], v[44:47], v[172:175]
    v_mfma_f32_16x16x32_bf16 v[176:179], v[240:243], v[32:35], v[176:179]
    v_mfma_f32_16x16x32_bf16 v[180:183], v[240:243], v[36:39], v[180:183]
    v_mfma_f32_16x16x32_bf16 v[184:187], v[240:243], v[40:43], v[184:187]
    v_mfma_f32_16x16x32_bf16 v[188:191], v[240:243], v[44:47], v[188:191]
    s_waitcnt lgkmcnt(8)
    s_waitcnt lgkmcnt(6)
    v_mfma_f32_16x16x32_bf16 v[48:51], v[208:211], v[16:19], v[48:51]
    ds_read_b64_tr_b16 v[224:225], v10 offset:128
    v_mfma_f32_16x16x32_bf16 v[52:55], v[208:211], v[20:23], v[52:55]
    ds_read_b64_tr_b16 v[226:227], v10 offset:4736
    v_mfma_f32_16x16x32_bf16 v[56:59], v[208:211], v[24:27], v[56:59]
    v_mfma_f32_16x16x32_bf16 v[60:63], v[208:211], v[28:31], v[60:63]
    s_waitcnt lgkmcnt(6)
    v_mfma_f32_16x16x32_bf16 v[64:67], v[212:215], v[16:19], v[64:67]
    ds_read_b64_tr_b16 v[228:229], v10 offset:160
    v_mfma_f32_16x16x32_bf16 v[68:71], v[212:215], v[20:23], v[68:71]
    ds_read_b64_tr_b16 v[230:231], v10 offset:4768
    v_mfma_f32_16x16x32_bf16 v[72:75], v[212:215], v[24:27], v[72:75]
    v_mfma_f32_16x16x32_bf16 v[76:79], v[212:215], v[28:31], v[76:79]
    s_waitcnt lgkmcnt(6)
    v_mfma_f32_16x16x32_bf16 v[80:83], v[216:219], v[16:19], v[80:83]
    ds_read_b64_tr_b16 v[232:233], v10 offset:192
    v_mfma_f32_16x16x32_bf16 v[84:87], v[216:219], v[20:23], v[84:87]
    ds_read_b64_tr_b16 v[234:235], v10 offset:4800
    v_mfma_f32_16x16x32_bf16 v[88:91], v[216:219], v[24:27], v[88:91]
    ds_read_b128 v[32:35], v6 offset:0
    v_mfma_f32_16x16x32_bf16 v[92:95], v[216:219], v[28:31], v[92:95]
    s_waitcnt lgkmcnt(7)
    v_mfma_f32_16x16x32_bf16 v[96:99], v[220:223], v[16:19], v[96:99]
    ds_read_b64_tr_b16 v[236:237], v10 offset:224
    v_mfma_f32_16x16x32_bf16 v[100:103], v[220:223], v[20:23], v[100:103]
    ds_read_b64_tr_b16 v[238:239], v10 offset:4832
    v_mfma_f32_16x16x32_bf16 v[104:107], v[220:223], v[24:27], v[104:107]
    ds_read_b128 v[36:39], v6 offset:2048
    v_mfma_f32_16x16x32_bf16 v[108:111], v[220:223], v[28:31], v[108:111]
    s_waitcnt lgkmcnt(8)
    v_mfma_f32_16x16x32_bf16 v[112:115], v[224:227], v[16:19], v[112:115]
    ds_read_b64_tr_b16 v[240:241], v10 offset:256
    v_mfma_f32_16x16x32_bf16 v[116:119], v[224:227], v[20:23], v[116:119]
    ds_read_b64_tr_b16 v[242:243], v10 offset:4864
    v_mfma_f32_16x16x32_bf16 v[120:123], v[224:227], v[24:27], v[120:123]
    ds_read_b128 v[40:43], v6 offset:4096
    v_mfma_f32_16x16x32_bf16 v[124:127], v[224:227], v[28:31], v[124:127]
    s_waitcnt lgkmcnt(9)
    v_mfma_f32_16x16x32_bf16 v[128:131], v[228:231], v[16:19], v[128:131]
    ds_read_b64_tr_b16 v[208:209], v10 offset:9216
    v_mfma_f32_16x16x32_bf16 v[132:135], v[228:231], v[20:23], v[132:135]
    ds_read_b64_tr_b16 v[210:211], v10 offset:13824
    v_mfma_f32_16x16x32_bf16 v[136:139], v[228:231], v[24:27], v[136:139]
    ds_read_b128 v[44:47], v6 offset:6144
    v_mfma_f32_16x16x32_bf16 v[140:143], v[228:231], v[28:31], v[140:143]
    s_waitcnt lgkmcnt(10)
    v_mfma_f32_16x16x32_bf16 v[144:147], v[232:235], v[16:19], v[144:147]
    ds_read_b64_tr_b16 v[212:213], v10 offset:9248
    v_mfma_f32_16x16x32_bf16 v[148:151], v[232:235], v[20:23], v[148:151]
    ds_read_b64_tr_b16 v[214:215], v10 offset:13856
    v_mfma_f32_16x16x32_bf16 v[152:155], v[232:235], v[24:27], v[152:155]
    v_mfma_f32_16x16x32_bf16 v[156:159], v[232:235], v[28:31], v[156:159]
    s_waitcnt lgkmcnt(9)
    v_mfma_f32_16x16x32_bf16 v[160:163], v[236:239], v[16:19], v[160:163]
    ds_read_b64_tr_b16 v[216:217], v10 offset:9280
    v_mfma_f32_16x16x32_bf16 v[164:167], v[236:239], v[20:23], v[164:167]
    ds_read_b64_tr_b16 v[218:219], v10 offset:13888
    v_mfma_f32_16x16x32_bf16 v[168:171], v[236:239], v[24:27], v[168:171]
    v_mfma_f32_16x16x32_bf16 v[172:175], v[236:239], v[28:31], v[172:175]
    s_waitcnt lgkmcnt(8)
    v_mfma_f32_16x16x32_bf16 v[176:179], v[240:243], v[16:19], v[176:179]
    ds_read_b64_tr_b16 v[220:221], v10 offset:9312
    v_mfma_f32_16x16x32_bf16 v[180:183], v[240:243], v[20:23], v[180:183]
    ds_read_b64_tr_b16 v[222:223], v10 offset:13920
    v_mfma_f32_16x16x32_bf16 v[184:187], v[240:243], v[24:27], v[184:187]
    v_mfma_f32_16x16x32_bf16 v[188:191], v[240:243], v[28:31], v[188:191]
    s_waitcnt lgkmcnt(6)
    s_mul_i32 s58, s53, 3
    s_add_u32 s58, s58, 1
    s_cmp_lg_u32 s58, s66
    s_cbranch_scc1 L_k1_xf_10
    s_cmp_eq_u32 s67, 1
    s_cbranch_scc1 L_k1_xf1_11
    s_add_u32 s58, s68, 0
    buffer_store_dwordx4 v[16:19], v12, s[24:27], s58 offen sc1
    s_add_u32 s58, s68, 18432
    buffer_store_dwordx4 v[20:23], v12, s[24:27], s58 offen sc1
    s_add_u32 s58, s68, 36864
    buffer_store_dwordx4 v[24:27], v12, s[24:27], s58 offen sc1
    s_add_u32 s58, s68, 55296
    buffer_store_dwordx4 v[28:31], v12, s[24:27], s58 offen sc1
    s_branch L_k1_xf_10
L_k1_xf1_11:
    s_add_u32 s58, s68, 0
    buffer_store_dwordx4 v[32:35], v12, s[24:27], s58 offen sc1
    s_add_u32 s58, s68, 18432
    buffer_store_dwordx4 v[36:39], v12, s[24:27], s58 offen sc1
    s_add_u32 s58, s68, 36864
    buffer_store_dwordx4 v[40:43], v12, s[24:27], s58 offen sc1
    s_add_u32 s58, s68, 55296
    buffer_store_dwordx4 v[44:47], v12, s[24:27], s58 offen sc1
L_k1_xf_10:
    v_mfma_f32_16x16x32_bf16 v[48:51], v[208:211], v[32:35], v[48:51]
    ds_read_b64_tr_b16 v[224:225], v10 offset:9344
    v_mfma_f32_16x16x32_bf16 v[52:55], v[208:211], v[36:39], v[52:55]
    ds_read_b64_tr_b16 v[226:227], v10 offset:13952
    v_mfma_f32_16x16x32_bf16 v[56:59], v[208:211], v[40:43], v[56:59]
    v_mfma_f32_16x16x32_bf16 v[60:63], v[208:211], v[44:47], v[60:63]
    s_waitcnt lgkmcnt(6)
    v_mfma_f32_16x16x32_bf16 v[64:67], v[212:215], v[32:35], v[64:67]
    ds_read_b64_tr_b16 v[228:229], v10 offset:9376
    v_mfma_f32_16x16x32_bf16 v[68:71], v[212:215], v[36:39], v[68:71]
    ds_read_b64_tr_b16 v[230:231], v10 offset:13984
    v_mfma_f32_16x16x32_bf16 v[72:75], v[212:215], v[40:43], v[72:75]
    v_mfma_f32_16x16x32_bf16 v[76:79], v[212:215], v[44:47], v[76:79]
    s_waitcnt lgkmcnt(6)
    v_mfma_f32_16x16x32_bf16 v[80:83], v[216:219], v[32:35], v[80:83]
    ds_read_b64_tr_b16 v[232:233], v10 offset:9408
    v_mfma_f32_16x16x32_bf16 v[84:87], v[216:219], v[36:39], v[84:87]
    ds_read_b64_tr_b16 v[234:235], v10 offset:14016
    v_mfma_f32_16x16x32_bf16 v[88:91], v[216:219], v[40:43], v[88:91]
    v_mfma_f32_16x16x32_bf16 v[92:95], v[216:219], v[44:47], v[92:95]
    s_waitcnt lgkmcnt(6)
    v_mfma_f32_16x16x32_bf16 v[96:99], v[220:223], v[32:35], v[96:99]
    ds_read_b64_tr_b16 v[236:237], v10 offset:9440
    v_mfma_f32_16x16x32_bf16 v[100:103], v[220:223], v[36:39], v[100:103]
    ds_read_b64_tr_b16 v[238:239], v10 offset:14048
    v_mfma_f32_16x16x32_bf16 v[104:107], v[220:223], v[40:43], v[104:107]
    v_mfma_f32_16x16x32_bf16 v[108:111], v[220:223], v[44:47], v[108:111]
    s_waitcnt lgkmcnt(6)
    v_mfma_f32_16x16x32_bf16 v[112:115], v[224:227], v[32:35], v[112:115]
    ds_read_b64_tr_b16 v[240:241], v10 offset:9472
    v_mfma_f32_16x16x32_bf16 v[116:119], v[224:227], v[36:39], v[116:119]
    ds_read_b64_tr_b16 v[242:243], v10 offset:14080
    v_mfma_f32_16x16x32_bf16 v[120:123], v[224:227], v[40:43], v[120:123]
    v_mfma_f32_16x16x32_bf16 v[124:127], v[224:227], v[44:47], v[124:127]
    s_waitcnt lgkmcnt(0)
    s_barrier
    ds_read_b128 v[16:19], v7 offset:0
    ds_read_b128 v[20:23], v7 offset:2048
    ds_read_b128 v[24:27], v7 offset:4096
    ds_read_b128 v[28:31], v7 offset:6144
    ds_read_b64_tr_b16 v[208:209], v11 offset:0
    ds_read_b64_tr_b16 v[210:211], v11 offset:4608
    ds_read_b64_tr_b16 v[212:213], v11 offset:32
    ds_read_b64_tr_b16 v[214:215], v11 offset:4640
    ds_read_b64_tr_b16 v[216:217], v11 offset:64
    ds_read_b64_tr_b16 v[218:219], v11 offset:4672
    ds_read_b64_tr_b16 v[220:221], v11 offset:96
    ds_read_b64_tr_b16 v[222:223], v11 offset:4704
    v_mfma_f32_16x16x32_bf16 v[128:131], v[228:231], v[32:35], v[128:131]
    v_mfma_f32_16x16x32_bf16 v[132:135], v[228:231], v[36:39], v[132:135]
    v_mfma_f32_16x16x32_bf16 v[136:139], v[228:231], v[40:43], v[136:139]
    v_mfma_f32_16x16x32_bf16 v[140:143], v[228:231], v[44:47], v[140:143]
    v_mfma_f32_16x16x32_bf16 v[144:147], v[232:235], v[32:35], v[144:147]
    v_mfma_f32_16x16x32_bf16 v[148:151], v[232:235], v[36:39], v[148:151]
    v_mfma_f32_16x16x32_bf16 v[152:155], v[232:235], v[40:43], v[152:155]
    v_mfma_f32_16x16x32_bf16 v[156:159], v[232:235], v[44:47], v[156:159]
    v_mfma_f32_16x16x32_bf16 v[160:163], v[236:239], v[32:35], v[160:163]
    v_mfma_f32_16x16x32_bf16 v[164:167], v[236:239], v[36:39], v[164:167]
    v_mfma_f32_16x16x32_bf16 v[168:171], v[236:239], v[40:43], v[168:171]
    v_mfma_f32_16x16x32_bf16 v[172:175], v[236:239], v[44:47], v[172:175]
    v_mfma_f32_16x16x32_bf16 v[176:179], v[240:243], v[32:35], v[176:179]
    v_mfma_f32_16x16x32_bf16 v[180:183], v[240:243], v[36:39], v[180:183]
    v_mfma_f32_16x16x32_bf16 v[184:187], v[240:243], v[40:43], v[184:187]
    v_mfma_f32_16x16x32_bf16 v[188:191], v[240:243], v[44:47], v[188:191]
    s_waitcnt lgkmcnt(8)
    s_waitcnt lgkmcnt(6)
    v_mfma_f32_16x16x32_bf16 v[48:51], v[208:211], v[16:19], v[48:51]
    ds_read_b64_tr_b16 v[224:225], v11 offset:128
    v_mfma_f32_16x16x32_bf16 v[52:55], v[208:211], v[20:23], v[52:55]
    ds_read_b64_tr_b16 v[226:227], v11 offset:4736
    v_mfma_f32_16x16x32_bf16 v[56:59], v[208:211], v[24:27], v[56:59]
    v_mfma_f32_16x16x32_bf16 v[60:63], v[208:211], v[28:31], v[60:63]
    s_waitcnt lgkmcnt(6)
    v_mfma_f32_16x16x32_bf16 v[64:67], v[212:215], v[16:19], v[64:67]
    ds_read_b64_tr_b16 v[228:229], v11 offset:160
    v_mfma_f32_16x16x32_bf16 v[68:71], v[212:215], v[20:23], v[68:71]
    ds_read_b64_tr_b16 v[230:231], v11 offset:4768
    v_mfma_f32_16x16x32_bf16 v[72:75], v[212:215], v[24:27], v[72:75]
    v_mfma_f32_16x16x32_bf16 v[76:79], v[212:215], v[28:31], v[76:79]
    s_waitcnt lgkmcnt(6)
    v_mfma_f32_16x16x32_bf16 v[80:83], v[216:219], v[16:19], v[80:83]
    ds_read_b64_tr_b16 v[232:233], v11 offset:192
    v_mfma_f32_16x16x32_bf16 v[84:87], v[216:219], v[20:23], v[84:87]
    ds_read_b64_tr_b16 v[234:235], v11 offset:4800
    v_mfma_f32_16x16x32_bf16 v[88:91], v[216:219], v[24:27], v[88:91]
    ds_read_b128 v[32:35], v8 offset:0
    v_mfma_f32_16x16x32_bf16 v[92:95], v[216:219], v[28:31], v[92:95]
    s_waitcnt lgkmcnt(7)
    v_mfma_f32_16x16x32_bf16 v[96:99], v[220:223], v[16:19], v[96:99]
    ds_read_b64_tr_b16 v[236:237], v11 offset:224
    v_mfma_f32_16x16x32_bf16 v[100:103], v[220:223], v[20:23], v[100:103]
    ds_read_b64_tr_b16 v[238:239], v11 offset:4832
    v_mfma_f32_16x16x32_bf16 v[104:107], v[220:223], v[24:27], v[104:107]
    ds_read_b128 v[36:39], v8 offset:2048
    v_mfma_f32_16x16x32_bf16 v[108:111], v[220:223], v[28:31], v[108:111]
    s_waitcnt lgkmcnt(8)
    v_mfma_f32_16x16x32_bf16 v[112:115], v[224:227], v[16:19], v[112:115]
    ds_read_b64_tr_b16 v[240:241], v11 offset:256
    v_mfma_f32_16x16x32_bf16 v[116:119], v[224:227], v[20:23], v[116:119]
    ds_read_b64_tr_b16 v[242:243], v11 offset:4864
    v_mfma_f32_16x16x32_bf16 v[120:123], v[224:227], v[24:27], v[120:123]
    ds_read_b128 v[40:43], v8 offset:4096
    v_mfma_f32_16x16x32_bf16 v[124:127], v[224:227], v[28:31], v[124:127]
    s_waitcnt lgkmcnt(9)
    v_mfma_f32_16x16x32_bf16 v[128:131], v[228:231], v[16:19], v[128:131]
    ds_read_b64_tr_b16 v[208:209], v11 offset:9216
    v_mfma_f32_16x16x32_bf16 v[132:135], v[228:231], v[20:23], v[132:135]
    ds_read_b64_tr_b16 v[210:211], v11 offset:13824
    v_mfma_f32_16x16x32_bf16 v[136:139], v[228:231], v[24:27], v[136:139]
    ds_read_b128 v[44:47], v8 offset:6144
    v_mfma_f32_16x16x32_bf16 v[140:143], v[228:231], v[28:31], v[140:143]
    s_waitcnt lgkmcnt(10)
    v_mfma_f32_16x16x32_bf16 v[144:147], v[232:235], v[16:19], v[144:147]
    ds_read_b64_tr_b16 v[212:213], v11 offset:9248
    v_mfma_f32_16x16x32_bf16 v[148:151], v[232:235], v[20:23], v[148:151]
    ds_read_b64_tr_b16 v[214:215], v11 offset:13856
    v_mfma_f32_16x16x32_bf16 v[152:155], v[232:235], v[24:27], v[152:155]
    v_mfma_f32_16x16x32_bf16 v[156:159], v[232:235], v[28:31], v[156:159]
    s_waitcnt lgkmcnt(9)
    v_mfma_f32_16x16x32_bf16 v[160:163], v[236:239], v[16:19], v[160:163]
    ds_read_b64_tr_b16 v[216:217], v11 offset:9280
    v_mfma_f32_16x16x32_bf16 v[164:167], v[236:239], v[20:23], v[164:167]
    ds_read_b64_tr_b16 v[218:219], v11 offset:13888
    v_mfma_f32_16x16x32_bf16 v[168:171], v[236:239], v[24:27], v[168:171]
    v_mfma_f32_16x16x32_bf16 v[172:175], v[236:239], v[28:31], v[172:175]
    s_waitcnt lgkmcnt(8)
    v_mfma_f32_16x16x32_bf16 v[176:179], v[240:243], v[16:19], v[176:179]
    ds_read_b64_tr_b16 v[220:221], v11 offset:9312
    v_mfma_f32_16x16x32_bf16 v[180:183], v[240:243], v[20:23], v[180:183]
    ds_read_b64_tr_b16 v[222:223], v11 offset:13920
    v_mfma_f32_16x16x32_bf16 v[184:187], v[240:243], v[24:27], v[184:187]
    v_mfma_f32_16x16x32_bf16 v[188:191], v[240:243], v[28:31], v[188:191]
    s_waitcnt lgkmcnt(6)
    s_mul_i32 s58, s53, 3
    s_add_u32 s58, s58, 2
    s_cmp_lg_u32 s58, s66
    s_cbranch_scc1 L_k1_xf_12
    s_cmp_eq_u32 s67, 1
    s_cbranch_scc1 L_k1_xf1_13
    s_add_u32 s58, s68, 0
    buffer_store_dwordx4 v[16:19], v12, s[24:27], s58 offen sc1
    s_add_u32 s58, s68, 18432
    buffer_store_dwordx4 v[20:23], v12, s[24:27], s58 offen sc1
    s_add_u32 s58, s68, 36864
    buffer_store_dwordx4 v[24:27], v12, s[24:27], s58 offen sc1
    s_add_u32 s58, s68, 55296
    buffer_store_dwordx4 v[28:31], v12, s[24:27], s58 offen sc1
    s_branch L_k1_xf_12
L_k1_xf1_13:
    s_add_u32 s58, s68, 0
    buffer_store_dwordx4 v[32:35], v12, s[24:27], s58 offen sc1
    s_add_u32 s58, s68, 18432
    buffer_store_dwordx4 v[36:39], v12, s[24:27], s58 offen sc1
    s_add_u32 s58, s68, 36864
    buffer_store_dwordx4 v[40:43], v12, s[24:27], s58 offen sc1
    s_add_u32 s58, s68, 55296
    buffer_store_dwordx4 v[44:47], v12, s[24:27], s58 offen sc1
L_k1_xf_12:
    v_mfma_f32_16x16x32_bf16 v[48:51], v[208:211], v[32:35], v[48:51]
    ds_read_b64_tr_b16 v[224:225], v11 offset:9344
    v_mfma_f32_16x16x32_bf16 v[52:55], v[208:211], v[36:39], v[52:55]
    ds_read_b64_tr_b16 v[226:227], v11 offset:13952
    v_mfma_f32_16x16x32_bf16 v[56:59], v[208:211], v[40:43], v[56:59]
    v_mfma_f32_16x16x32_bf16 v[60:63], v[208:211], v[44:47], v[60:63]
    s_waitcnt lgkmcnt(6)
    v_mfma_f32_16x16x32_bf16 v[64:67], v[212:215], v[32:35], v[64:67]
    ds_read_b64_tr_b16 v[228:229], v11 offset:9376
    v_mfma_f32_16x16x32_bf16 v[68:71], v[212:215], v[36:39], v[68:71]
    ds_read_b64_tr_b16 v[230:231], v11 offset:13984
    v_mfma_f32_16x16x32_bf16 v[72:75], v[212:215], v[40:43], v[72:75]
    v_mfma_f32_16x16x32_bf16 v[76:79], v[212:215], v[44:47], v[76:79]
    s_waitcnt lgkmcnt(6)
    v_mfma_f32_16x16x32_bf16 v[80:83], v[216:219], v[32:35], v[80:83]
    ds_read_b64_tr_b16 v[232:233], v11 offset:9408
    v_mfma_f32_16x16x32_bf16 v[84:87], v[216:219], v[36:39], v[84:87]
    ds_read_b64_tr_b16 v[234:235], v11 offset:14016
    v_mfma_f32_16x16x32_bf16 v[88:91], v[216:219], v[40:43], v[88:91]
    v_mfma_f32_16x16x32_bf16 v[92:95], v[216:219], v[44:47], v[92:95]
    s_waitcnt lgkmcnt(6)
    v_mfma_f32_16x16x32_bf16 v[96:99], v[220:223], v[32:35], v[96:99]
    ds_read_b64_tr_b16 v[236:237], v11 offset:9440
    v_mfma_f32_16x16x32_bf16 v[100:103], v[220:223], v[36:39], v[100:103]
    ds_read_b64_tr_b16 v[238:239], v11 offset:14048
    v_mfma_f32_16x16x32_bf16 v[104:107], v[220:223], v[40:43], v[104:107]
    v_mfma_f32_16x16x32_bf16 v[108:111], v[220:223], v[44:47], v[108:111]
    s_waitcnt lgkmcnt(6)
    v_mfma_f32_16x16x32_bf16 v[112:115], v[224:227], v[32:35], v[112:115]
    ds_read_b64_tr_b16 v[240:241], v11 offset:9472
    v_mfma_f32_16x16x32_bf16 v[116:119], v[224:227], v[36:39], v[116:119]
    ds_read_b64_tr_b16 v[242:243], v11 offset:14080
    v_mfma_f32_16x16x32_bf16 v[120:123], v[224:227], v[40:43], v[120:123]
    v_mfma_f32_16x16x32_bf16 v[124:127], v[224:227], v[44:47], v[124:127]
    s_waitcnt lgkmcnt(0)
    s_cmp_eq_u32 s53, 2
    s_cbranch_scc1 L_k1_last_14
    s_barrier
    ds_read_b128 v[16:19], v3 offset:0
    ds_read_b128 v[20:23], v3 offset:2048
    ds_read_b128 v[24:27], v3 offset:4096
    ds_read_b128 v[28:31], v3 offset:6144
    ds_read_b64_tr_b16 v[208:209], v9 offset:0
    ds_read_b64_tr_b16 v[210:211], v9 offset:4608
    ds_read_b64_tr_b16 v[212:213], v9 offset:32
    ds_read_b64_tr_b16 v[214:215], v9 offset:4640
    ds_read_b64_tr_b16 v[216:217], v9 offset:64
    ds_read_b64_tr_b16 v[218:219], v9 offset:4672
    ds_read_b64_tr_b16 v[220:221], v9 offset:96
    ds_read_b64_tr_b16 v[222:223], v9 offset:4704
L_k1_last_14:
    v_mfma_f32_16x16x32_bf16 v[128:131], v[228:231], v[32:35], v[128:131]
    v_mfma_f32_16x16x32_bf16 v[132:135], v[228:231], v[36:39], v[132:135]
    v_mfma_f32_16x16x32_bf16 v[136:139], v[228:231], v[40:43], v[136:139]
    v_mfma_f32_16x16x32_bf16 v[140:143], v[228:231], v[44:47], v[140:143]
    v_mfma_f32_16x16x32_bf16 v[144:147], v[232:235], v[32:35], v[144:147]
    v_mfma_f32_16x16x32_bf16 v[148:151], v[232:235], v[36:39], v[148:151]
    v_mfma_f32_16x16x32_bf16 v[152:155], v[232:235], v[40:43], v[152:155]
    v_mfma_f32_16x16x32_bf16 v[156:159], v[232:235], v[44:47], v[156:159]
    v_mfma_f32_16x16x32_bf16 v[160:163], v[236:239], v[32:35], v[160:163]
    v_mfma_f32_16x16x32_bf16 v[164:167], v[236:239], v[36:39], v[164:167]
    v_mfma_f32_16x16x32_bf16 v[168:171], v[236:239], v[40:43], v[168:171]
    v_mfma_f32_16x16x32_bf16 v[172:175], v[236:239], v[44:47], v[172:175]
    v_mfma_f32_16x16x32_bf16 v[176:179], v[240:243], v[32:35], v[176:179]
    v_mfma_f32_16x16x32_bf16 v[180:183], v[240:243], v[36:39], v[180:183]
    v_mfma_f32_16x16x32_bf16 v[184:187], v[240:243], v[40:43], v[184:187]
    v_mfma_f32_16x16x32_bf16 v[188:191], v[240:243], v[44:47], v[188:191]
    s_waitcnt lgkmcnt(8)
    s_waitcnt lgkmcnt(6)
    s_add_u32 s53, s53, 1
    s_cmp_lt_u32 s53, 3
    s_cbranch_scc1 L_k1_loop_z
    s_sub_u32 s58, s38, 12
    s_lshr_b32 s59, s58, 1
    s_and_b32 s60, s58, 1
    s_mul_i32 s59, s59, 9
    s_mul_i32 s61, s60, 5
    s_add_u32 s61, s61, s59
    s_add_u32 s62, s59, 4
    s_lshl_b32 s63, s37, 4
    s_lshl_b32 s58, s36, 2
    s_add_u32 s63, s63, s58
    s_mul_i32 s63, s63, 73728
    s_add_u32 s63, s63, 8388608
    s_lshl_b32 s61, s61, 10
    s_add_u32 s61, s61, s63
    s_lshl_b32 s62, s62, 10
    s_add_u32 s62, s62, s63
    s_lshl_b32 s60, s60, 9
    s_add_u32 s62, s62, s60
    v_lshlrev_b32 v10, 4, v2
    v_lshrrev_b32 v13, 4, v2
    v_and_b32 v14, 15, v2
    v_lshrrev_b32 v11, 1, v13
    v_lshlrev_b32 v11, 8, v11
    v_lshl_add_u32 v11, v14, 4, v11
    v_mov_b32 v14, 1073741824
    v_and_b32 v13, 1, v13
    v_cmp_eq_u32 vcc, 0, v13
    s_nop 1
    v_cndmask_b32 v11, v14, v11, vcc
    v_cvt_pk_bf16_f32 v208, v48, v49
    v_cvt_pk_bf16_f32 v209, v50, v51
    v_cvt_pk_bf16_f32 v210, v64, v65
    v_cvt_pk_bf16_f32 v211, v66, v67
    s_add_u32 s58, s61, 0
    buffer_store_dwordx4 v[208:211], v10, s[24:27], s58 offen
    v_cvt_pk_bf16_f32 v212, v80, v81
    v_cvt_pk_bf16_f32 v213, v82, v83
    v_cvt_pk_bf16_f32 v214, v96, v97
    v_cvt_pk_bf16_f32 v215, v98, v99
    s_add_u32 s58, s61, 1024
    buffer_store_dwordx4 v[212:215], v10, s[24:27], s58 offen
    v_cvt_pk_bf16_f32 v216, v112, v113
    v_cvt_pk_bf16_f32 v217, v114, v115
    v_cvt_pk_bf16_f32 v218, v128, v129
    v_cvt_pk_bf16_f32 v219, v130, v131
    s_add_u32 s58, s61, 2048
    buffer_store_dwordx4 v[216:219], v10, s[24:27], s58 offen
    v_cvt_pk_bf16_f32 v220, v144, v145
    v_cvt_pk_bf16_f32 v221, v146, v147
    v_cvt_pk_bf16_f32 v222, v160, v161
    v_cvt_pk_bf16_f32 v223, v162, v163
    s_add_u32 s58, s61, 3072
    buffer_store_dwordx4 v[220:223], v10, s[24:27], s58 offen
    v_cvt_pk_bf16_f32 v224, v176, v177
    v_cvt_pk_bf16_f32 v225, v178, v179
    v_mov_b32 v14, v224
    v_mov_b32 v226, v224
    v_mov_b32 v15, v225
    v_mov_b32 v227, v225
    v_permlane16_swap_b32 v14, v226
    s_nop 0
    v_permlane16_swap_b32 v15, v227
    s_add_u32 s58, s62, 0
    buffer_store_dwordx4 v[224:227], v11, s[24:27], s58 offen
    v_cvt_pk_bf16_f32 v228, v52, v53
    v_cvt_pk_bf16_f32 v229, v54, v55
    v_cvt_pk_bf16_f32 v230, v68, v69
    v_cvt_pk_bf16_f32 v231, v70, v71
    s_add_u32 s58, s61, 73728
    buffer_store_dwordx4 v[228:231], v10, s[24:27], s58 offen
    v_cvt_pk_bf16_f32 v232, v84, v85
    v_cvt_pk_bf16_f32 v233, v86, v87
    v_cvt_pk_bf16_f32 v234, v100, v101
    v_cvt_pk_bf16_f32 v235, v102, v103
    s_add_u32 s58, s61, 74752
    buffer_store_dwordx4 v[232:235], v10, s[24:27], s58 offen
    v_cvt_pk_bf16_f32 v236, v116, v117
    v_cvt_pk_bf16_f32 v237, v118, v119
    v_cvt_pk_bf16_f32 v238, v132, v133
    v_cvt_pk_bf16_f32 v239, v134, v135
    s_add_u32 s58, s61, 75776
    buffer_store_dwordx4 v[236:239], v10, s[24:27], s58 offen
    v_cvt_pk_bf16_f32 v208, v148, v149
    v_cvt_pk_bf16_f32 v209, v150, v151
    v_cvt_pk_bf16_f32 v210, v164, v165
    v_cvt_pk_bf16_f32 v211, v166, v167
    s_add_u32 s58, s61, 76800
    buffer_store_dwordx4 v[208:211], v10, s[24:27], s58 offen
    v_cvt_pk_bf16_f32 v212, v180, v181
    v_cvt_pk_bf16_f32 v213, v182, v183
    v_mov_b32 v14, v212
    v_mov_b32 v214, v212
    v_mov_b32 v15, v213
    v_mov_b32 v215, v213
    v_permlane16_swap_b32 v14, v214
    s_nop 0
    v_permlane16_swap_b32 v15, v215
    s_add_u32 s58, s62, 73728
    buffer_store_dwordx4 v[212:215], v11, s[24:27], s58 offen
    v_cvt_pk_bf16_f32 v216, v56, v57
    v_cvt_pk_bf16_f32 v217, v58, v59
    v_cvt_pk_bf16_f32 v218, v72, v73
    v_cvt_pk_bf16_f32 v219, v74, v75
    s_add_u32 s58, s61, 147456
    buffer_store_dwordx4 v[216:219], v10, s[24:27], s58 offen
    v_cvt_pk_bf16_f32 v220, v88, v89
    v_cvt_pk_bf16_f32 v221, v90, v91
    v_cvt_pk_bf16_f32 v222, v104, v105
    v_cvt_pk_bf16_f32 v223, v106, v107
    s_add_u32 s58, s61, 148480
    buffer_store_dwordx4 v[220:223], v10, s[24:27], s58 offen
    v_cvt_pk_bf16_f32 v224, v120, v121
    v_cvt_pk_bf16_f32 v225, v122, v123
    v_cvt_pk_bf16_f32 v226, v136, v137
    v_cvt_pk_bf16_f32 v227, v138, v139
    s_add_u32 s58, s61, 149504
    buffer_store_dwordx4 v[224:227], v10, s[24:27], s58 offen
    v_cvt_pk_bf16_f32 v228, v152, v153
    v_cvt_pk_bf16_f32 v229, v154, v155
    v_cvt_pk_bf16_f32 v230, v168, v169
    v_cvt_pk_bf16_f32 v231, v170, v171
    s_add_u32 s58, s61, 150528
    buffer_store_dwordx4 v[228:231], v10, s[24:27], s58 offen
    v_cvt_pk_bf16_f32 v232, v184, v185
    v_cvt_pk_bf16_f32 v233, v186, v187
    v_mov_b32 v14, v232
    v_mov_b32 v234, v232
    v_mov_b32 v15, v233
    v_mov_b32 v235, v233
    v_permlane16_swap_b32 v14, v234
    s_nop 0
    v_permlane16_swap_b32 v15, v235
    s_add_u32 s58, s62, 147456
    buffer_store_dwordx4 v[232:235], v11, s[24:27], s58 offen
    v_cvt_pk_bf16_f32 v236, v60, v61
    v_cvt_pk_bf16_f32 v237, v62, v63
    v_cvt_pk_bf16_f32 v238, v76, v77
    v_cvt_pk_bf16_f32 v239, v78, v79
    s_add_u32 s58, s61, 221184
    buffer_store_dwordx4 v[236:239], v10, s[24:27], s58 offen
    v_cvt_pk_bf16_f32 v208, v92, v93
    v_cvt_pk_bf16_f32 v209, v94, v95
    v_cvt_pk_bf16_f32 v210, v108, v109
    v_cvt_pk_bf16_f32 v211, v110, v111
    s_add_u32 s58, s61, 222208
    buffer_store_dwordx4 v[208:211], v10, s[24:27], s58 offen
    v_cvt_pk_bf16_f32 v212, v124, v125
    v_cvt_pk_bf16_f32 v213, v126, v127
    v_cvt_pk_bf16_f32 v214, v140, v141
    v_cvt_pk_bf16_f32 v215, v142, v143
    s_add_u32 s58, s61, 223232
    buffer_store_dwordx4 v[212:215], v10, s[24:27], s58 offen
    v_cvt_pk_bf16_f32 v216, v156, v157
    v_cvt_pk_bf16_f32 v217, v158, v159
    v_cvt_pk_bf16_f32 v218, v172, v173
    v_cvt_pk_bf16_f32 v219, v174, v175
    s_add_u32 s58, s61, 224256
    buffer_store_dwordx4 v[216:219], v10, s[24:27], s58 offen
    v_cvt_pk_bf16_f32 v220, v188, v189
    v_cvt_pk_bf16_f32 v221, v190, v191
    v_mov_b32 v14, v220
    v_mov_b32 v222, v220
    v_mov_b32 v15, v221
    v_mov_b32 v223, v221
    v_permlane16_swap_b32 v14, v222
    s_nop 0
    v_permlane16_swap_b32 v15, v223
    s_add_u32 s58, s62, 221184
    buffer_store_dwordx4 v[220:223], v11, s[24:27], s58 offen
    s_branch L_k1_fin
L_k1_V:
    s_mov_b32 s53, 0
    s_barrier
    ds_read_b128 v[16:19], v3 offset:0
    ds_read_b128 v[20:23], v3 offset:2048
    ds_read_b128 v[24:27], v3 offset:4096
    ds_read_b128 v[28:31], v3 offset:6144
    ds_read_b64_tr_b16 v[208:209], v9 offset:0
    ds_read_b64_tr_b16 v[210:211], v9 offset:4608
    ds_read_b64_tr_b16 v[212:213], v9 offset:32
    ds_read_b64_tr_b16 v[214:215], v9 offset:4640
    ds_read_b64_tr_b16 v[216:217], v9 offset:64
    ds_read_b64_tr_b16 v[218:219], v9 offset:4672
    ds_read_b64_tr_b16 v[220:221], v9 offset:96
    ds_read_b64_tr_b16 v[222:223], v9 offset:4704
    s_waitcnt lgkmcnt(8)
    s_waitcnt lgkmcnt(6)
.p2align 6
L_k1_loop_v:
    v_mfma_f32_16x16x32_bf16 v[48:51], v[16:19], v[208:211], v[48:51]
    ds_read_b64_tr_b16 v[224:225], v9 offset:128
    v_mfma_f32_16x16x32_bf16 v[52:55], v[20:23], v[208:211], v[52:55]
    ds_read_b64_tr_b16 v[226:227], v9 offset:4736
    v_mfma_f32_16x16x32_bf16 v[56:59], v[24:27], v[208:211], v[56:59]
    v_mfma_f32_16x16x32_bf16 v[60:63], v[28:31], v[208:211], v[60:63]
    s_waitcnt lgkmcnt(6)
    v_mfma_f32_16x16x32_bf16 v[64:67], v[16:19], v[212:215], v[64:67]
    ds_read_b64_tr_b16 v[228:229], v9 offset:160
    v_mfma_f32_16x16x32_bf16 v[68:71], v[20:23], v[212:215], v[68:71]
    ds_read_b64_tr_b16 v[230:231], v9 offset:4768
    v_mfma_f32_16x16x32_bf16 v[72:75], v[24:27], v[212:215], v[72:75]
    v_mfma_f32_16x16x32_bf16 v[76:79], v[28:31], v[212:215], v[76:79]
    s_waitcnt lgkmcnt(6)
    v_mfma_f32_16x16x32_bf16 v[80:83], v[16:19], v[216:219], v[80:83]
    ds_read_b64_tr_b16 v[232:233], v9 offset:192
    v_mfma_f32_16x16x32_bf16 v[84:87], v[20:23], v[216:219], v[84:87]
    ds_read_b64_tr_b16 v[234:235], v9 offset:4800
    v_mfma_f32_16x16x32_bf16 v[88:91], v[24:27], v[216:219], v[88:91]
    ds_read_b128 v[32:35], v4 offset:0
    v_mfma_f32_16x16x32_bf16 v[92:95], v[28:31], v[216:219], v[92:95]
    s_waitcnt lgkmcnt(7)
    v_mfma_f32_16x16x32_bf16 v[96:99], v[16:19], v[220:223], v[96:99]
    ds_read_b64_tr_b16 v[236:237], v9 offset:224
    v_mfma_f32_16x16x32_bf16 v[100:103], v[20:23], v[220:223], v[100:103]
    ds_read_b64_tr_b16 v[238:239], v9 offset:4832
    v_mfma_f32_16x16x32_bf16 v[104:107], v[24:27], v[220:223], v[104:107]
    ds_read_b128 v[36:39], v4 offset:2048
    v_mfma_f32_16x16x32_bf16 v[108:111], v[28:31], v[220:223], v[108:111]
    s_waitcnt lgkmcnt(8)
    v_mfma_f32_16x16x32_bf16 v[112:115], v[16:19], v[224:227], v[112:115]
    ds_read_b64_tr_b16 v[240:241], v9 offset:256
    v_mfma_f32_16x16x32_bf16 v[116:119], v[20:23], v[224:227], v[116:119]
    ds_read_b64_tr_b16 v[242:243], v9 offset:4864
    v_mfma_f32_16x16x32_bf16 v[120:123], v[24:27], v[224:227], v[120:123]
    ds_read_b128 v[40:43], v4 offset:4096
    v_mfma_f32_16x16x32_bf16 v[124:127], v[28:31], v[224:227], v[124:127]
    s_waitcnt lgkmcnt(9)
    v_mfma_f32_16x16x32_bf16 v[128:131], v[16:19], v[228:231], v[128:131]
    ds_read_b64_tr_b16 v[208:209], v9 offset:9216
    v_mfma_f32_16x16x32_bf16 v[132:135], v[20:23], v[228:231], v[132:135]
    ds_read_b64_tr_b16 v[210:211], v9 offset:13824
    v_mfma_f32_16x16x32_bf16 v[136:139], v[24:27], v[228:231], v[136:139]
    ds_read_b128 v[44:47], v4 offset:6144
    v_mfma_f32_16x16x32_bf16 v[140:143], v[28:31], v[228:231], v[140:143]
    s_waitcnt lgkmcnt(10)
    v_mfma_f32_16x16x32_bf16 v[144:147], v[16:19], v[232:235], v[144:147]
    ds_read_b64_tr_b16 v[212:213], v9 offset:9248
    v_mfma_f32_16x16x32_bf16 v[148:151], v[20:23], v[232:235], v[148:151]
    ds_read_b64_tr_b16 v[214:215], v9 offset:13856
    v_mfma_f32_16x16x32_bf16 v[152:155], v[24:27], v[232:235], v[152:155]
    v_mfma_f32_16x16x32_bf16 v[156:159], v[28:31], v[232:235], v[156:159]
    s_waitcnt lgkmcnt(9)
    v_mfma_f32_16x16x32_bf16 v[160:163], v[16:19], v[236:239], v[160:163]
    ds_read_b64_tr_b16 v[216:217], v9 offset:9280
    v_mfma_f32_16x16x32_bf16 v[164:167], v[20:23], v[236:239], v[164:167]
    ds_read_b64_tr_b16 v[218:219], v9 offset:13888
    v_mfma_f32_16x16x32_bf16 v[168:171], v[24:27], v[236:239], v[168:171]
    v_mfma_f32_16x16x32_bf16 v[172:175], v[28:31], v[236:239], v[172:175]
    s_waitcnt lgkmcnt(8)
    v_mfma_f32_16x16x32_bf16 v[176:179], v[16:19], v[240:243], v[176:179]
    ds_read_b64_tr_b16 v[220:221], v9 offset:9312
    v_mfma_f32_16x16x32_bf16 v[180:183], v[20:23], v[240:243], v[180:183]
    ds_read_b64_tr_b16 v[222:223], v9 offset:13920
    v_mfma_f32_16x16x32_bf16 v[184:187], v[24:27], v[240:243], v[184:187]
    v_mfma_f32_16x16x32_bf16 v[188:191], v[28:31], v[240:243], v[188:191]
    s_waitcnt lgkmcnt(6)
    s_mul_i32 s58, s53, 3
    s_add_u32 s58, s58, 0
    s_cmp_lg_u32 s58, s66
    s_cbranch_scc1 L_k1_xf_15
    s_cmp_eq_u32 s67, 1
    s_cbranch_scc1 L_k1_xf1_16
    s_add_u32 s58, s68, 0
    buffer_store_dwordx4 v[16:19], v12, s[24:27], s58 offen sc1
    s_add_u32 s58, s68, 18432
    buffer_store_dwordx4 v[20:23], v12, s[24:27], s58 offen sc1
    s_add_u32 s58, s68, 36864
    buffer_store_dwordx4 v[24:27], v12, s[24:27], s58 offen sc1
    s_add_u32 s58, s68, 55296
    buffer_store_dwordx4 v[28:31], v12, s[24:27], s58 offen sc1
    s_branch L_k1_xf_15
L_k1_xf1_16:
    s_add_u32 s58, s68, 0
    buffer_store_dwordx4 v[32:35], v12, s[24:27], s58 offen sc1
    s_add_u32 s58, s68, 18432
    buffer_store_dwordx4 v[36:39], v12, s[24:27], s58 offen sc1
    s_add_u32 s58, s68, 36864
    buffer_store_dwordx4 v[40:43], v12, s[24:27], s58 offen sc1
    s_add_u32 s58, s68, 55296
    buffer_store_dwordx4 v[44:47], v12, s[24:27], s58 offen sc1
L_k1_xf_15:
    v_mfma_f32_16x16x32_bf16 v[48:51], v[32:35], v[208:211], v[48:51]
    ds_read_b64_tr_b16 v[224:225], v9 offset:9344
    v_mfma_f32_16x16x32_bf16 v[52:55], v[36:39], v[208:211], v[52:55]
    ds_read_b64_tr_b16 v[226:227], v9 offset:13952
    v_mfma_f32_16x16x32_bf16 v[56:59], v[40:43], v[208:211], v[56:59]
    v_mfma_f32_16x16x32_bf16 v[60:63], v[44:47], v[208:211], v[60:63]
    s_waitcnt lgkmcnt(6)
    v_mfma_f32_16x16x32_bf16 v[64:67], v[32:35], v[212:215], v[64:67]
    ds_read_b64_tr_b16 v[228:229], v9 offset:9376
    v_mfma_f32_16x16x32_bf16 v[68:71], v[36:39], v[212:215], v[68:71]
    ds_read_b64_tr_b16 v[230:231], v9 offset:13984
    v_mfma_f32_16x16x32_bf16 v[72:75], v[40:43], v[212:215], v[72:75]
    v_mfma_f32_16x16x32_bf16 v[76:79], v[44:47], v[212:215], v[76:79]
    s_waitcnt lgkmcnt(6)
    v_mfma_f32_16x16x32_bf16 v[80:83], v[32:35], v[216:219], v[80:83]
    ds_read_b64_tr_b16 v[232:233], v9 offset:9408
    v_mfma_f32_16x16x32_bf16 v[84:87], v[36:39], v[216:219], v[84:87]
    ds_read_b64_tr_b16 v[234:235], v9 offset:14016
    v_mfma_f32_16x16x32_bf16 v[88:91], v[40:43], v[216:219], v[88:91]
    v_mfma_f32_16x16x32_bf16 v[92:95], v[44:47], v[216:219], v[92:95]
    s_waitcnt lgkmcnt(6)
    v_mfma_f32_16x16x32_bf16 v[96:99], v[32:35], v[220:223], v[96:99]
    ds_read_b64_tr_b16 v[236:237], v9 offset:9440
    v_mfma_f32_16x16x32_bf16 v[100:103], v[36:39], v[220:223], v[100:103]
    ds_read_b64_tr_b16 v[238:239], v9 offset:14048
    v_mfma_f32_16x16x32_bf16 v[104:107], v[40:43], v[220:223], v[104:107]
    v_mfma_f32_16x16x32_bf16 v[108:111], v[44:47], v[220:223], v[108:111]
    s_waitcnt lgkmcnt(6)
    v_mfma_f32_16x16x32_bf16 v[112:115], v[32:35], v[224:227], v[112:115]
    ds_read_b64_tr_b16 v[240:241], v9 offset:9472
    v_mfma_f32_16x16x32_bf16 v[116:119], v[36:39], v[224:227], v[116:119]
    ds_read_b64_tr_b16 v[242:243], v9 offset:14080
    v_mfma_f32_16x16x32_bf16 v[120:123], v[40:43], v[224:227], v[120:123]
    v_mfma_f32_16x16x32_bf16 v[124:127], v[44:47], v[224:227], v[124:127]
    s_waitcnt lgkmcnt(0)
    s_barrier
    ds_read_b128 v[16:19], v5 offset:0
    ds_read_b128 v[20:23], v5 offset:2048
    ds_read_b128 v[24:27], v5 offset:4096
    ds_read_b128 v[28:31], v5 offset:6144
    ds_read_b64_tr_b16 v[208:209], v10 offset:0
    ds_read_b64_tr_b16 v[210:211], v10 offset:4608
    ds_read_b64_tr_b16 v[212:213], v10 offset:32
    ds_read_b64_tr_b16 v[214:215], v10 offset:4640
    ds_read_b64_tr_b16 v[216:217], v10 offset:64
    ds_read_b64_tr_b16 v[218:219], v10 offset:4672
    ds_read_b64_tr_b16 v[220:221], v10 offset:96
    ds_read_b64_tr_b16 v[222:223], v10 offset:4704
    v_mfma_f32_16x16x32_bf16 v[128:131], v[32:35], v[228:231], v[128:131]
    v_mfma_f32_16x16x32_bf16 v[132:135], v[36:39], v[228:231], v[132:135]
    v_mfma_f32_16x16x32_bf16 v[136:139], v[40:43], v[228:231], v[136:139]
    v_mfma_f32_16x16x32_bf16 v[140:143], v[44:47], v[228:231], v[140:143]
    v_mfma_f32_16x16x32_bf16 v[144:147], v[32:35], v[232:235], v[144:147]
    v_mfma_f32_16x16x32_bf16 v[148:151], v[36:39], v[232:235], v[148:151]
    v_mfma_f32_16x16x32_bf16 v[152:155], v[40:43], v[232:235], v[152:155]
    v_mfma_f32_16x16x32_bf16 v[156:159], v[44:47], v[232:235], v[156:159]
    v_mfma_f32_16x16x32_bf16 v[160:163], v[32:35], v[236:239], v[160:163]
    v_mfma_f32_16x16x32_bf16 v[164:167], v[36:39], v[236:239], v[164:167]
    v_mfma_f32_16x16x32_bf16 v[168:171], v[40:43], v[236:239], v[168:171]
    v_mfma_f32_16x16x32_bf16 v[172:175], v[44:47], v[236:239], v[172:175]
    v_mfma_f32_16x16x32_bf16 v[176:179], v[32:35], v[240:243], v[176:179]
    v_mfma_f32_16x16x32_bf16 v[180:183], v[36:39], v[240:243], v[180:183]
    v_mfma_f32_16x16x32_bf16 v[184:187], v[40:43], v[240:243], v[184:187]
    v_mfma_f32_16x16x32_bf16 v[188:191], v[44:47], v[240:243], v[188:191]
    s_waitcnt lgkmcnt(8)
    s_waitcnt lgkmcnt(6)
    v_mfma_f32_16x16x32_bf16 v[48:51], v[16:19], v[208:211], v[48:51]
    ds_read_b64_tr_b16 v[224:225], v10 offset:128
    v_mfma_f32_16x16x32_bf16 v[52:55], v[20:23], v[208:211], v[52:55]
    ds_read_b64_tr_b16 v[226:227], v10 offset:4736
    v_mfma_f32_16x16x32_bf16 v[56:59], v[24:27], v[208:211], v[56:59]
    v_mfma_f32_16x16x32_bf16 v[60:63], v[28:31], v[208:211], v[60:63]
    s_waitcnt lgkmcnt(6)
    v_mfma_f32_16x16x32_bf16 v[64:67], v[16:19], v[212:215], v[64:67]
    ds_read_b64_tr_b16 v[228:229], v10 offset:160
    v_mfma_f32_16x16x32_bf16 v[68:71], v[20:23], v[212:215], v[68:71]
    ds_read_b64_tr_b16 v[230:231], v10 offset:4768
    v_mfma_f32_16x16x32_bf16 v[72:75], v[24:27], v[212:215], v[72:75]
    v_mfma_f32_16x16x32_bf16 v[76:79], v[28:31], v[212:215], v[76:79]
    s_waitcnt lgkmcnt(6)
    v_mfma_f32_16x16x32_bf16 v[80:83], v[16:19], v[216:219], v[80:83]
    ds_read_b64_tr_b16 v[232:233], v10 offset:192
    v_mfma_f32_16x16x32_bf16 v[84:87], v[20:23], v[216:219], v[84:87]
    ds_read_b64_tr_b16 v[234:235], v10 offset:4800
    v_mfma_f32_16x16x32_bf16 v[88:91], v[24:27], v[216:219], v[88:91]
    ds_read_b128 v[32:35], v6 offset:0
    v_mfma_f32_16x16x32_bf16 v[92:95], v[28:31], v[216:219], v[92:95]
    s_waitcnt lgkmcnt(7)
    v_mfma_f32_16x16x32_bf16 v[96:99], v[16:19], v[220:223], v[96:99]
    ds_read_b64_tr_b16 v[236:237], v10 offset:224
    v_mfma_f32_16x16x32_bf16 v[100:103], v[20:23], v[220:223], v[100:103]
    ds_read_b64_tr_b16 v[238:239], v10 offset:4832
    v_mfma_f32_16x16x32_bf16 v[104:107], v[24:27], v[220:223], v[104:107]
    ds_read_b128 v[36:39], v6 offset:2048
    v_mfma_f32_16x16x32_bf16 v[108:111], v[28:31], v[220:223], v[108:111]
    s_waitcnt lgkmcnt(8)
    v_mfma_f32_16x16x32_bf16 v[112:115], v[16:19], v[224:227], v[112:115]
    ds_read_b64_tr_b16 v[240:241], v10 offset:256
    v_mfma_f32_16x16x32_bf16 v[116:119], v[20:23], v[224:227], v[116:119]
    ds_read_b64_tr_b16 v[242:243], v10 offset:4864
    v_mfma_f32_16x16x32_bf16 v[120:123], v[24:27], v[224:227], v[120:123]
    ds_read_b128 v[40:43], v6 offset:4096
    v_mfma_f32_16x16x32_bf16 v[124:127], v[28:31], v[224:227], v[124:127]
    s_waitcnt lgkmcnt(9)
    v_mfma_f32_16x16x32_bf16 v[128:131], v[16:19], v[228:231], v[128:131]
    ds_read_b64_tr_b16 v[208:209], v10 offset:9216
    v_mfma_f32_16x16x32_bf16 v[132:135], v[20:23], v[228:231], v[132:135]
    ds_read_b64_tr_b16 v[210:211], v10 offset:13824
    v_mfma_f32_16x16x32_bf16 v[136:139], v[24:27], v[228:231], v[136:139]
    ds_read_b128 v[44:47], v6 offset:6144
    v_mfma_f32_16x16x32_bf16 v[140:143], v[28:31], v[228:231], v[140:143]
    s_waitcnt lgkmcnt(10)
    v_mfma_f32_16x16x32_bf16 v[144:147], v[16:19], v[232:235], v[144:147]
    ds_read_b64_tr_b16 v[212:213], v10 offset:9248
    v_mfma_f32_16x16x32_bf16 v[148:151], v[20:23], v[232:235], v[148:151]
    ds_read_b64_tr_b16 v[214:215], v10 offset:13856
    v_mfma_f32_16x16x32_bf16 v[152:155], v[24:27], v[232:235], v[152:155]
    v_mfma_f32_16x16x32_bf16 v[156:159], v[28:31], v[232:235], v[156:159]
    s_waitcnt lgkmcnt(9)
    v_mfma_f32_16x16x32_bf16 v[160:163], v[16:19], v[236:239], v[160:163]
    ds_read_b64_tr_b16 v[216:217], v10 offset:9280
    v_mfma_f32_16x16x32_bf16 v[164:167], v[20:23], v[236:239], v[164:167]
    ds_read_b64_tr_b16 v[218:219], v10 offset:13888
    v_mfma_f32_16x16x32_bf16 v[168:171], v[24:27], v[236:239], v[168:171]
    v_mfma_f32_16x16x32_bf16 v[172:175], v[28:31], v[236:239], v[172:175]
    s_waitcnt lgkmcnt(8)
    v_mfma_f32_16x16x32_bf16 v[176:179], v[16:19], v[240:243], v[176:179]
    ds_read_b64_tr_b16 v[220:221], v10 offset:9312
    v_mfma_f32_16x16x32_bf16 v[180:183], v[20:23], v[240:243], v[180:183]
    ds_read_b64_tr_b16 v[222:223], v10 offset:13920
    v_mfma_f32_16x16x32_bf16 v[184:187], v[24:27], v[240:243], v[184:187]
    v_mfma_f32_16x16x32_bf16 v[188:191], v[28:31], v[240:243], v[188:191]
    s_waitcnt lgkmcnt(6)
    s_mul_i32 s58, s53, 3
    s_add_u32 s58, s58, 1
    s_cmp_lg_u32 s58, s66
    s_cbranch_scc1 L_k1_xf_17
    s_cmp_eq_u32 s67, 1
    s_cbranch_scc1 L_k1_xf1_18
    s_add_u32 s58, s68, 0
    buffer_store_dwordx4 v[16:19], v12, s[24:27], s58 offen sc1
    s_add_u32 s58, s68, 18432
    buffer_store_dwordx4 v[20:23], v12, s[24:27], s58 offen sc1
    s_add_u32 s58, s68, 36864
    buffer_store_dwordx4 v[24:27], v12, s[24:27], s58 offen sc1
    s_add_u32 s58, s68, 55296
    buffer_store_dwordx4 v[28:31], v12, s[24:27], s58 offen sc1
    s_branch L_k1_xf_17
L_k1_xf1_18:
    s_add_u32 s58, s68, 0
    buffer_store_dwordx4 v[32:35], v12, s[24:27], s58 offen sc1
    s_add_u32 s58, s68, 18432
    buffer_store_dwordx4 v[36:39], v12, s[24:27], s58 offen sc1
    s_add_u32 s58, s68, 36864
    buffer_store_dwordx4 v[40:43], v12, s[24:27], s58 offen sc1
    s_add_u32 s58, s68, 55296
    buffer_store_dwordx4 v[44:47], v12, s[24:27], s58 offen sc1
L_k1_xf_17:
    v_mfma_f32_16x16x32_bf16 v[48:51], v[32:35], v[208:211], v[48:51]
    ds_read_b64_tr_b16 v[224:225], v10 offset:9344
    v_mfma_f32_16x16x32_bf16 v[52:55], v[36:39], v[208:211], v[52:55]
    ds_read_b64_tr_b16 v[226:227], v10 offset:13952
    v_mfma_f32_16x16x32_bf16 v[56:59], v[40:43], v[208:211], v[56:59]
    v_mfma_f32_16x16x32_bf16 v[60:63], v[44:47], v[208:211], v[60:63]
    s_waitcnt lgkmcnt(6)
    v_mfma_f32_16x16x32_bf16 v[64:67], v[32:35], v[212:215], v[64:67]
    ds_read_b64_tr_b16 v[228:229], v10 offset:9376
    v_mfma_f32_16x16x32_bf16 v[68:71], v[36:39], v[212:215], v[68:71]
    ds_read_b64_tr_b16 v[230:231], v10 offset:13984
    v_mfma_f32_16x16x32_bf16 v[72:75], v[40:43], v[212:215], v[72:75]
    v_mfma_f32_16x16x32_bf16 v[76:79], v[44:47], v[212:215], v[76:79]
    s_waitcnt lgkmcnt(6)
    v_mfma_f32_16x16x32_bf16 v[80:83], v[32:35], v[216:219], v[80:83]
    ds_read_b64_tr_b16 v[232:233], v10 offset:9408
    v_mfma_f32_16x16x32_bf16 v[84:87], v[36:39], v[216:219], v[84:87]
    ds_read_b64_tr_b16 v[234:235], v10 offset:14016
    v_mfma_f32_16x16x32_bf16 v[88:91], v[40:43], v[216:219], v[88:91]
    v_mfma_f32_16x16x32_bf16 v[92:95], v[44:47], v[216:219], v[92:95]
    s_waitcnt lgkmcnt(6)
    v_mfma_f32_16x16x32_bf16 v[96:99], v[32:35], v[220:223], v[96:99]
    ds_read_b64_tr_b16 v[236:237], v10 offset:9440
    v_mfma_f32_16x16x32_bf16 v[100:103], v[36:39], v[220:223], v[100:103]
    ds_read_b64_tr_b16 v[238:239], v10 offset:14048
    v_mfma_f32_16x16x32_bf16 v[104:107], v[40:43], v[220:223], v[104:107]
    v_mfma_f32_16x16x32_bf16 v[108:111], v[44:47], v[220:223], v[108:111]
    s_waitcnt lgkmcnt(6)
    v_mfma_f32_16x16x32_bf16 v[112:115], v[32:35], v[224:227], v[112:115]
    ds_read_b64_tr_b16 v[240:241], v10 offset:9472
    v_mfma_f32_16x16x32_bf16 v[116:119], v[36:39], v[224:227], v[116:119]
    ds_read_b64_tr_b16 v[242:243], v10 offset:14080
    v_mfma_f32_16x16x32_bf16 v[120:123], v[40:43], v[224:227], v[120:123]
    v_mfma_f32_16x16x32_bf16 v[124:127], v[44:47], v[224:227], v[124:127]
    s_waitcnt lgkmcnt(0)
    s_barrier
    ds_read_b128 v[16:19], v7 offset:0
    ds_read_b128 v[20:23], v7 offset:2048
    ds_read_b128 v[24:27], v7 offset:4096
    ds_read_b128 v[28:31], v7 offset:6144
    ds_read_b64_tr_b16 v[208:209], v11 offset:0
    ds_read_b64_tr_b16 v[210:211], v11 offset:4608
    ds_read_b64_tr_b16 v[212:213], v11 offset:32
    ds_read_b64_tr_b16 v[214:215], v11 offset:4640
    ds_read_b64_tr_b16 v[216:217], v11 offset:64
    ds_read_b64_tr_b16 v[218:219], v11 offset:4672
    ds_read_b64_tr_b16 v[220:221], v11 offset:96
    ds_read_b64_tr_b16 v[222:223], v11 offset:4704
    v_mfma_f32_16x16x32_bf16 v[128:131], v[32:35], v[228:231], v[128:131]
    v_mfma_f32_16x16x32_bf16 v[132:135], v[36:39], v[228:231], v[132:135]
    v_mfma_f32_16x16x32_bf16 v[136:139], v[40:43], v[228:231], v[136:139]
    v_mfma_f32_16x16x32_bf16 v[140:143], v[44:47], v[228:231], v[140:143]
    v_mfma_f32_16x16x32_bf16 v[144:147], v[32:35], v[232:235], v[144:147]
    v_mfma_f32_16x16x32_bf16 v[148:151], v[36:39], v[232:235], v[148:151]
    v_mfma_f32_16x16x32_bf16 v[152:155], v[40:43], v[232:235], v[152:155]
    v_mfma_f32_16x16x32_bf16 v[156:159], v[44:47], v[232:235], v[156:159]
    v_mfma_f32_16x16x32_bf16 v[160:163], v[32:35], v[236:239], v[160:163]
    v_mfma_f32_16x16x32_bf16 v[164:167], v[36:39], v[236:239], v[164:167]
    v_mfma_f32_16x16x32_bf16 v[168:171], v[40:43], v[236:239], v[168:171]
    v_mfma_f32_16x16x32_bf16 v[172:175], v[44:47], v[236:239], v[172:175]
    v_mfma_f32_16x16x32_bf16 v[176:179], v[32:35], v[240:243], v[176:179]
    v_mfma_f32_16x16x32_bf16 v[180:183], v[36:39], v[240:243], v[180:183]
    v_mfma_f32_16x16x32_bf16 v[184:187], v[40:43], v[240:243], v[184:187]
    v_mfma_f32_16x16x32_bf16 v[188:191], v[44:47], v[240:243], v[188:191]
    s_waitcnt lgkmcnt(8)
    s_waitcnt lgkmcnt(6)
    v_mfma_f32_16x16x32_bf16 v[48:51], v[16:19], v[208:211], v[48:51]
    ds_read_b64_tr_b16 v[224:225], v11 offset:128
    v_mfma_f32_16x16x32_bf16 v[52:55], v[20:23], v[208:211], v[52:55]
    ds_read_b64_tr_b16 v[226:227], v11 offset:4736
    v_mfma_f32_16x16x32_bf16 v[56:59], v[24:27], v[208:211], v[56:59]
    v_mfma_f32_16x16x32_bf16 v[60:63], v[28:31], v[208:211], v[60:63]
    s_waitcnt lgkmcnt(6)
    v_mfma_f32_16x16x32_bf16 v[64:67], v[16:19], v[212:215], v[64:67]
    ds_read_b64_tr_b16 v[228:229], v11 offset:160
    v_mfma_f32_16x16x32_bf16 v[68:71], v[20:23], v[212:215], v[68:71]
    ds_read_b64_tr_b16 v[230:231], v11 offset:4768
    v_mfma_f32_16x16x32_bf16 v[72:75], v[24:27], v[212:215], v[72:75]
    v_mfma_f32_16x16x32_bf16 v[76:79], v[28:31], v[212:215], v[76:79]
    s_waitcnt lgkmcnt(6)
    v_mfma_f32_16x16x32_bf16 v[80:83], v[16:19], v[216:219], v[80:83]
    ds_read_b64_tr_b16 v[232:233], v11 offset:192
    v_mfma_f32_16x16x32_bf16 v[84:87], v[20:23], v[216:219], v[84:87]
    ds_read_b64_tr_b16 v[234:235], v11 offset:4800
    v_mfma_f32_16x16x32_bf16 v[88:91], v[24:27], v[216:219], v[88:91]
    ds_read_b128 v[32:35], v8 offset:0
    v_mfma_f32_16x16x32_bf16 v[92:95], v[28:31], v[216:219], v[92:95]
    s_waitcnt lgkmcnt(7)
    v_mfma_f32_16x16x32_bf16 v[96:99], v[16:19], v[220:223], v[96:99]
    ds_read_b64_tr_b16 v[236:237], v11 offset:224
    v_mfma_f32_16x16x32_bf16 v[100:103], v[20:23], v[220:223], v[100:103]
    ds_read_b64_tr_b16 v[238:239], v11 offset:4832
    v_mfma_f32_16x16x32_bf16 v[104:107], v[24:27], v[220:223], v[104:107]
    ds_read_b128 v[36:39], v8 offset:2048
    v_mfma_f32_16x16x32_bf16 v[108:111], v[28:31], v[220:223], v[108:111]
    s_waitcnt lgkmcnt(8)
    v_mfma_f32_16x16x32_bf16 v[112:115], v[16:19], v[224:227], v[112:115]
    ds_read_b64_tr_b16 v[240:241], v11 offset:256
    v_mfma_f32_16x16x32_bf16 v[116:119], v[20:23], v[224:227], v[116:119]
    ds_read_b64_tr_b16 v[242:243], v11 offset:4864
    v_mfma_f32_16x16x32_bf16 v[120:123], v[24:27], v[224:227], v[120:123]
    ds_read_b128 v[40:43], v8 offset:4096
    v_mfma_f32_16x16x32_bf16 v[124:127], v[28:31], v[224:227], v[124:127]
    s_waitcnt lgkmcnt(9)
    v_mfma_f32_16x16x32_bf16 v[128:131], v[16:19], v[228:231], v[128:131]
    ds_read_b64_tr_b16 v[208:209], v11 offset:9216
    v_mfma_f32_16x16x32_bf16 v[132:135], v[20:23], v[228:231], v[132:135]
    ds_read_b64_tr_b16 v[210:211], v11 offset:13824
    v_mfma_f32_16x16x32_bf16 v[136:139], v[24:27], v[228:231], v[136:139]
    ds_read_b128 v[44:47], v8 offset:6144
    v_mfma_f32_16x16x32_bf16 v[140:143], v[28:31], v[228:231], v[140:143]
    s_waitcnt lgkmcnt(10)
    v_mfma_f32_16x16x32_bf16 v[144:147], v[16:19], v[232:235], v[144:147]
    ds_read_b64_tr_b16 v[212:213], v11 offset:9248
    v_mfma_f32_16x16x32_bf16 v[148:151], v[20:23], v[232:235], v[148:151]
    ds_read_b64_tr_b16 v[214:215], v11 offset:13856
    v_mfma_f32_16x16x32_bf16 v[152:155], v[24:27], v[232:235], v[152:155]
    v_mfma_f32_16x16x32_bf16 v[156:159], v[28:31], v[232:235], v[156:159]
    s_waitcnt lgkmcnt(9)
    v_mfma_f32_16x16x32_bf16 v[160:163], v[16:19], v[236:239], v[160:163]
    ds_read_b64_tr_b16 v[216:217], v11 offset:9280
    v_mfma_f32_16x16x32_bf16 v[164:167], v[20:23], v[236:239], v[164:167]
    ds_read_b64_tr_b16 v[218:219], v11 offset:13888
    v_mfma_f32_16x16x32_bf16 v[168:171], v[24:27], v[236:239], v[168:171]
    v_mfma_f32_16x16x32_bf16 v[172:175], v[28:31], v[236:239], v[172:175]
    s_waitcnt lgkmcnt(8)
    v_mfma_f32_16x16x32_bf16 v[176:179], v[16:19], v[240:243], v[176:179]
    ds_read_b64_tr_b16 v[220:221], v11 offset:9312
    v_mfma_f32_16x16x32_bf16 v[180:183], v[20:23], v[240:243], v[180:183]
    ds_read_b64_tr_b16 v[222:223], v11 offset:13920
    v_mfma_f32_16x16x32_bf16 v[184:187], v[24:27], v[240:243], v[184:187]
    v_mfma_f32_16x16x32_bf16 v[188:191], v[28:31], v[240:243], v[188:191]
    s_waitcnt lgkmcnt(6)
    s_mul_i32 s58, s53, 3
    s_add_u32 s58, s58, 2
    s_cmp_lg_u32 s58, s66
    s_cbranch_scc1 L_k1_xf_19
    s_cmp_eq_u32 s67, 1
    s_cbranch_scc1 L_k1_xf1_20
    s_add_u32 s58, s68, 0
    buffer_store_dwordx4 v[16:19], v12, s[24:27], s58 offen sc1
    s_add_u32 s58, s68, 18432
    buffer_store_dwordx4 v[20:23], v12, s[24:27], s58 offen sc1
    s_add_u32 s58, s68, 36864
    buffer_store_dwordx4 v[24:27], v12, s[24:27], s58 offen sc1
    s_add_u32 s58, s68, 55296
    buffer_store_dwordx4 v[28:31], v12, s[24:27], s58 offen sc1
    s_branch L_k1_xf_19
L_k1_xf1_20:
    s_add_u32 s58, s68, 0
    buffer_store_dwordx4 v[32:35], v12, s[24:27], s58 offen sc1
    s_add_u32 s58, s68, 18432
    buffer_store_dwordx4 v[36:39], v12, s[24:27], s58 offen sc1
    s_add_u32 s58, s68, 36864
    buffer_store_dwordx4 v[40:43], v12, s[24:27], s58 offen sc1
    s_add_u32 s58, s68, 55296
    buffer_store_dwordx4 v[44:47], v12, s[24:27], s58 offen sc1
L_k1_xf_19:
    v_mfma_f32_16x16x32_bf16 v[48:51], v[32:35], v[208:211], v[48:51]
    ds_read_b64_tr_b16 v[224:225], v11 offset:9344
    v_mfma_f32_16x16x32_bf16 v[52:55], v[36:39], v[208:211], v[52:55]
    ds_read_b64_tr_b16 v[226:227], v11 offset:13952
    v_mfma_f32_16x16x32_bf16 v[56:59], v[40:43], v[208:211], v[56:59]
    v_mfma_f32_16x16x32_bf16 v[60:63], v[44:47], v[208:211], v[60:63]
    s_waitcnt lgkmcnt(6)
    v_mfma_f32_16x16x32_bf16 v[64:67], v[32:35], v[212:215], v[64:67]
    ds_read_b64_tr_b16 v[228:229], v11 offset:9376
    v_mfma_f32_16x16x32_bf16 v[68:71], v[36:39], v[212:215], v[68:71]
    ds_read_b64_tr_b16 v[230:231], v11 offset:13984
    v_mfma_f32_16x16x32_bf16 v[72:75], v[40:43], v[212:215], v[72:75]
    v_mfma_f32_16x16x32_bf16 v[76:79], v[44:47], v[212:215], v[76:79]
    s_waitcnt lgkmcnt(6)
    v_mfma_f32_16x16x32_bf16 v[80:83], v[32:35], v[216:219], v[80:83]
    ds_read_b64_tr_b16 v[232:233], v11 offset:9408
    v_mfma_f32_16x16x32_bf16 v[84:87], v[36:39], v[216:219], v[84:87]
    ds_read_b64_tr_b16 v[234:235], v11 offset:14016
    v_mfma_f32_16x16x32_bf16 v[88:91], v[40:43], v[216:219], v[88:91]
    v_mfma_f32_16x16x32_bf16 v[92:95], v[44:47], v[216:219], v[92:95]
    s_waitcnt lgkmcnt(6)
    v_mfma_f32_16x16x32_bf16 v[96:99], v[32:35], v[220:223], v[96:99]
    ds_read_b64_tr_b16 v[236:237], v11 offset:9440
    v_mfma_f32_16x16x32_bf16 v[100:103], v[36:39], v[220:223], v[100:103]
    ds_read_b64_tr_b16 v[238:239], v11 offset:14048
    v_mfma_f32_16x16x32_bf16 v[104:107], v[40:43], v[220:223], v[104:107]
    v_mfma_f32_16x16x32_bf16 v[108:111], v[44:47], v[220:223], v[108:111]
    s_waitcnt lgkmcnt(6)
    v_mfma_f32_16x16x32_bf16 v[112:115], v[32:35], v[224:227], v[112:115]
    ds_read_b64_tr_b16 v[240:241], v11 offset:9472
    v_mfma_f32_16x16x32_bf16 v[116:119], v[36:39], v[224:227], v[116:119]
    ds_read_b64_tr_b16 v[242:243], v11 offset:14080
    v_mfma_f32_16x16x32_bf16 v[120:123], v[40:43], v[224:227], v[120:123]
    v_mfma_f32_16x16x32_bf16 v[124:127], v[44:47], v[224:227], v[124:127]
    s_waitcnt lgkmcnt(0)
    s_cmp_eq_u32 s53, 2
    s_cbranch_scc1 L_k1_last_21
    s_barrier
    ds_read_b128 v[16:19], v3 offset:0
    ds_read_b128 v[20:23], v3 offset:2048
    ds_read_b128 v[24:27], v3 offset:4096
    ds_read_b128 v[28:31], v3 offset:6144
    ds_read_b64_tr_b16 v[208:209], v9 offset:0
    ds_read_b64_tr_b16 v[210:211], v9 offset:4608
    ds_read_b64_tr_b16 v[212:213], v9 offset:32
    ds_read_b64_tr_b16 v[214:215], v9 offset:4640
    ds_read_b64_tr_b16 v[216:217], v9 offset:64
    ds_read_b64_tr_b16 v[218:219], v9 offset:4672
    ds_read_b64_tr_b16 v[220:221], v9 offset:96
    ds_read_b64_tr_b16 v[222:223], v9 offset:4704
L_k1_last_21:
    v_mfma_f32_16x16x32_bf16 v[128:131], v[32:35], v[228:231], v[128:131]
    v_mfma_f32_16x16x32_bf16 v[132:135], v[36:39], v[228:231], v[132:135]
    v_mfma_f32_16x16x32_bf16 v[136:139], v[40:43], v[228:231], v[136:139]
    v_mfma_f32_16x16x32_bf16 v[140:143], v[44:47], v[228:231], v[140:143]
    v_mfma_f32_16x16x32_bf16 v[144:147], v[32:35], v[232:235], v[144:147]
    v_mfma_f32_16x16x32_bf16 v[148:151], v[36:39], v[232:235], v[148:151]
    v_mfma_f32_16x16x32_bf16 v[152:155], v[40:43], v[232:235], v[152:155]
    v_mfma_f32_16x16x32_bf16 v[156:159], v[44:47], v[232:235], v[156:159]
    v_mfma_f32_16x16x32_bf16 v[160:163], v[32:35], v[236:239], v[160:163]
    v_mfma_f32_16x16x32_bf16 v[164:167], v[36:39], v[236:239], v[164:167]
    v_mfma_f32_16x16x32_bf16 v[168:171], v[40:43], v[236:239], v[168:171]
    v_mfma_f32_16x16x32_bf16 v[172:175], v[44:47], v[236:239], v[172:175]
    v_mfma_f32_16x16x32_bf16 v[176:179], v[32:35], v[240:243], v[176:179]
    v_mfma_f32_16x16x32_bf16 v[180:183], v[36:39], v[240:243], v[180:183]
    v_mfma_f32_16x16x32_bf16 v[184:187], v[40:43], v[240:243], v[184:187]
    v_mfma_f32_16x16x32_bf16 v[188:191], v[44:47], v[240:243], v[188:191]
    s_waitcnt lgkmcnt(8)
    s_waitcnt lgkmcnt(6)
    s_add_u32 s53, s53, 1
    s_cmp_lt_u32 s53, 3
    s_cbranch_scc1 L_k1_loop_v
    s_sub_u32 s58, s38, 8
    s_lshl_b32 s58, s58, 3
    s_mul_i32 s61, s58, 155648
    s_lshl_b32 s59, s37, 3
    s_lshl_b32 s58, s36, 1
    s_add_u32 s59, s59, s58
    s_mul_i32 s59, s59, 2432
    s_add_u32 s61, s61, s59
    s_add_u32 s61, s61, 1152
    s_add_u32 s63, s61, 2432
    v_and_b32 v10, 15, v2
    v_lshrrev_b32 v11, 4, v2
    v_mul_u32_u24 v11, 304, v11
    s_mov_b32 s62, 155648
    v_add_u32 v12, 0, v10
    v_mul_u32_u24 v13, 57, v12
    v_lshrrev_b32 v13, 10, v13
    v_mul_u32_u24 v14, 18, v13
    v_sub_u32 v14, v12, v14
    v_mul_lo_u32 v13, v13, s62
    v_lshl_add_u32 v13, v14, 4, v13
    v_add_u32 v13, v13, v11
    v_cvt_pk_bf16_f32 v208, v48, v49
    v_cvt_pk_bf16_f32 v209, v50, v51
    v_cvt_pk_bf16_f32 v210, v52, v53
    v_cvt_pk_bf16_f32 v211, v54, v55
    buffer_store_dwordx4 v[208:211], v13, s[24:27], s61 offen
    v_cvt_pk_bf16_f32 v212, v56, v57
    v_cvt_pk_bf16_f32 v213, v58, v59
    v_cvt_pk_bf16_f32 v214, v60, v61
    v_cvt_pk_bf16_f32 v215, v62, v63
    buffer_store_dwordx4 v[212:215], v13, s[24:27], s63 offen
    v_add_u32 v12, 16, v10
    v_mul_u32_u24 v13, 57, v12
    v_lshrrev_b32 v13, 10, v13
    v_mul_u32_u24 v14, 18, v13
    v_sub_u32 v14, v12, v14
    v_mul_lo_u32 v13, v13, s62
    v_lshl_add_u32 v13, v14, 4, v13
    v_add_u32 v13, v13, v11
    v_cvt_pk_bf16_f32 v216, v64, v65
    v_cvt_pk_bf16_f32 v217, v66, v67
    v_cvt_pk_bf16_f32 v218, v68, v69
    v_cvt_pk_bf16_f32 v219, v70, v71
    buffer_store_dwordx4 v[216:219], v13, s[24:27], s61 offen
    v_cvt_pk_bf16_f32 v220, v72, v73
    v_cvt_pk_bf16_f32 v221, v74, v75
    v_cvt_pk_bf16_f32 v222, v76, v77
    v_cvt_pk_bf16_f32 v223, v78, v79
    buffer_store_dwordx4 v[220:223], v13, s[24:27], s63 offen
    v_add_u32 v12, 32, v10
    v_mul_u32_u24 v13, 57, v12
    v_lshrrev_b32 v13, 10, v13
    v_mul_u32_u24 v14, 18, v13
    v_sub_u32 v14, v12, v14
    v_mul_lo_u32 v13, v13, s62
    v_lshl_add_u32 v13, v14, 4, v13
    v_add_u32 v13, v13, v11
    v_cvt_pk_bf16_f32 v224, v80, v81
    v_cvt_pk_bf16_f32 v225, v82, v83
    v_cvt_pk_bf16_f32 v226, v84, v85
    v_cvt_pk_bf16_f32 v227, v86, v87
    buffer_store_dwordx4 v[224:227], v13, s[24:27], s61 offen
    v_cvt_pk_bf16_f32 v228, v88, v89
    v_cvt_pk_bf16_f32 v229, v90, v91
    v_cvt_pk_bf16_f32 v230, v92, v93
    v_cvt_pk_bf16_f32 v231, v94, v95
    buffer_store_dwordx4 v[228:231], v13, s[24:27], s63 offen
    v_add_u32 v12, 48, v10
    v_mul_u32_u24 v13, 57, v12
    v_lshrrev_b32 v13, 10, v13
    v_mul_u32_u24 v14, 18, v13
    v_sub_u32 v14, v12, v14
    v_mul_lo_u32 v13, v13, s62
    v_lshl_add_u32 v13, v14, 4, v13
    v_add_u32 v13, v13, v11
    v_cvt_pk_bf16_f32 v232, v96, v97
    v_cvt_pk_bf16_f32 v233, v98, v99
    v_cvt_pk_bf16_f32 v234, v100, v101
    v_cvt_pk_bf16_f32 v235, v102, v103
    buffer_store_dwordx4 v[232:235], v13, s[24:27], s61 offen
    v_cvt_pk_bf16_f32 v236, v104, v105
    v_cvt_pk_bf16_f32 v237, v106, v107
    v_cvt_pk_bf16_f32 v238, v108, v109
    v_cvt_pk_bf16_f32 v239, v110, v111
    buffer_store_dwordx4 v[236:239], v13, s[24:27], s63 offen
    v_add_u32 v12, 64, v10
    v_mul_u32_u24 v13, 57, v12
    v_lshrrev_b32 v13, 10, v13
    v_mul_u32_u24 v14, 18, v13
    v_sub_u32 v14, v12, v14
    v_mul_lo_u32 v13, v13, s62
    v_lshl_add_u32 v13, v14, 4, v13
    v_add_u32 v13, v13, v11
    v_cvt_pk_bf16_f32 v208, v112, v113
    v_cvt_pk_bf16_f32 v209, v114, v115
    v_cvt_pk_bf16_f32 v210, v116, v117
    v_cvt_pk_bf16_f32 v211, v118, v119
    buffer_store_dwordx4 v[208:211], v13, s[24:27], s61 offen
    v_cvt_pk_bf16_f32 v212, v120, v121
    v_cvt_pk_bf16_f32 v213, v122, v123
    v_cvt_pk_bf16_f32 v214, v124, v125
    v_cvt_pk_bf16_f32 v215, v126, v127
    buffer_store_dwordx4 v[212:215], v13, s[24:27], s63 offen
    v_add_u32 v12, 80, v10
    v_mul_u32_u24 v13, 57, v12
    v_lshrrev_b32 v13, 10, v13
    v_mul_u32_u24 v14, 18, v13
    v_sub_u32 v14, v12, v14
    v_mul_lo_u32 v13, v13, s62
    v_lshl_add_u32 v13, v14, 4, v13
    v_add_u32 v13, v13, v11
    v_cvt_pk_bf16_f32 v216, v128, v129
    v_cvt_pk_bf16_f32 v217, v130, v131
    v_cvt_pk_bf16_f32 v218, v132, v133
    v_cvt_pk_bf16_f32 v219, v134, v135
    buffer_store_dwordx4 v[216:219], v13, s[24:27], s61 offen
    v_cvt_pk_bf16_f32 v220, v136, v137
    v_cvt_pk_bf16_f32 v221, v138, v139
    v_cvt_pk_bf16_f32 v222, v140, v141
    v_cvt_pk_bf16_f32 v223, v142, v143
    buffer_store_dwordx4 v[220:223], v13, s[24:27], s63 offen
    v_add_u32 v12, 96, v10
    v_mul_u32_u24 v13, 57, v12
    v_lshrrev_b32 v13, 10, v13
    v_mul_u32_u24 v14, 18, v13
    v_sub_u32 v14, v12, v14
    v_mul_lo_u32 v13, v13, s62
    v_lshl_add_u32 v13, v14, 4, v13
    v_add_u32 v13, v13, v11
    v_cvt_pk_bf16_f32 v224, v144, v145
    v_cvt_pk_bf16_f32 v225, v146, v147
    v_cvt_pk_bf16_f32 v226, v148, v149
    v_cvt_pk_bf16_f32 v227, v150, v151
    buffer_store_dwordx4 v[224:227], v13, s[24:27], s61 offen
    v_cvt_pk_bf16_f32 v228, v152, v153
    v_cvt_pk_bf16_f32 v229, v154, v155
    v_cvt_pk_bf16_f32 v230, v156, v157
    v_cvt_pk_bf16_f32 v231, v158, v159
    buffer_store_dwordx4 v[228:231], v13, s[24:27], s63 offen
    v_add_u32 v12, 112, v10
    v_mul_u32_u24 v13, 57, v12
    v_lshrrev_b32 v13, 10, v13
    v_mul_u32_u24 v14, 18, v13
    v_sub_u32 v14, v12, v14
    v_mul_lo_u32 v13, v13, s62
    v_lshl_add_u32 v13, v14, 4, v13
    v_add_u32 v13, v13, v11
    v_cvt_pk_bf16_f32 v232, v160, v161
    v_cvt_pk_bf16_f32 v233, v162, v163
    v_cvt_pk_bf16_f32 v234, v164, v165
    v_cvt_pk_bf16_f32 v235, v166, v167
    buffer_store_dwordx4 v[232:235], v13, s[24:27], s61 offen
    v_cvt_pk_bf16_f32 v236, v168, v169
    v_cvt_pk_bf16_f32 v237, v170, v171
    v_cvt_pk_bf16_f32 v238, v172, v173
    v_cvt_pk_bf16_f32 v239, v174, v175
    buffer_store_dwordx4 v[236:239], v13, s[24:27], s63 offen
    v_add_u32 v12, 128, v10
    v_mul_u32_u24 v13, 57, v12
    v_lshrrev_b32 v13, 10, v13
    v_mul_u32_u24 v14, 18, v13
    v_sub_u32 v14, v12, v14
    v_mul_lo_u32 v13, v13, s62
    v_lshl_add_u32 v13, v14, 4, v13
    v_add_u32 v13, v13, v11
    v_cvt_pk_bf16_f32 v208, v176, v177
    v_cvt_pk_bf16_f32 v209, v178, v179
    v_cvt_pk_bf16_f32 v210, v180, v181
    v_cvt_pk_bf16_f32 v211, v182, v183
    buffer_store_dwordx4 v[208:211], v13, s[24:27], s61 offen
    v_cvt_pk_bf16_f32 v212, v184, v185
    v_cvt_pk_bf16_f32 v213, v186, v187
    v_cvt_pk_bf16_f32 v214, v188, v189
    v_cvt_pk_bf16_f32 v215, v190, v191
    buffer_store_dwordx4 v[212:215], v13, s[24:27], s63 offen
    v_lshrrev_b32 v12, 2, v2
    v_and_b32 v12, 7, v12
    v_mul_lo_u32 v12, v12, s62
    v_and_b32 v13, 3, v2
    v_mul_u32_u24 v13, 304, v13
    v_add_u32 v12, v12, v13
    v_add_u32 v12, 288, v12
    v_lshrrev_b32 v13, 5, v2
    v_mul_u32_u24 v13, 2432, v13
    v_add_u32 v12, v12, v13
    v_mov_b32 v20, 0x3f803f80
    v_mov_b32 v21, 0x3f803f80
    v_mov_b32 v22, 0x3f803f80
    v_mov_b32 v23, 0x3f803f80
    buffer_store_dwordx4 v[20:23], v12, s[24:27], s61 offen
    v_lshrrev_b32 v12, 2, v2
    v_and_b32 v12, 7, v12
    v_mul_lo_u32 v12, v12, s62
    v_and_b32 v13, 3, v2
    v_lshl_add_u32 v12, v13, 4, v12
    v_add_u32 v12, 1216, v12
    v_lshrrev_b32 v13, 5, v2
    v_mul_u32_u24 v13, 2432, v13
    v_add_u32 v12, v12, v13
    buffer_store_dwordx4 v[20:23], v12, s[24:27], s61 offen
    s_branch L_k1_fin
L_k1_spare:
    s_sub_u32 s41, s41, 28
    s_lshl_b32 s42, s40, 2
    s_add_u32 s42, s42, s41
    s_getpc_b64 s[60:61]
L_k1_pc:
    s_lshl_b32 s44, s41, 3
    s_add_u32 s44, s44, s36
    s_lshl_b32 s44, s44, 10
    v_lshl_add_u32 v24, v2, 4, s44
    s_add_u32 s62, s60, k1_kernel-L_k1_pc
    s_addc_u32 s63, s61, -1
    s_cmp_lt_u32 s44, L_k1_codeend-k1_kernel-1023
    s_cbranch_scc0 L_k1_cp1
    global_load_dwordx4 v[32:35], v24, s[62:63]
L_k1_cp1:
    s_add_u32 s60, s60, k2_kernel-L_k1_pc
    s_addc_u32 s61, s61, 0
    s_cmp_lt_u32 s44, L_k2_codeend-k2_kernel-1023
    s_cbranch_scc0 L_k1_cp2
    global_load_dwordx4 v[36:39], v24, s[60:61]
L_k1_cp2:
    s_add_u32 s44, s44, 32768
    s_cmp_lt_u32 s44, L_k2_codeend-k2_kernel-1023
    s_cbranch_scc0 L_k1_cp3
    v_add_u32 v24, 32768, v24
    global_load_dwordx4 v[40:43], v24, s[60:61]
L_k1_cp3:
    s_lshl_b32 s46, s42, 3
    s_add_u32 s46, s46, s36
    s_cmp_lg_u32 s46, 4
    s_cbranch_scc1 L_k1_nz
    v_lshlrev_b32 v10, 8, v2
    v_mov_b32 v11, 0
    s_mov_b32 s43, 55312384
    buffer_store_dword v11, v10, s[24:27], s43 offen
L_k1_nz:
    s_mov_b32 s16, s4
    s_and_b32 s17, s5, 0xffff
    s_mov_b32 s18, 0x240000
    s_mov_b32 s19, 0x20000
    s_mov_b32 s32, s14
    s_and_b32 s33, s15, 0xffff
    s_mov_b32 s34, 0x480
    s_mov_b32 s35, 0x20000
    s_mov_b32 s56, s10
    s_and_b32 s57, s11, 0xffff
    s_mov_b32 s58, 0x510000
    s_mov_b32 s59, 0x20000
    s_mov_b32 s28, s12
    s_and_b32 s29, s13, 0xffff
    s_mov_b32 s30, 0x800000
    s_mov_b32 s31, 0x20000
    v_lshrrev_b32 v10, 3, v2
    v_and_b32 v11, 7, v2
    v_lshlrev_b32 v22, 4, v11
    s_lshl_b32 s43, s46, 3
    v_add_u32 v15, s43, v10
    v_mul_u32_u24 v13, 1152, v15
    v_lshl_add_u32 v21, v11, 4, v13
    v_lshlrev_b32 v24, 4, v2
    buffer_load_dwordx4 v[100:103], v21, s[16:19], 0 offen offset:0
    buffer_load_dwordx4 v[104:107], v21, s[16:19], 0 offen offset:128
    buffer_load_dwordx4 v[108:111], v21, s[16:19], 0 offen offset:256
    buffer_load_dwordx4 v[112:115], v21, s[16:19], 0 offen offset:384
    buffer_load_dwordx4 v[116:119], v21, s[16:19], 0 offen offset:512
    buffer_load_dwordx4 v[120:123], v21, s[16:19], 0 offen offset:640
    buffer_load_dwordx4 v[124:127], v21, s[16:19], 0 offen offset:768
    buffer_load_dwordx4 v[128:131], v21, s[16:19], 0 offen offset:896
    buffer_load_dwordx4 v[132:135], v21, s[16:19], 0 offen offset:1024
    buffer_load_dwordx4 v[140:143], v22, s[32:35], 0 offen offset:0
    buffer_load_dwordx4 v[144:147], v22, s[32:35], 0 offen offset:128
    buffer_load_dwordx4 v[148:151], v22, s[32:35], 0 offen offset:256
    buffer_load_dwordx4 v[152:155], v22, s[32:35], 0 offen offset:384
    buffer_load_dwordx4 v[156:159], v22, s[32:35], 0 offen offset:512
    buffer_load_dwordx4 v[160:163], v22, s[32:35], 0 offen offset:640
    buffer_load_dwordx4 v[164:167], v22, s[32:35], 0 offen offset:768
    buffer_load_dwordx4 v[168:171], v22, s[32:35], 0 offen offset:896
    buffer_load_dwordx4 v[172:175], v22, s[32:35], 0 offen offset:1024
    v_bfe_u32 v12, v10, 1, 2
    v_lshlrev_b32 v12, 1, v12
    v_xor_b32 v12, v11, v12
    v_lshlrev_b32 v12, 4, v12
    v_lshrrev_b32 v13, 2, v10
    v_lshlrev_b32 v13, 3, v13
    v_and_b32 v14, 3, v10
    v_add_u32 v13, v13, v14
    v_mul_u32_u24 v13, 9216, v13
    v_add_u32 v14, v13, v12
    s_mul_i32 s47, s36, 12288
    s_add_u32 s44, s46, 0
    s_min_u32 s44, s44, 647
    s_mul_i32 s45, s44, 1821
    s_lshr_b32 s45, s45, 16
    s_mul_i32 s68, s45, 36
    s_sub_u32 s68, s44, s68
    s_mul_i32 s69, s45, 294912
    s_lshl_b32 s70, s68, 7
    s_add_u32 s69, s69, s70
    s_mul_i32 s70, s68, 73728
    s_lshl_b32 s45, s45, 10
    s_add_u32 s70, s70, s45
    s_add_u32 s72, s70, 60817408
    s_add_u32 m0, s47, 0
    s_add_u32 s70, s69, 0
    buffer_load_dwordx4 v14, s[56:59], s70 offen lds
    s_add_u32 m0, s47, 1024
    s_add_u32 s70, s69, 147456
    buffer_load_dwordx4 v14, s[56:59], s70 offen lds
    s_add_u32 m0, s47, 2048
    s_add_u32 s70, s69, 36864
    buffer_load_dwordx4 v14, s[56:59], s70 offen lds
    s_add_u32 m0, s47, 3072
    s_add_u32 s70, s69, 184320
    buffer_load_dwordx4 v14, s[56:59], s70 offen lds
    s_add_u32 s44, s46, 256
    s_min_u32 s44, s44, 647
    s_mul_i32 s45, s44, 1821
    s_lshr_b32 s45, s45, 16
    s_mul_i32 s68, s45, 36
    s_sub_u32 s68, s44, s68
    s_mul_i32 s69, s45, 294912
    s_lshl_b32 s70, s68, 7
    s_add_u32 s69, s69, s70
    s_mul_i32 s70, s68, 73728
    s_lshl_b32 s45, s45, 10
    s_add_u32 s70, s70, s45
    s_add_u32 s73, s70, 60817408
    s_add_u32 m0, s47, 4096
    s_add_u32 s70, s69, 0
    buffer_load_dwordx4 v14, s[56:59], s70 offen lds
    s_add_u32 m0, s47, 5120
    s_add_u32 s70, s69, 147456
    buffer_load_dwordx4 v14, s[56:59], s70 offen lds
    s_add_u32 m0, s47, 6144
    s_add_u32 s70, s69, 36864
    buffer_load_dwordx4 v14, s[56:59], s70 offen lds
    s_add_u32 m0, s47, 7168
    s_add_u32 s70, s69, 184320
    buffer_load_dwordx4 v14, s[56:59], s70 offen lds
    s_add_u32 s44, s46, 512
    s_min_u32 s44, s44, 647
    s_mul_i32 s45, s44, 1821
    s_lshr_b32 s45, s45, 16
    s_mul_i32 s68, s45, 36
    s_sub_u32 s68, s44, s68
    s_mul_i32 s69, s45, 294912
    s_lshl_b32 s70, s68, 7
    s_add_u32 s69, s69, s70
    s_mul_i32 s70, s68, 73728
    s_lshl_b32 s45, s45, 10
    s_add_u32 s70, s70, s45
    s_add_u32 s74, s70, 60817408
    s_add_u32 m0, s47, 8192
    s_add_u32 s70, s69, 0
    buffer_load_dwordx4 v14, s[56:59], s70 offen lds
    s_add_u32 m0, s47, 9216
    s_add_u32 s70, s69, 147456
    buffer_load_dwordx4 v14, s[56:59], s70 offen lds
    s_add_u32 m0, s47, 10240
    s_add_u32 s70, s69, 36864
    buffer_load_dwordx4 v14, s[56:59], s70 offen lds
    s_add_u32 m0, s47, 11264
    s_add_u32 s70, s69, 184320
    buffer_load_dwordx4 v14, s[56:59], s70 offen lds
    v_lshrrev_b32 v10, 4, v2
    v_bfe_u32 v12, v2, 2, 2
    v_lshl_add_u32 v10, v10, 2, v12
    v_bfe_u32 v12, v10, 1, 2
    v_lshlrev_b32 v12, 5, v12
    v_lshlrev_b32 v10, 7, v10
    v_and_b32 v13, 3, v2
    v_lshl_add_u32 v10, v13, 3, v10
    v_add_u32 v10, s47, v10
    v_xor_b32 v13, 0, v12
    v_add_u32 v16, v10, v13
    v_xor_b32 v13, 32, v12
    v_add_u32 v17, v10, v13
    v_xor_b32 v13, 64, v12
    v_add_u32 v18, v10, v13
    v_xor_b32 v13, 96, v12
    v_add_u32 v19, v10, v13
    s_waitcnt vmcnt(12)
    v_mov_b32 v20, 0
    v_dot2_f32_bf16 v20, v100, v140, v20
    v_dot2_f32_bf16 v20, v101, v141, v20
    v_dot2_f32_bf16 v20, v102, v142, v20
    v_dot2_f32_bf16 v20, v103, v143, v20
    v_dot2_f32_bf16 v20, v104, v144, v20
    v_dot2_f32_bf16 v20, v105, v145, v20
    v_dot2_f32_bf16 v20, v106, v146, v20
    v_dot2_f32_bf16 v20, v107, v147, v20
    v_dot2_f32_bf16 v20, v108, v148, v20
    v_dot2_f32_bf16 v20, v109, v149, v20
    v_dot2_f32_bf16 v20, v110, v150, v20
    v_dot2_f32_bf16 v20, v111, v151, v20
    v_dot2_f32_bf16 v20, v112, v152, v20
    v_dot2_f32_bf16 v20, v113, v153, v20
    v_dot2_f32_bf16 v20, v114, v154, v20
    v_dot2_f32_bf16 v20, v115, v155, v20
    v_dot2_f32_bf16 v20, v116, v156, v20
    v_dot2_f32_bf16 v20, v117, v157, v20
    v_dot2_f32_bf16 v20, v118, v158, v20
    v_dot2_f32_bf16 v20, v119, v159, v20
    v_dot2_f32_bf16 v20, v120, v160, v20
    v_dot2_f32_bf16 v20, v121, v161, v20
    v_dot2_f32_bf16 v20, v122, v162, v20
    v_dot2_f32_bf16 v20, v123, v163, v20
    v_dot2_f32_bf16 v20, v124, v164, v20
    v_dot2_f32_bf16 v20, v125, v165, v20
    v_dot2_f32_bf16 v20, v126, v166, v20
    v_dot2_f32_bf16 v20, v127, v167, v20
    v_dot2_f32_bf16 v20, v128, v168, v20
    v_dot2_f32_bf16 v20, v129, v169, v20
    v_dot2_f32_bf16 v20, v130, v170, v20
    v_dot2_f32_bf16 v20, v131, v171, v20
    v_dot2_f32_bf16 v20, v132, v172, v20
    v_dot2_f32_bf16 v20, v133, v173, v20
    v_dot2_f32_bf16 v20, v134, v174, v20
    v_dot2_f32_bf16 v20, v135, v175, v20
    s_nop 2
    v_add_f32_dpp v20, v20, v20 quad_perm:[1,0,3,2] row_mask:0xf bank_mask:0xf
    s_nop 1
    v_add_f32_dpp v20, v20, v20 quad_perm:[2,3,0,1] row_mask:0xf bank_mask:0xf
    s_nop 1
    v_add_f32_dpp v20, v20, v20 row_half_mirror row_mask:0xf bank_mask:0xf
    v_mul_f32 v20, 0xbfb8aa3b, v20
    v_exp_f32 v20, v20
    s_nop 0
    v_add_f32 v20, 1.0, v20
    v_rcp_f32 v20, v20
    v_lshlrev_b32 v21, 2, v15
    v_add_u32 v21, 31457280, v21
    v_mov_b32 v22, 1073741824
    v_cmp_eq_u32 vcc, 0, v11
    s_nop 1
    v_cndmask_b32 v21, v22, v21, vcc
    buffer_store_dword v20, v21, s[24:27], 0 offen
    s_waitcnt vmcnt(1)
    ds_read_b64_tr_b16 v[32:33], v16 offset:0
    ds_read_b64_tr_b16 v[34:35], v16 offset:2048
    ds_read_b64_tr_b16 v[36:37], v17 offset:0
    ds_read_b64_tr_b16 v[38:39], v17 offset:2048
    ds_read_b64_tr_b16 v[40:41], v18 offset:0
    ds_read_b64_tr_b16 v[42:43], v18 offset:2048
    ds_read_b64_tr_b16 v[44:45], v19 offset:0
    ds_read_b64_tr_b16 v[46:47], v19 offset:2048
    s_waitcnt lgkmcnt(0)
    s_add_u32 s70, s72, 0
    buffer_store_dwordx4 v[32:35], v24, s[24:27], s70 offen
    s_add_u32 s70, s72, 18432
    buffer_store_dwordx4 v[36:39], v24, s[24:27], s70 offen
    s_add_u32 s70, s72, 36864
    buffer_store_dwordx4 v[40:43], v24, s[24:27], s70 offen
    s_add_u32 s70, s72, 55296
    buffer_store_dwordx4 v[44:47], v24, s[24:27], s70 offen
    ds_read_b64_tr_b16 v[48:49], v16 offset:4096
    ds_read_b64_tr_b16 v[50:51], v16 offset:6144
    ds_read_b64_tr_b16 v[52:53], v17 offset:4096
    ds_read_b64_tr_b16 v[54:55], v17 offset:6144
    ds_read_b64_tr_b16 v[56:57], v18 offset:4096
    ds_read_b64_tr_b16 v[58:59], v18 offset:6144
    ds_read_b64_tr_b16 v[60:61], v19 offset:4096
    ds_read_b64_tr_b16 v[62:63], v19 offset:6144
    s_waitcnt lgkmcnt(0)
    s_add_u32 s70, s73, 0
    buffer_store_dwordx4 v[48:51], v24, s[24:27], s70 offen
    s_add_u32 s70, s73, 18432
    buffer_store_dwordx4 v[52:55], v24, s[24:27], s70 offen
    s_add_u32 s70, s73, 36864
    buffer_store_dwordx4 v[56:59], v24, s[24:27], s70 offen
    s_add_u32 s70, s73, 55296
    buffer_store_dwordx4 v[60:63], v24, s[24:27], s70 offen
    ds_read_b64_tr_b16 v[64:65], v16 offset:8192
    ds_read_b64_tr_b16 v[66:67], v16 offset:10240
    ds_read_b64_tr_b16 v[68:69], v17 offset:8192
    ds_read_b64_tr_b16 v[70:71], v17 offset:10240
    ds_read_b64_tr_b16 v[72:73], v18 offset:8192
    ds_read_b64_tr_b16 v[74:75], v18 offset:10240
    ds_read_b64_tr_b16 v[76:77], v19 offset:8192
    ds_read_b64_tr_b16 v[78:79], v19 offset:10240
    s_waitcnt lgkmcnt(0)
    s_add_u32 s70, s74, 0
    buffer_store_dwordx4 v[64:67], v24, s[24:27], s70 offen
    s_add_u32 s70, s74, 18432
    buffer_store_dwordx4 v[68:71], v24, s[24:27], s70 offen
    s_add_u32 s70, s74, 36864
    buffer_store_dwordx4 v[72:75], v24, s[24:27], s70 offen
    s_add_u32 s70, s74, 55296
    buffer_store_dwordx4 v[76:79], v24, s[24:27], s70 offen
    s_branch L_k1_fin
L_k1_fin:
L_k1_end:
    s_endpgm
L_k1_codeend:
.section .rodata,"a"
.p2align 6
.amdhsa_kernel k1_kernel
.amdhsa_next_free_vgpr 256
.amdhsa_next_free_sgpr 96
.amdhsa_accum_offset 256
.amdhsa_group_segment_fixed_size 0
.amdhsa_kernarg_size 96
.amdhsa_user_sgpr_count 2
.amdhsa_user_sgpr_kernarg_segment_ptr 1
.amdhsa_system_sgpr_workgroup_id_x 1
.amdhsa_float_denorm_mode_32 3
.end_amdhsa_kernel
.text
.globl k2_kernel
.p2align 8
.type k2_kernel,@function
k2_kernel:
    s_cmp_ge_u32 s2, 512
    s_cbranch_scc1 L_k2_end
    s_cmp_ge_u32 s2, 256
    s_cbranch_scc1 L_k2_A
    s_load_dwordx2 s[8:9], s[0:1], 88
    s_load_dwordx2 s[10:11], s[0:1], 32
    s_load_dwordx2 s[12:13], s[0:1], 40
    s_load_dwordx2 s[14:15], s[0:1], 48
    v_lshrrev_b32 v1, 6, v0
    v_and_b32 v2, 63, v0
    s_nop 0
    v_readfirstlane_b32 s36, v1
    s_waitcnt lgkmcnt(0)
    s_mov_b32 s24, s8
    s_and_b32 s25, s9, 0xffff
    s_mov_b32 s26, 0x3d00000
    s_mov_b32 s27, 0x20000
    s_setprio 3
    v_mov_b32 v125, 0
    s_mov_b32 s91, 0
    s_lshr_b32 s44, s2, 1
    s_mul_i32 s44, s44, 73728
    s_add_u32 s44, s44, 8388608
    s_mul_i32 s45, s36, 18432
    s_add_u32 s44, s44, s45
    s_and_b32 s45, s2, 1
    s_lshl_b32 s45, s45, 7
    s_add_u32 s44, s44, s45
    v_and_b32 v3, 7, v2
    v_bfe_u32 v4, v2, 3, 2
    v_lshrrev_b32 v5, 5, v2
    v_lshlrev_b32 v6, 4, v3
    v_lshl_add_u32 v6, v4, 8, v6
    v_mul_u32_u24 v7, 9216, v5
    v_add_u32 v6, v6, v7
    s_add_u32 s45, s44, 0
    buffer_load_dwordx4 v[16:19], v6, s[24:27], s45 offen
    s_add_u32 s45, s44, 1024
    buffer_load_dwordx4 v[20:23], v6, s[24:27], s45 offen
    s_add_u32 s45, s44, 2048
    buffer_load_dwordx4 v[24:27], v6, s[24:27], s45 offen
    s_add_u32 s45, s44, 3072
    buffer_load_dwordx4 v[28:31], v6, s[24:27], s45 offen
    s_add_u32 s45, s44, 4096
    buffer_load_dwordx4 v[32:35], v6, s[24:27], s45 offen
    s_add_u32 s45, s44, 5120
    buffer_load_dwordx4 v[36:39], v6, s[24:27], s45 offen
    s_add_u32 s45, s44, 6144
    buffer_load_dwordx4 v[40:43], v6, s[24:27], s45 offen
    s_add_u32 s45, s44, 7168
    buffer_load_dwordx4 v[44:47], v6, s[24:27], s45 offen
    s_add_u32 s45, s44, 8192
    buffer_load_dwordx4 v[48:51], v6, s[24:27], s45 offen
    v_mov_b32 v12, 0xc0135761
    v_mov_b32 v13, 0xc0135761
    s_mov_b32 s50, 0xbdd2d3e8
    s_mov_b32 s51, 0xbdd2d3e8
    v_mov_b32 v14, 1.0
    v_mov_b32 v15, 1.0
    s_mov_b32 s28, s10
    s_and_b32 s29, s11, 0xffff
    s_mov_b32 s30, 0x510000
    s_mov_b32 s31, 0x20000
    s_mov_b32 s32, s14
    s_and_b32 s33, s15, 0xffff
    s_mov_b32 s34, 0x1000
    s_mov_b32 s35, 0x20000
    s_and_b32 s40, s2, 7
    s_lshr_b32 s41, s2, 3
    s_and_b32 s42, s40, 1
    s_lshl_b32 s42, s42, 3
    s_and_b32 s43, s41, 7
    s_add_u32 s37, s42, s43
    s_lshr_b32 s42, s40, 1
    s_lshl_b32 s42, s42, 2
    s_lshr_b32 s43, s41, 3
    s_add_u32 s38, s42, s43
    s_lshl_b32 s56, s37, 3
    s_lshl_b32 s43, s36, 1
    s_add_u32 s56, s56, s43
    s_lshl_b32 s57, s36, 10
    v_lshlrev_b32 v236, 4, v2
    v_add_u32 v237, 36864, v236
    v_add_u32 v244, 18432, v236
    v_lshrrev_b32 v8, 4, v2
    v_bfe_u32 v9, v2, 2, 2
    v_lshl_add_u32 v9, v8, 2, v9
    v_mul_u32_u24 v9, 288, v9
    v_and_b32 v10, 3, v2
    v_lshl_add_u32 v238, v10, 3, v9
    v_add_u32 v250, 36864, v238
    s_mul_i32 s48, s38, 288
    s_add_u32 s49, s36, 0
    s_lshr_b32 s58, s49, 1
    s_mul_i32 s59, s58, 18432
    s_mul_i32 s58, s58, 65536
    s_and_b32 s49, s49, 1
    s_lshl_b32 s49, s49, 10
    s_add_u32 s58, s58, s49
    s_add_u32 s59, s59, s49
    v_add_u32 v245, s58, v236
    v_add_u32 v239, s59, v236
    s_add_u32 s49, s36, 4
    s_lshr_b32 s58, s49, 1
    s_mul_i32 s59, s58, 18432
    s_mul_i32 s58, s58, 65536
    s_and_b32 s49, s49, 1
    s_lshl_b32 s49, s49, 10
    s_add_u32 s58, s58, s49
    s_add_u32 s59, s59, s49
    v_add_u32 v246, s58, v236
    v_add_u32 v240, s59, v236
    s_add_u32 s49, s36, 8
    s_lshr_b32 s58, s49, 1
    s_mul_i32 s59, s58, 18432
    s_mul_i32 s58, s58, 65536
    s_and_b32 s49, s49, 1
    s_lshl_b32 s49, s49, 10
    s_add_u32 s58, s58, s49
    s_add_u32 s59, s59, s49
    v_add_u32 v247, s58, v236
    v_add_u32 v241, s59, v236
    s_add_u32 s49, s36, 12
    s_lshr_b32 s58, s49, 1
    s_mul_i32 s59, s58, 18432
    s_mul_i32 s58, s58, 65536
    s_and_b32 s49, s49, 1
    s_lshl_b32 s49, s49, 10
    s_add_u32 s58, s58, s49
    s_add_u32 s59, s59, s49
    v_add_u32 v248, s58, v236
    v_add_u32 v242, s59, v236
    s_add_u32 s49, s36, 16
    s_lshr_b32 s58, s49, 1
    s_mul_i32 s59, s58, 18432
    s_mul_i32 s58, s58, 65536
    s_and_b32 s49, s49, 1
    s_lshl_b32 s49, s49, 10
    s_add_u32 s58, s58, s49
    s_add_u32 s59, s59, s49
    v_add_u32 v249, s58, v236
    v_add_u32 v243, s59, v236
    s_waitcnt vmcnt(0)
    s_mul_i32 s52, s56, 18432
    s_add_u32 s52, s52, 18874368
    s_mov_b32 s53, 0
    s_mul_i32 s53, s38, 165888
    s_add_u32 s53, s53, 60817408
    buffer_load_dwordx4 v[136:139], v236, s[24:27], s52 offen offset:0
    buffer_load_dwordx4 v[140:143], v244, s[24:27], s52 offen offset:0
    buffer_load_dwordx4 v[144:147], v236, s[24:27], s52 offen offset:1024
    buffer_load_dwordx4 v[148:151], v244, s[24:27], s52 offen offset:1024
    s_add_u32 s52, s52, 2048
    s_add_u32 m0, s57, 0
    s_nop 0
    buffer_load_dwordx4 v239, s[24:27], s53 offen lds
    s_add_u32 m0, s57, 4096
    s_nop 0
    buffer_load_dwordx4 v240, s[24:27], s53 offen lds
    s_add_u32 m0, s57, 8192
    s_nop 0
    buffer_load_dwordx4 v241, s[24:27], s53 offen lds
    s_add_u32 m0, s57, 12288
    s_nop 0
    buffer_load_dwordx4 v242, s[24:27], s53 offen lds
    s_cmp_ge_u32 s36, 2
    s_cbranch_scc1 L_k2sp_sk_1
    s_add_u32 m0, s57, 16384
    s_nop 0
    buffer_load_dwordx4 v243, s[24:27], s53 offen lds
L_k2sp_sk_1:
    s_add_u32 s53, s53, 2048
    buffer_load_dwordx4 v[152:155], v236, s[24:27], s52 offen offset:0
    buffer_load_dwordx4 v[156:159], v244, s[24:27], s52 offen offset:0
    buffer_load_dwordx4 v[160:163], v236, s[24:27], s52 offen offset:1024
    buffer_load_dwordx4 v[164:167], v244, s[24:27], s52 offen offset:1024
    s_add_u32 s52, s52, 2048
    s_add_u32 m0, s57, 18432
    s_nop 0
    buffer_load_dwordx4 v239, s[24:27], s53 offen lds
    s_add_u32 m0, s57, 22528
    s_nop 0
    buffer_load_dwordx4 v240, s[24:27], s53 offen lds
    s_add_u32 m0, s57, 26624
    s_nop 0
    buffer_load_dwordx4 v241, s[24:27], s53 offen lds
    s_add_u32 m0, s57, 30720
    s_nop 0
    buffer_load_dwordx4 v242, s[24:27], s53 offen lds
    s_cmp_ge_u32 s36, 2
    s_cbranch_scc1 L_k2sp_sk_2
    s_add_u32 m0, s57, 34816
    s_nop 0
    buffer_load_dwordx4 v243, s[24:27], s53 offen lds
L_k2sp_sk_2:
    s_add_u32 s53, s53, 2048
    s_mul_i32 s60, s36, 8
    s_add_u32 s60, s60, 0
    s_mov_b32 s64, s12
    s_and_b32 s65, s13, 0xffff
    s_mov_b32 s66, 0x800000
    s_mov_b32 s67, 0x20000
    s_lshl_b32 s61, s2, 3
    v_lshrrev_b32 v184, 3, v2
    v_and_b32 v185, 7, v2
    v_add_u32 v184, s61, v184
    v_lshlrev_b32 v186, 12, v184
    v_lshl_add_u32 v186, v185, 4, v186
    s_lshl_b32 s62, s60, 7
    buffer_load_dwordx4 v[200:203], v186, s[64:67], s62 offen offset:0
    buffer_load_dwordx4 v[204:207], v186, s[64:67], s62 offen offset:128
    buffer_load_dwordx4 v[208:211], v186, s[64:67], s62 offen offset:256
    buffer_load_dwordx4 v[212:215], v186, s[64:67], s62 offen offset:384
    buffer_load_dwordx4 v[216:219], v186, s[64:67], s62 offen offset:512
    buffer_load_dwordx4 v[220:223], v186, s[64:67], s62 offen offset:640
    buffer_load_dwordx4 v[224:227], v186, s[64:67], s62 offen offset:768
    buffer_load_dwordx4 v[228:231], v186, s[64:67], s62 offen offset:896
    v_and_b32 v184, 15, v184
    v_and_b32 v186, 3, v185
    v_lshl_add_u32 v184, v186, 4, v184
    v_lshlrev_b32 v184, 4, v184
    v_lshrrev_b32 v185, 2, v185
    v_lshl_add_u32 v184, v185, 10, v184
    s_lshr_b32 s61, s61, 4
    s_mul_i32 s61, s61, 65536
    s_add_u32 s61, s61, 22020096
    s_lshl_b32 s62, s60, 11
    s_add_u32 s61, s61, s62
    v_lshlrev_b32 v64, 16, v16
    v_and_b32 v65, 0xffff0000, v16
    v_lshlrev_b32 v66, 16, v17
    v_and_b32 v67, 0xffff0000, v17
    v_lshlrev_b32 v68, 16, v18
    v_and_b32 v69, 0xffff0000, v18
    v_lshlrev_b32 v70, 16, v19
    v_and_b32 v71, 0xffff0000, v19
    v_lshlrev_b32 v72, 16, v20
    v_and_b32 v73, 0xffff0000, v20
    v_lshlrev_b32 v74, 16, v21
    v_and_b32 v75, 0xffff0000, v21
    v_lshlrev_b32 v76, 16, v22
    v_and_b32 v77, 0xffff0000, v22
    v_lshlrev_b32 v78, 16, v23
    v_and_b32 v79, 0xffff0000, v23
    v_lshlrev_b32 v80, 16, v24
    v_and_b32 v81, 0xffff0000, v24
    v_lshlrev_b32 v82, 16, v25
    v_and_b32 v83, 0xffff0000, v25
    v_lshlrev_b32 v84, 16, v26
    v_and_b32 v85, 0xffff0000, v26
    v_lshlrev_b32 v86, 16, v27
    v_and_b32 v87, 0xffff0000, v27
    v_lshlrev_b32 v88, 16, v28
    v_and_b32 v89, 0xffff0000, v28
    v_lshlrev_b32 v90, 16, v29
    v_and_b32 v91, 0xffff0000, v29
    v_lshlrev_b32 v92, 16, v30
    v_and_b32 v93, 0xffff0000, v30
    v_lshlrev_b32 v94, 16, v31
    v_and_b32 v95, 0xffff0000, v31
    v_lshlrev_b32 v96, 16, v32
    v_and_b32 v97, 0xffff0000, v32
    v_lshlrev_b32 v98, 16, v33
    v_and_b32 v99, 0xffff0000, v33
    v_lshlrev_b32 v100, 16, v34
    v_and_b32 v101, 0xffff0000, v34
    v_lshlrev_b32 v102, 16, v35
    v_and_b32 v103, 0xffff0000, v35
    v_lshlrev_b32 v104, 16, v36
    v_and_b32 v105, 0xffff0000, v36
    v_lshlrev_b32 v106, 16, v37
    v_and_b32 v107, 0xffff0000, v37
    v_lshlrev_b32 v108, 16, v38
    v_and_b32 v109, 0xffff0000, v38
    v_lshlrev_b32 v110, 16, v39
    v_and_b32 v111, 0xffff0000, v39
    v_lshlrev_b32 v112, 16, v40
    v_and_b32 v113, 0xffff0000, v40
    v_lshlrev_b32 v114, 16, v41
    v_and_b32 v115, 0xffff0000, v41
    v_lshlrev_b32 v116, 16, v42
    v_and_b32 v117, 0xffff0000, v42
    v_lshlrev_b32 v118, 16, v43
    v_and_b32 v119, 0xffff0000, v43
    v_lshlrev_b32 v120, 16, v44
    v_and_b32 v121, 0xffff0000, v44
    v_lshlrev_b32 v122, 16, v45
    v_and_b32 v123, 0xffff0000, v45
    v_lshlrev_b32 v124, 16, v46
    v_and_b32 v125, 0xffff0000, v46
    v_lshlrev_b32 v126, 16, v47
    v_and_b32 v127, 0xffff0000, v47
    v_lshlrev_b32 v128, 16, v48
    v_and_b32 v129, 0xffff0000, v48
    v_lshlrev_b32 v130, 16, v49
    v_and_b32 v131, 0xffff0000, v49
    v_lshlrev_b32 v132, 16, v50
    v_and_b32 v133, 0xffff0000, v50
    v_lshlrev_b32 v134, 16, v51
    v_and_b32 v135, 0xffff0000, v51
    v_pk_mul_f32 v[16:17], v[64:65], v[64:65]
    v_pk_mul_f32 v[18:19], v[66:67], v[66:67]
    v_pk_mul_f32 v[20:21], v[68:69], v[68:69]
    v_pk_mul_f32 v[22:23], v[70:71], v[70:71]
    v_pk_mul_f32 v[24:25], v[72:73], v[72:73]
    v_pk_mul_f32 v[26:27], v[74:75], v[74:75]
    v_pk_fma_f32 v[16:17], v[16:17], s[50:51], v[12:13]
    v_pk_fma_f32 v[18:19], v[18:19], s[50:51], v[12:13]
    v_pk_fma_f32 v[20:21], v[20:21], s[50:51], v[12:13]
    v_pk_fma_f32 v[22:23], v[22:23], s[50:51], v[12:13]
    v_pk_fma_f32 v[24:25], v[24:25], s[50:51], v[12:13]
    v_pk_fma_f32 v[26:27], v[26:27], s[50:51], v[12:13]
    v_pk_mul_f32 v[16:17], v[16:17], v[64:65]
    v_pk_mul_f32 v[18:19], v[18:19], v[66:67]
    v_pk_mul_f32 v[20:21], v[20:21], v[68:69]
    v_pk_mul_f32 v[22:23], v[22:23], v[70:71]
    v_pk_mul_f32 v[24:25], v[24:25], v[72:73]
    v_pk_mul_f32 v[26:27], v[26:27], v[74:75]
    v_exp_f32 v16, v16
    v_exp_f32 v17, v17
    v_exp_f32 v18, v18
    v_exp_f32 v19, v19
    v_exp_f32 v20, v20
    v_exp_f32 v21, v21
    v_exp_f32 v22, v22
    v_exp_f32 v23, v23
    v_exp_f32 v24, v24
    v_exp_f32 v25, v25
    v_exp_f32 v26, v26
    v_exp_f32 v27, v27
    v_pk_add_f32 v[16:17], v[16:17], v[14:15]
    v_pk_add_f32 v[18:19], v[18:19], v[14:15]
    v_pk_add_f32 v[20:21], v[20:21], v[14:15]
    v_pk_add_f32 v[22:23], v[22:23], v[14:15]
    v_pk_add_f32 v[24:25], v[24:25], v[14:15]
    v_pk_add_f32 v[26:27], v[26:27], v[14:15]
    v_rcp_f32 v16, v16
    v_rcp_f32 v17, v17
    v_rcp_f32 v18, v18
    v_rcp_f32 v19, v19
    v_rcp_f32 v20, v20
    v_rcp_f32 v21, v21
    v_rcp_f32 v22, v22
    v_rcp_f32 v23, v23
    v_rcp_f32 v24, v24
    v_rcp_f32 v25, v25
    v_rcp_f32 v26, v26
    v_rcp_f32 v27, v27
    v_pk_mul_f32 v[64:65], v[64:65], v[16:17]
    v_pk_mul_f32 v[66:67], v[66:67], v[18:19]
    v_pk_mul_f32 v[68:69], v[68:69], v[20:21]
    v_pk_mul_f32 v[70:71], v[70:71], v[22:23]
    v_pk_mul_f32 v[72:73], v[72:73], v[24:25]
    v_pk_mul_f32 v[74:75], v[74:75], v[26:27]
    v_pk_mul_f32 v[16:17], v[76:77], v[76:77]
    v_pk_mul_f32 v[18:19], v[78:79], v[78:79]
    v_pk_mul_f32 v[20:21], v[80:81], v[80:81]
    v_pk_mul_f32 v[22:23], v[82:83], v[82:83]
    v_pk_mul_f32 v[24:25], v[84:85], v[84:85]
    v_pk_mul_f32 v[26:27], v[86:87], v[86:87]
    v_pk_fma_f32 v[16:17], v[16:17], s[50:51], v[12:13]
    v_pk_fma_f32 v[18:19], v[18:19], s[50:51], v[12:13]
    v_pk_fma_f32 v[20:21], v[20:21], s[50:51], v[12:13]
    v_pk_fma_f32 v[22:23], v[22:23], s[50:51], v[12:13]
    v_pk_fma_f32 v[24:25], v[24:25], s[50:51], v[12:13]
    v_pk_fma_f32 v[26:27], v[26:27], s[50:51], v[12:13]
    v_pk_mul_f32 v[16:17], v[16:17], v[76:77]
    v_pk_mul_f32 v[18:19], v[18:19], v[78:79]
    v_pk_mul_f32 v[20:21], v[20:21], v[80:81]
    v_pk_mul_f32 v[22:23], v[22:23], v[82:83]
    v_pk_mul_f32 v[24:25], v[24:25], v[84:85]
    v_pk_mul_f32 v[26:27], v[26:27], v[86:87]
    v_exp_f32 v16, v16
    v_exp_f32 v17, v17
    v_exp_f32 v18, v18
    v_exp_f32 v19, v19
    v_exp_f32 v20, v20
    v_exp_f32 v21, v21
    v_exp_f32 v22, v22
    v_exp_f32 v23, v23
    v_exp_f32 v24, v24
    v_exp_f32 v25, v25
    v_exp_f32 v26, v26
    v_exp_f32 v27, v27
    v_pk_add_f32 v[16:17], v[16:17], v[14:15]
    v_pk_add_f32 v[18:19], v[18:19], v[14:15]
    v_pk_add_f32 v[20:21], v[20:21], v[14:15]
    v_pk_add_f32 v[22:23], v[22:23], v[14:15]
    v_pk_add_f32 v[24:25], v[24:25], v[14:15]
    v_pk_add_f32 v[26:27], v[26:27], v[14:15]
    v_rcp_f32 v16, v16
    v_rcp_f32 v17, v17
    v_rcp_f32 v18, v18
    v_rcp_f32 v19, v19
    v_rcp_f32 v20, v20
    v_rcp_f32 v21, v21
    v_rcp_f32 v22, v22
    v_rcp_f32 v23, v23
    v_rcp_f32 v24, v24
    v_rcp_f32 v25, v25
    v_rcp_f32 v26, v26
    v_rcp_f32 v27, v27
    v_pk_mul_f32 v[76:77], v[76:77], v[16:17]
    v_pk_mul_f32 v[78:79], v[78:79], v[18:19]
    v_pk_mul_f32 v[80:81], v[80:81], v[20:21]
    v_pk_mul_f32 v[82:83], v[82:83], v[22:23]
    v_pk_mul_f32 v[84:85], v[84:85], v[24:25]
    v_pk_mul_f32 v[86:87], v[86:87], v[26:27]
    v_pk_mul_f32 v[16:17], v[88:89], v[88:89]
    v_pk_mul_f32 v[18:19], v[90:91], v[90:91]
    v_pk_mul_f32 v[20:21], v[92:93], v[92:93]
    v_pk_mul_f32 v[22:23], v[94:95], v[94:95]
    v_pk_mul_f32 v[24:25], v[96:97], v[96:97]
    v_pk_mul_f32 v[26:27], v[98:99], v[98:99]
    v_pk_fma_f32 v[16:17], v[16:17], s[50:51], v[12:13]
    v_pk_fma_f32 v[18:19], v[18:19], s[50:51], v[12:13]
    v_pk_fma_f32 v[20:21], v[20:21], s[50:51], v[12:13]
    v_pk_fma_f32 v[22:23], v[22:23], s[50:51], v[12:13]
    v_pk_fma_f32 v[24:25], v[24:25], s[50:51], v[12:13]
    v_pk_fma_f32 v[26:27], v[26:27], s[50:51], v[12:13]
    v_pk_mul_f32 v[16:17], v[16:17], v[88:89]
    v_pk_mul_f32 v[18:19], v[18:19], v[90:91]
    v_pk_mul_f32 v[20:21], v[20:21], v[92:93]
    v_pk_mul_f32 v[22:23], v[22:23], v[94:95]
    v_pk_mul_f32 v[24:25], v[24:25], v[96:97]
    v_pk_mul_f32 v[26:27], v[26:27], v[98:99]
    v_exp_f32 v16, v16
    v_exp_f32 v17, v17
    v_exp_f32 v18, v18
    v_exp_f32 v19, v19
    v_exp_f32 v20, v20
    v_exp_f32 v21, v21
    v_exp_f32 v22, v22
    v_exp_f32 v23, v23
    v_exp_f32 v24, v24
    v_exp_f32 v25, v25
    v_exp_f32 v26, v26
    v_exp_f32 v27, v27
    v_pk_add_f32 v[16:17], v[16:17], v[14:15]
    v_pk_add_f32 v[18:19], v[18:19], v[14:15]
    v_pk_add_f32 v[20:21], v[20:21], v[14:15]
    v_pk_add_f32 v[22:23], v[22:23], v[14:15]
    v_pk_add_f32 v[24:25], v[24:25], v[14:15]
    v_pk_add_f32 v[26:27], v[26:27], v[14:15]
    v_rcp_f32 v16, v16
    v_rcp_f32 v17, v17
    v_rcp_f32 v18, v18
    v_rcp_f32 v19, v19
    v_rcp_f32 v20, v20
    v_rcp_f32 v21, v21
    v_rcp_f32 v22, v22
    v_rcp_f32 v23, v23
    v_rcp_f32 v24, v24
    v_rcp_f32 v25, v25
    v_rcp_f32 v26, v26
    v_rcp_f32 v27, v27
    v_pk_mul_f32 v[88:89], v[88:89], v[16:17]
    v_pk_mul_f32 v[90:91], v[90:91], v[18:19]
    v_pk_mul_f32 v[92:93], v[92:93], v[20:21]
    v_pk_mul_f32 v[94:95], v[94:95], v[22:23]
    v_pk_mul_f32 v[96:97], v[96:97], v[24:25]
    v_pk_mul_f32 v[98:99], v[98:99], v[26:27]
    v_pk_mul_f32 v[16:17], v[100:101], v[100:101]
    v_pk_mul_f32 v[18:19], v[102:103], v[102:103]
    v_pk_mul_f32 v[20:21], v[104:105], v[104:105]
    v_pk_mul_f32 v[22:23], v[106:107], v[106:107]
    v_pk_mul_f32 v[24:25], v[108:109], v[108:109]
    v_pk_mul_f32 v[26:27], v[110:111], v[110:111]
    v_pk_fma_f32 v[16:17], v[16:17], s[50:51], v[12:13]
    v_pk_fma_f32 v[18:19], v[18:19], s[50:51], v[12:13]
    v_pk_fma_f32 v[20:21], v[20:21], s[50:51], v[12:13]
    v_pk_fma_f32 v[22:23], v[22:23], s[50:51], v[12:13]
    v_pk_fma_f32 v[24:25], v[24:25], s[50:51], v[12:13]
    v_pk_fma_f32 v[26:27], v[26:27], s[50:51], v[12:13]
    v_pk_mul_f32 v[16:17], v[16:17], v[100:101]
    v_pk_mul_f32 v[18:19], v[18:19], v[102:103]
    v_pk_mul_f32 v[20:21], v[20:21], v[104:105]
    v_pk_mul_f32 v[22:23], v[22:23], v[106:107]
    v_pk_mul_f32 v[24:25], v[24:25], v[108:109]
    v_pk_mul_f32 v[26:27], v[26:27], v[110:111]
    v_exp_f32 v16, v16
    v_exp_f32 v17, v17
    v_exp_f32 v18, v18
    v_exp_f32 v19, v19
    v_exp_f32 v20, v20
    v_exp_f32 v21, v21
    v_exp_f32 v22, v22
    v_exp_f32 v23, v23
    v_exp_f32 v24, v24
    v_exp_f32 v25, v25
    v_exp_f32 v26, v26
    v_exp_f32 v27, v27
    v_pk_add_f32 v[16:17], v[16:17], v[14:15]
    v_pk_add_f32 v[18:19], v[18:19], v[14:15]
    v_pk_add_f32 v[20:21], v[20:21], v[14:15]
    v_pk_add_f32 v[22:23], v[22:23], v[14:15]
    v_pk_add_f32 v[24:25], v[24:25], v[14:15]
    v_pk_add_f32 v[26:27], v[26:27], v[14:15]
    v_rcp_f32 v16, v16
    v_rcp_f32 v17, v17
    v_rcp_f32 v18, v18
    v_rcp_f32 v19, v19
    v_rcp_f32 v20, v20
    v_rcp_f32 v21, v21
    v_rcp_f32 v22, v22
    v_rcp_f32 v23, v23
    v_rcp_f32 v24, v24
    v_rcp_f32 v25, v25
    v_rcp_f32 v26, v26
    v_rcp_f32 v27, v27
    v_pk_mul_f32 v[100:101], v[100:101], v[16:17]
    v_pk_mul_f32 v[102:103], v[102:103], v[18:19]
    v_pk_mul_f32 v[104:105], v[104:105], v[20:21]
    v_pk_mul_f32 v[106:107], v[106:107], v[22:23]
    v_pk_mul_f32 v[108:109], v[108:109], v[24:25]
    v_pk_mul_f32 v[110:111], v[110:111], v[26:27]
    v_pk_mul_f32 v[16:17], v[112:113], v[112:113]
    v_pk_mul_f32 v[18:19], v[114:115], v[114:115]
    v_pk_mul_f32 v[20:21], v[116:117], v[116:117]
    v_pk_mul_f32 v[22:23], v[118:119], v[118:119]
    v_pk_mul_f32 v[24:25], v[120:121], v[120:121]
    v_pk_mul_f32 v[26:27], v[122:123], v[122:123]
    v_pk_fma_f32 v[16:17], v[16:17], s[50:51], v[12:13]
    v_pk_fma_f32 v[18:19], v[18:19], s[50:51], v[12:13]
    v_pk_fma_f32 v[20:21], v[20:21], s[50:51], v[12:13]
    v_pk_fma_f32 v[22:23], v[22:23], s[50:51], v[12:13]
    v_pk_fma_f32 v[24:25], v[24:25], s[50:51], v[12:13]
    v_pk_fma_f32 v[26:27], v[26:27], s[50:51], v[12:13]
    v_pk_mul_f32 v[16:17], v[16:17], v[112:113]
    v_pk_mul_f32 v[18:19], v[18:19], v[114:115]
    v_pk_mul_f32 v[20:21], v[20:21], v[116:117]
    v_pk_mul_f32 v[22:23], v[22:23], v[118:119]
    v_pk_mul_f32 v[24:25], v[24:25], v[120:121]
    v_pk_mul_f32 v[26:27], v[26:27], v[122:123]
    v_exp_f32 v16, v16
    v_exp_f32 v17, v17
    v_exp_f32 v18, v18
    v_exp_f32 v19, v19
    v_exp_f32 v20, v20
    v_exp_f32 v21, v21
    v_exp_f32 v22, v22
    v_exp_f32 v23, v23
    v_exp_f32 v24, v24
    v_exp_f32 v25, v25
    v_exp_f32 v26, v26
    v_exp_f32 v27, v27
    v_pk_add_f32 v[16:17], v[16:17], v[14:15]
    v_pk_add_f32 v[18:19], v[18:19], v[14:15]
    v_pk_add_f32 v[20:21], v[20:21], v[14:15]
    v_pk_add_f32 v[22:23], v[22:23], v[14:15]
    v_pk_add_f32 v[24:25], v[24:25], v[14:15]
    v_pk_add_f32 v[26:27], v[26:27], v[14:15]
    v_rcp_f32 v16, v16
    v_rcp_f32 v17, v17
    v_rcp_f32 v18, v18
    v_rcp_f32 v19, v19
    v_rcp_f32 v20, v20
    v_rcp_f32 v21, v21
    v_rcp_f32 v22, v22
    v_rcp_f32 v23, v23
    v_rcp_f32 v24, v24
    v_rcp_f32 v25, v25
    v_rcp_f32 v26, v26
    v_rcp_f32 v27, v27
    v_pk_mul_f32 v[112:113], v[112:113], v[16:17]
    v_pk_mul_f32 v[114:115], v[114:115], v[18:19]
    v_pk_mul_f32 v[116:117], v[116:117], v[20:21]
    v_pk_mul_f32 v[118:119], v[118:119], v[22:23]
    v_pk_mul_f32 v[120:121], v[120:121], v[24:25]
    v_pk_mul_f32 v[122:123], v[122:123], v[26:27]
    v_pk_mul_f32 v[16:17], v[124:125], v[124:125]
    v_pk_mul_f32 v[18:19], v[126:127], v[126:127]
    v_pk_mul_f32 v[20:21], v[128:129], v[128:129]
    v_pk_mul_f32 v[22:23], v[130:131], v[130:131]
    v_pk_mul_f32 v[24:25], v[132:133], v[132:133]
    v_pk_mul_f32 v[26:27], v[134:135], v[134:135]
    v_pk_fma_f32 v[16:17], v[16:17], s[50:51], v[12:13]
    v_pk_fma_f32 v[18:19], v[18:19], s[50:51], v[12:13]
    v_pk_fma_f32 v[20:21], v[20:21], s[50:51], v[12:13]
    v_pk_fma_f32 v[22:23], v[22:23], s[50:51], v[12:13]
    v_pk_fma_f32 v[24:25], v[24:25], s[50:51], v[12:13]
    v_pk_fma_f32 v[26:27], v[26:27], s[50:51], v[12:13]
    v_pk_mul_f32 v[16:17], v[16:17], v[124:125]
    v_pk_mul_f32 v[18:19], v[18:19], v[126:127]
    v_pk_mul_f32 v[20:21], v[20:21], v[128:129]
    v_pk_mul_f32 v[22:23], v[22:23], v[130:131]
    v_pk_mul_f32 v[24:25], v[24:25], v[132:133]
    v_pk_mul_f32 v[26:27], v[26:27], v[134:135]
    v_exp_f32 v16, v16
    v_exp_f32 v17, v17
    v_exp_f32 v18, v18
    v_exp_f32 v19, v19
    v_exp_f32 v20, v20
    v_exp_f32 v21, v21
    v_exp_f32 v22, v22
    v_exp_f32 v23, v23
    v_exp_f32 v24, v24
    v_exp_f32 v25, v25
    v_exp_f32 v26, v26
    v_exp_f32 v27, v27
    v_pk_add_f32 v[16:17], v[16:17], v[14:15]
    v_pk_add_f32 v[18:19], v[18:19], v[14:15]
    v_pk_add_f32 v[20:21], v[20:21], v[14:15]
    v_pk_add_f32 v[22:23], v[22:23], v[14:15]
    v_pk_add_f32 v[24:25], v[24:25], v[14:15]
    v_pk_add_f32 v[26:27], v[26:27], v[14:15]
    v_rcp_f32 v16, v16
    v_rcp_f32 v17, v17
    v_rcp_f32 v18, v18
    v_rcp_f32 v19, v19
    v_rcp_f32 v20, v20
    v_rcp_f32 v21, v21
    v_rcp_f32 v22, v22
    v_rcp_f32 v23, v23
    v_rcp_f32 v24, v24
    v_rcp_f32 v25, v25
    v_rcp_f32 v26, v26
    v_rcp_f32 v27, v27
    v_pk_mul_f32 v[124:125], v[124:125], v[16:17]
    v_pk_mul_f32 v[126:127], v[126:127], v[18:19]
    v_pk_mul_f32 v[128:129], v[128:129], v[20:21]
    v_pk_mul_f32 v[130:131], v[130:131], v[22:23]
    v_pk_mul_f32 v[132:133], v[132:133], v[24:25]
    v_pk_mul_f32 v[134:135], v[134:135], v[26:27]
    v_mov_b32 v16, 0
    v_mov_b32 v17, 0
    v_mov_b32 v18, 0
    v_mov_b32 v19, 0
    v_mov_b32 v20, 0
    v_mov_b32 v21, 0
    v_mov_b32 v22, 0
    v_mov_b32 v23, 0
    v_pk_add_f32 v[16:17], v[16:17], v[64:65]
    v_pk_fma_f32 v[18:19], v[64:65], v[64:65], v[18:19]
    v_pk_add_f32 v[20:21], v[20:21], v[66:67]
    v_pk_fma_f32 v[22:23], v[66:67], v[66:67], v[22:23]
    v_pk_add_f32 v[16:17], v[16:17], v[68:69]
    v_pk_fma_f32 v[18:19], v[68:69], v[68:69], v[18:19]
    v_pk_add_f32 v[20:21], v[20:21], v[70:71]
    v_pk_fma_f32 v[22:23], v[70:71], v[70:71], v[22:23]
    v_pk_add_f32 v[16:17], v[16:17], v[72:73]
    v_pk_fma_f32 v[18:19], v[72:73], v[72:73], v[18:19]
    v_pk_add_f32 v[20:21], v[20:21], v[74:75]
    v_pk_fma_f32 v[22:23], v[74:75], v[74:75], v[22:23]
    v_pk_add_f32 v[16:17], v[16:17], v[76:77]
    v_pk_fma_f32 v[18:19], v[76:77], v[76:77], v[18:19]
    v_pk_add_f32 v[20:21], v[20:21], v[78:79]
    v_pk_fma_f32 v[22:23], v[78:79], v[78:79], v[22:23]
    v_pk_add_f32 v[16:17], v[16:17], v[80:81]
    v_pk_fma_f32 v[18:19], v[80:81], v[80:81], v[18:19]
    v_pk_add_f32 v[20:21], v[20:21], v[82:83]
    v_pk_fma_f32 v[22:23], v[82:83], v[82:83], v[22:23]
    v_pk_add_f32 v[16:17], v[16:17], v[84:85]
    v_pk_fma_f32 v[18:19], v[84:85], v[84:85], v[18:19]
    v_pk_add_f32 v[20:21], v[20:21], v[86:87]
    v_pk_fma_f32 v[22:23], v[86:87], v[86:87], v[22:23]
    v_pk_add_f32 v[16:17], v[16:17], v[88:89]
    v_pk_fma_f32 v[18:19], v[88:89], v[88:89], v[18:19]
    v_pk_add_f32 v[20:21], v[20:21], v[90:91]
    v_pk_fma_f32 v[22:23], v[90:91], v[90:91], v[22:23]
    v_pk_add_f32 v[16:17], v[16:17], v[92:93]
    v_pk_fma_f32 v[18:19], v[92:93], v[92:93], v[18:19]
    v_pk_add_f32 v[20:21], v[20:21], v[94:95]
    v_pk_fma_f32 v[22:23], v[94:95], v[94:95], v[22:23]
    v_pk_add_f32 v[16:17], v[16:17], v[96:97]
    v_pk_fma_f32 v[18:19], v[96:97], v[96:97], v[18:19]
    v_pk_add_f32 v[20:21], v[20:21], v[98:99]
    v_pk_fma_f32 v[22:23], v[98:99], v[98:99], v[22:23]
    v_pk_add_f32 v[16:17], v[16:17], v[100:101]
    v_pk_fma_f32 v[18:19], v[100:101], v[100:101], v[18:19]
    v_pk_add_f32 v[20:21], v[20:21], v[102:103]
    v_pk_fma_f32 v[22:23], v[102:103], v[102:103], v[22:23]
    v_pk_add_f32 v[16:17], v[16:17], v[104:105]
    v_pk_fma_f32 v[18:19], v[104:105], v[104:105], v[18:19]
    v_pk_add_f32 v[20:21], v[20:21], v[106:107]
    v_pk_fma_f32 v[22:23], v[106:107], v[106:107], v[22:23]
    v_pk_add_f32 v[16:17], v[16:17], v[108:109]
    v_pk_fma_f32 v[18:19], v[108:109], v[108:109], v[18:19]
    v_pk_add_f32 v[20:21], v[20:21], v[110:111]
    v_pk_fma_f32 v[22:23], v[110:111], v[110:111], v[22:23]
    v_pk_add_f32 v[16:17], v[16:17], v[112:113]
    v_pk_fma_f32 v[18:19], v[112:113], v[112:113], v[18:19]
    v_pk_add_f32 v[20:21], v[20:21], v[114:115]
    v_pk_fma_f32 v[22:23], v[114:115], v[114:115], v[22:23]
    v_pk_add_f32 v[16:17], v[16:17], v[116:117]
    v_pk_fma_f32 v[18:19], v[116:117], v[116:117], v[18:19]
    v_pk_add_f32 v[20:21], v[20:21], v[118:119]
    v_pk_fma_f32 v[22:23], v[118:119], v[118:119], v[22:23]
    v_pk_add_f32 v[16:17], v[16:17], v[120:121]
    v_pk_fma_f32 v[18:19], v[120:121], v[120:121], v[18:19]
    v_pk_add_f32 v[20:21], v[20:21], v[122:123]
    v_pk_fma_f32 v[22:23], v[122:123], v[122:123], v[22:23]
    v_pk_add_f32 v[16:17], v[16:17], v[124:125]
    v_pk_fma_f32 v[18:19], v[124:125], v[124:125], v[18:19]
    v_pk_add_f32 v[20:21], v[20:21], v[126:127]
    v_pk_fma_f32 v[22:23], v[126:127], v[126:127], v[22:23]
    v_pk_add_f32 v[16:17], v[16:17], v[128:129]
    v_pk_fma_f32 v[18:19], v[128:129], v[128:129], v[18:19]
    v_pk_add_f32 v[20:21], v[20:21], v[130:131]
    v_pk_fma_f32 v[22:23], v[130:131], v[130:131], v[22:23]
    v_pk_add_f32 v[16:17], v[16:17], v[132:133]
    v_pk_fma_f32 v[18:19], v[132:133], v[132:133], v[18:19]
    v_pk_add_f32 v[20:21], v[20:21], v[134:135]
    v_pk_fma_f32 v[22:23], v[134:135], v[134:135], v[22:23]
    v_pk_add_f32 v[16:17], v[16:17], v[20:21]
    v_pk_add_f32 v[18:19], v[18:19], v[22:23]
    v_add_f32 v16, v16, v17
    v_add_f32 v17, v18, v19
    s_nop 0
    v_add_f32_dpp v16, v16, v16 row_ror:8 row_mask:0xf bank_mask:0xf
    v_add_f32_dpp v17, v17, v17 row_ror:8 row_mask:0xf bank_mask:0xf
    v_mov_b32 v20, v16
    v_mov_b32 v21, v16
    s_nop 1
    v_permlane16_swap_b32 v20, v21
    v_add_f32 v16, v20, v21
    v_mov_b32 v20, v17
    v_mov_b32 v21, v17
    s_nop 1
    v_permlane16_swap_b32 v20, v21
    v_add_f32 v17, v20, v21
    v_mov_b32 v20, v16
    v_mov_b32 v21, v16
    s_nop 1
    v_permlane32_swap_b32 v20, v21
    v_add_f32 v16, v20, v21
    v_mov_b32 v20, v17
    v_mov_b32 v21, v17
    s_nop 1
    v_permlane32_swap_b32 v20, v21
    v_add_f32 v17, v20, v21
    s_waitcnt vmcnt(0)
    s_add_u32 s62, s61, 0
    buffer_store_dwordx4 v[200:203], v184, s[24:27], s62 offen sc1
    s_add_u32 s62, s61, 2048
    buffer_store_dwordx4 v[204:207], v184, s[24:27], s62 offen sc1
    s_add_u32 s62, s61, 4096
    buffer_store_dwordx4 v[208:211], v184, s[24:27], s62 offen sc1
    s_add_u32 s62, s61, 6144
    buffer_store_dwordx4 v[212:215], v184, s[24:27], s62 offen sc1
    s_add_u32 s62, s61, 8192
    buffer_store_dwordx4 v[216:219], v184, s[24:27], s62 offen sc1
    s_add_u32 s62, s61, 10240
    buffer_store_dwordx4 v[220:223], v184, s[24:27], s62 offen sc1
    s_add_u32 s62, s61, 12288
    buffer_store_dwordx4 v[224:227], v184, s[24:27], s62 offen sc1
    s_add_u32 s62, s61, 14336
    buffer_store_dwordx4 v[228:231], v184, s[24:27], s62 offen sc1
    s_lshl_b32 s45, s36, 6
    v_lshlrev_b32 v20, 3, v3
    v_add_u32 v21, s45, v20
    v_add_u32 v21, 73856, v21
    ds_write_b64 v21, v[16:17]
    s_waitcnt lgkmcnt(0)
    s_barrier
    v_add_u32 v20, 73856, v20
    ds_read_b64 v[22:23], v20
    ds_read_b64 v[24:25], v20 offset:64
    ds_read_b64 v[26:27], v20 offset:128
    ds_read_b64 v[28:29], v20 offset:192
    v_mul_u32_u24 v30, 4624, v3
    v_lshl_add_u32 v30, v4, 3, v30
    v_mul_u32_u24 v31, 576, v5
    v_add_u32 v30, v30, v31
    s_mul_i32 s45, s36, 1152
    s_add_u32 s45, s45, 36864
    v_add_u32 v30, s45, v30
    s_waitcnt lgkmcnt(0)
    v_pk_add_f32 v[22:23], v[22:23], v[24:25]
    v_pk_add_f32 v[26:27], v[26:27], v[28:29]
    v_pk_add_f32 v[22:23], v[22:23], v[26:27]
    v_mul_f32 v22, 0x39e38e39, v22
    v_mul_f32 v23, 0x39e38e39, v23
    v_fma_f32 v23, -v22, v22, v23
    v_max_f32 v23, 0, v23
    v_add_f32 v23, 0x3727c5ac, v23
    v_rsq_f32 v24, v23
    s_nop 0
    v_mul_f32 v26, v22, v24
    v_sub_f32 v26, 0, v26
    v_mov_b32 v25, v24
    v_mov_b32 v27, v26
    v_lshrrev_b32 v28, 1, v4
    v_mul_u32_u24 v28, 288, v28
    v_and_b32 v29, 1, v4
    v_lshl_add_u32 v28, v29, 4, v28
    v_lshlrev_b32 v29, 3, v4
    v_sub_u32 v28, v28, v29
    v_add_u32 v31, v30, v28
    v_pk_fma_f32 v[64:65], v[64:65], v[24:25], v[26:27]
    v_pk_fma_f32 v[66:67], v[66:67], v[24:25], v[26:27]
    v_pk_fma_f32 v[68:69], v[68:69], v[24:25], v[26:27]
    v_pk_fma_f32 v[70:71], v[70:71], v[24:25], v[26:27]
    v_cvt_pk_bf16_f32 v32, v64, v65
    v_cvt_pk_bf16_f32 v33, v66, v67
    v_cvt_pk_bf16_f32 v34, v68, v69
    v_cvt_pk_bf16_f32 v35, v70, v71
    ds_write_b64 v30, v[32:33] offset:0
    ds_write_b64 v30, v[34:35] offset:32
    v_pk_fma_f32 v[72:73], v[72:73], v[24:25], v[26:27]
    v_pk_fma_f32 v[74:75], v[74:75], v[24:25], v[26:27]
    v_pk_fma_f32 v[76:77], v[76:77], v[24:25], v[26:27]
    v_pk_fma_f32 v[78:79], v[78:79], v[24:25], v[26:27]
    v_cvt_pk_bf16_f32 v36, v72, v73
    v_cvt_pk_bf16_f32 v37, v74, v75
    v_cvt_pk_bf16_f32 v38, v76, v77
    v_cvt_pk_bf16_f32 v39, v78, v79
    ds_write_b64 v30, v[36:37] offset:64
    ds_write_b64 v30, v[38:39] offset:96
    v_pk_fma_f32 v[80:81], v[80:81], v[24:25], v[26:27]
    v_pk_fma_f32 v[82:83], v[82:83], v[24:25], v[26:27]
    v_pk_fma_f32 v[84:85], v[84:85], v[24:25], v[26:27]
    v_pk_fma_f32 v[86:87], v[86:87], v[24:25], v[26:27]
    v_cvt_pk_bf16_f32 v40, v80, v81
    v_cvt_pk_bf16_f32 v41, v82, v83
    v_cvt_pk_bf16_f32 v42, v84, v85
    v_cvt_pk_bf16_f32 v43, v86, v87
    ds_write_b64 v30, v[40:41] offset:128
    ds_write_b64 v30, v[42:43] offset:160
    v_pk_fma_f32 v[88:89], v[88:89], v[24:25], v[26:27]
    v_pk_fma_f32 v[90:91], v[90:91], v[24:25], v[26:27]
    v_pk_fma_f32 v[92:93], v[92:93], v[24:25], v[26:27]
    v_pk_fma_f32 v[94:95], v[94:95], v[24:25], v[26:27]
    v_cvt_pk_bf16_f32 v44, v88, v89
    v_cvt_pk_bf16_f32 v45, v90, v91
    v_cvt_pk_bf16_f32 v46, v92, v93
    v_cvt_pk_bf16_f32 v47, v94, v95
    ds_write_b64 v30, v[44:45] offset:192
    ds_write_b64 v30, v[46:47] offset:224
    v_pk_fma_f32 v[96:97], v[96:97], v[24:25], v[26:27]
    v_pk_fma_f32 v[98:99], v[98:99], v[24:25], v[26:27]
    v_pk_fma_f32 v[100:101], v[100:101], v[24:25], v[26:27]
    v_pk_fma_f32 v[102:103], v[102:103], v[24:25], v[26:27]
    v_cvt_pk_bf16_f32 v32, v96, v97
    v_cvt_pk_bf16_f32 v33, v98, v99
    v_cvt_pk_bf16_f32 v34, v100, v101
    v_cvt_pk_bf16_f32 v35, v102, v103
    ds_write_b64 v31, v[32:33] offset:256
    ds_write_b64 v31, v[34:35] offset:264
    v_pk_fma_f32 v[104:105], v[104:105], v[24:25], v[26:27]
    v_pk_fma_f32 v[106:107], v[106:107], v[24:25], v[26:27]
    v_pk_fma_f32 v[108:109], v[108:109], v[24:25], v[26:27]
    v_pk_fma_f32 v[110:111], v[110:111], v[24:25], v[26:27]
    v_cvt_pk_bf16_f32 v36, v104, v105
    v_cvt_pk_bf16_f32 v37, v106, v107
    v_cvt_pk_bf16_f32 v38, v108, v109
    v_cvt_pk_bf16_f32 v39, v110, v111
    ds_write_b64 v30, v[36:37] offset:288
    ds_write_b64 v30, v[38:39] offset:320
    v_pk_fma_f32 v[112:113], v[112:113], v[24:25], v[26:27]
    v_pk_fma_f32 v[114:115], v[114:115], v[24:25], v[26:27]
    v_pk_fma_f32 v[116:117], v[116:117], v[24:25], v[26:27]
    v_pk_fma_f32 v[118:119], v[118:119], v[24:25], v[26:27]
    v_cvt_pk_bf16_f32 v40, v112, v113
    v_cvt_pk_bf16_f32 v41, v114, v115
    v_cvt_pk_bf16_f32 v42, v116, v117
    v_cvt_pk_bf16_f32 v43, v118, v119
    ds_write_b64 v30, v[40:41] offset:352
    ds_write_b64 v30, v[42:43] offset:384
    v_pk_fma_f32 v[120:121], v[120:121], v[24:25], v[26:27]
    v_pk_fma_f32 v[122:123], v[122:123], v[24:25], v[26:27]
    v_pk_fma_f32 v[124:125], v[124:125], v[24:25], v[26:27]
    v_pk_fma_f32 v[126:127], v[126:127], v[24:25], v[26:27]
    v_cvt_pk_bf16_f32 v44, v120, v121
    v_cvt_pk_bf16_f32 v45, v122, v123
    v_cvt_pk_bf16_f32 v46, v124, v125
    v_cvt_pk_bf16_f32 v47, v126, v127
    ds_write_b64 v30, v[44:45] offset:416
    ds_write_b64 v30, v[46:47] offset:448
    v_pk_fma_f32 v[128:129], v[128:129], v[24:25], v[26:27]
    v_pk_fma_f32 v[130:131], v[130:131], v[24:25], v[26:27]
    v_pk_fma_f32 v[132:133], v[132:133], v[24:25], v[26:27]
    v_pk_fma_f32 v[134:135], v[134:135], v[24:25], v[26:27]
    v_cvt_pk_bf16_f32 v32, v128, v129
    v_cvt_pk_bf16_f32 v33, v130, v131
    v_cvt_pk_bf16_f32 v34, v132, v133
    v_cvt_pk_bf16_f32 v35, v134, v135
    ds_write_b64 v30, v[32:33] offset:480
    ds_write_b64 v30, v[34:35] offset:512
    v_bfe_u32 v20, v2, 2, 2
    v_mul_u32_u24 v20, 4624, v20
    v_and_b32 v21, 3, v2
    v_lshl_add_u32 v20, v21, 3, v20
    v_lshrrev_b32 v21, 4, v2
    v_lshl_add_u32 v20, v21, 5, v20
    s_mul_i32 s45, s36, 1152
    s_add_u32 s45, s45, 36864
    v_add_u32 v20, s45, v20
    v_mul_u32_u24 v21, 65536, v21
    v_and_b32 v22, 15, v2
    v_lshl_add_u32 v21, v22, 4, v21
    s_mul_i32 s45, s36, 2359296
    s_lshr_b32 s46, s2, 2
    s_lshl_b32 s46, s46, 10
    s_add_u32 s45, s45, s46
    s_and_b32 s46, s2, 3
    s_lshl_b32 s46, s46, 8
    s_add_u32 s45, s45, s46
    s_add_u32 s45, s45, 32505856
    s_waitcnt lgkmcnt(0)
    ds_read_b64_tr_b16 v[32:33], v20 offset:0
    ds_read_b64_tr_b16 v[34:35], v20 offset:18496
    ds_read_b64_tr_b16 v[36:37], v20 offset:128
    ds_read_b64_tr_b16 v[38:39], v20 offset:18624
    ds_read_b64_tr_b16 v[40:41], v20 offset:256
    ds_read_b64_tr_b16 v[42:43], v20 offset:18752
    ds_read_b64_tr_b16 v[44:45], v20 offset:384
    ds_read_b64_tr_b16 v[46:47], v20 offset:18880
    ds_read_b64_tr_b16 v[48:49], v20 offset:512
    ds_read_b64_tr_b16 v[50:51], v20 offset:19008
    ds_read_b64_tr_b16 v[52:53], v20 offset:640
    ds_read_b64_tr_b16 v[54:55], v20 offset:19136
    ds_read_b64_tr_b16 v[56:57], v20 offset:768
    ds_read_b64_tr_b16 v[58:59], v20 offset:19264
    ds_read_b64_tr_b16 v[60:61], v20 offset:896
    ds_read_b64_tr_b16 v[62:63], v20 offset:19392
    ds_read_b64_tr_b16 v[64:65], v20 offset:1024
    ds_read_b64_tr_b16 v[66:67], v20 offset:19520
    s_waitcnt lgkmcnt(15)
    s_add_u32 s46, s45, 0
    buffer_store_dwordx4 v[32:35], v21, s[24:27], s46 offen sc1
    s_waitcnt lgkmcnt(14)
    s_add_u32 s46, s45, 262144
    buffer_store_dwordx4 v[36:39], v21, s[24:27], s46 offen sc1
    s_waitcnt lgkmcnt(12)
    s_add_u32 s46, s45, 524288
    buffer_store_dwordx4 v[40:43], v21, s[24:27], s46 offen sc1
    s_waitcnt lgkmcnt(10)
    s_add_u32 s46, s45, 786432
    buffer_store_dwordx4 v[44:47], v21, s[24:27], s46 offen sc1
    s_waitcnt lgkmcnt(8)
    s_add_u32 s46, s45, 1048576
    buffer_store_dwordx4 v[48:51], v21, s[24:27], s46 offen sc1
    s_waitcnt lgkmcnt(6)
    s_add_u32 s46, s45, 1310720
    buffer_store_dwordx4 v[52:55], v21, s[24:27], s46 offen sc1
    s_waitcnt lgkmcnt(4)
    s_add_u32 s46, s45, 1572864
    buffer_store_dwordx4 v[56:59], v21, s[24:27], s46 offen sc1
    s_waitcnt lgkmcnt(2)
    s_add_u32 s46, s45, 1835008
    buffer_store_dwordx4 v[60:63], v21, s[24:27], s46 offen sc1
    s_waitcnt lgkmcnt(0)
    s_add_u32 s46, s45, 2097152
    buffer_store_dwordx4 v[64:67], v21, s[24:27], s46 offen sc1
    s_barrier
    v_mov_b64 v[16:17], 0
    v_mov_b64 v[18:19], 0
    v_mov_b64 v[20:21], 0
    v_mov_b64 v[22:23], 0
    v_mov_b64 v[24:25], 0
    v_mov_b64 v[26:27], 0
    v_mov_b64 v[28:29], 0
    v_mov_b64 v[30:31], 0
    v_mov_b64 v[32:33], 0
    v_mov_b64 v[34:35], 0
    v_mov_b64 v[36:37], 0
    v_mov_b64 v[38:39], 0
    v_mov_b64 v[40:41], 0
    v_mov_b64 v[42:43], 0
    v_mov_b64 v[44:45], 0
    v_mov_b64 v[46:47], 0
    v_mov_b64 v[48:49], 0
    v_mov_b64 v[50:51], 0
    v_mov_b64 v[52:53], 0
    v_mov_b64 v[54:55], 0
    v_mov_b64 v[56:57], 0
    v_mov_b64 v[58:59], 0
    v_mov_b64 v[60:61], 0
    v_mov_b64 v[62:63], 0
    v_mov_b64 v[64:65], 0
    v_mov_b64 v[66:67], 0
    v_mov_b64 v[68:69], 0
    v_mov_b64 v[70:71], 0
    v_mov_b64 v[72:73], 0
    v_mov_b64 v[74:75], 0
    v_mov_b64 v[76:77], 0
    v_mov_b64 v[78:79], 0
    v_mov_b64 v[80:81], 0
    v_mov_b64 v[82:83], 0
    v_mov_b64 v[84:85], 0
    v_mov_b64 v[86:87], 0
    s_setprio 3
    buffer_load_dwordx4 v[168:171], v236, s[24:27], s52 offen offset:0
    buffer_load_dwordx4 v[172:175], v244, s[24:27], s52 offen offset:0
    buffer_load_dwordx4 v[176:179], v236, s[24:27], s52 offen offset:1024
    buffer_load_dwordx4 v[180:183], v244, s[24:27], s52 offen offset:1024
    s_add_u32 s52, s52, 2048
    s_add_u32 m0, s57, 36864
    s_nop 0
    buffer_load_dwordx4 v239, s[24:27], s53 offen lds
    s_add_u32 m0, s57, 40960
    s_nop 0
    buffer_load_dwordx4 v240, s[24:27], s53 offen lds
    s_add_u32 m0, s57, 45056
    s_nop 0
    buffer_load_dwordx4 v241, s[24:27], s53 offen lds
    s_add_u32 m0, s57, 49152
    s_nop 0
    buffer_load_dwordx4 v242, s[24:27], s53 offen lds
    s_cmp_ge_u32 s36, 2
    s_cbranch_scc1 L_k2sp_sk_3
    s_add_u32 m0, s57, 53248
    s_nop 0
    buffer_load_dwordx4 v243, s[24:27], s53 offen lds
L_k2sp_sk_3:
    s_add_u32 s53, s53, 2048
    s_waitcnt vmcnt(25)
    s_barrier
    ds_read_b128 v[200:203], v236 offset:0
    ds_read_b128 v[204:207], v236 offset:2048
    ds_read_b128 v[208:211], v236 offset:4096
    ds_read_b128 v[212:215], v236 offset:6144
    s_add_u32 m0, s57, 55296
    s_nop 0
    buffer_load_dwordx4 v239, s[24:27], s53 offen lds
    s_add_u32 m0, s57, 59392
    s_nop 0
    buffer_load_dwordx4 v240, s[24:27], s53 offen lds
    s_waitcnt lgkmcnt(3)
    s_mov_b32 s55, 0
L_k2sp_z1_loop:
    v_mfma_f32_16x16x32_bf16 v[16:19], v[200:203], v[136:139], v[16:19]
    ds_read_b128 v[216:219], v236 offset:8192
    v_mfma_f32_16x16x32_bf16 v[20:23], v[200:203], v[140:143], v[20:23]
    s_add_u32 m0, s57, 63488
    s_nop 0
    buffer_load_dwordx4 v241, s[24:27], s53 offen lds
    ds_read_b128 v[220:223], v236 offset:10240
    s_waitcnt lgkmcnt(4)
    v_mfma_f32_16x16x32_bf16 v[24:27], v[204:207], v[136:139], v[24:27]
    ds_read_b128 v[224:227], v236 offset:12288
    v_mfma_f32_16x16x32_bf16 v[28:31], v[204:207], v[140:143], v[28:31]
    s_waitcnt lgkmcnt(4)
    v_mfma_f32_16x16x32_bf16 v[32:35], v[208:211], v[136:139], v[32:35]
    ds_read_b128 v[228:231], v236 offset:14336
    v_mfma_f32_16x16x32_bf16 v[36:39], v[208:211], v[140:143], v[36:39]
    s_add_u32 m0, s57, 67584
    s_nop 0
    buffer_load_dwordx4 v242, s[24:27], s53 offen lds
    s_waitcnt lgkmcnt(4)
    v_mfma_f32_16x16x32_bf16 v[40:43], v[212:215], v[136:139], v[40:43]
    ds_read_b128 v[232:235], v236 offset:16384
    ds_read_b128 v[200:203], v236 offset:1024
    v_mfma_f32_16x16x32_bf16 v[44:47], v[212:215], v[140:143], v[44:47]
    s_waitcnt lgkmcnt(5)
    v_mfma_f32_16x16x32_bf16 v[48:51], v[216:219], v[136:139], v[48:51]
    ds_read_b128 v[204:207], v236 offset:3072
    v_mfma_f32_16x16x32_bf16 v[52:55], v[216:219], v[140:143], v[52:55]
    s_cmp_ge_u32 s36, 2
    s_cbranch_scc1 L_k2sp_sk_4
    s_add_u32 m0, s57, 71680
    s_nop 0
    buffer_load_dwordx4 v243, s[24:27], s53 offen lds
L_k2sp_sk_4:
    s_add_u32 s53, s53, 2048
    s_waitcnt lgkmcnt(5)
    v_mfma_f32_16x16x32_bf16 v[56:59], v[220:223], v[136:139], v[56:59]
    ds_read_b128 v[208:211], v236 offset:5120
    v_mfma_f32_16x16x32_bf16 v[60:63], v[220:223], v[140:143], v[60:63]
    s_waitcnt lgkmcnt(5)
    v_mfma_f32_16x16x32_bf16 v[64:67], v[224:227], v[136:139], v[64:67]
    ds_read_b128 v[212:215], v236 offset:7168
    v_mfma_f32_16x16x32_bf16 v[68:71], v[224:227], v[140:143], v[68:71]
    buffer_load_dwordx4 v[184:187], v236, s[24:27], s52 offen offset:0
    ds_read_b128 v[216:219], v236 offset:9216
    s_waitcnt lgkmcnt(6)
    v_mfma_f32_16x16x32_bf16 v[72:75], v[228:231], v[136:139], v[72:75]
    ds_read_b128 v[220:223], v236 offset:11264
    v_mfma_f32_16x16x32_bf16 v[76:79], v[228:231], v[140:143], v[76:79]
    s_waitcnt lgkmcnt(6)
    v_mfma_f32_16x16x32_bf16 v[80:83], v[232:235], v[136:139], v[80:83]
    ds_read_b128 v[224:227], v236 offset:13312
    v_mfma_f32_16x16x32_bf16 v[84:87], v[232:235], v[140:143], v[84:87]
    buffer_load_dwordx4 v[188:191], v244, s[24:27], s52 offen offset:0
    s_waitcnt lgkmcnt(6)
    v_mfma_f32_16x16x32_bf16 v[16:19], v[200:203], v[144:147], v[16:19]
    ds_read_b128 v[228:231], v236 offset:15360
    v_mfma_f32_16x16x32_bf16 v[20:23], v[200:203], v[148:151], v[20:23]
    s_waitcnt lgkmcnt(6)
    v_mfma_f32_16x16x32_bf16 v[24:27], v[204:207], v[144:147], v[24:27]
    ds_read_b128 v[232:235], v236 offset:17408
    v_mfma_f32_16x16x32_bf16 v[28:31], v[204:207], v[148:151], v[28:31]
    buffer_load_dwordx4 v[192:195], v236, s[24:27], s52 offen offset:1024
    s_waitcnt lgkmcnt(6)
    v_mfma_f32_16x16x32_bf16 v[32:35], v[208:211], v[144:147], v[32:35]
    v_mfma_f32_16x16x32_bf16 v[36:39], v[208:211], v[148:151], v[36:39]
    s_waitcnt lgkmcnt(5)
    v_mfma_f32_16x16x32_bf16 v[40:43], v[212:215], v[144:147], v[40:43]
    v_mfma_f32_16x16x32_bf16 v[44:47], v[212:215], v[148:151], v[44:47]
    buffer_load_dwordx4 v[196:199], v244, s[24:27], s52 offen offset:1024
    s_add_u32 s52, s52, 2048
    s_waitcnt lgkmcnt(4)
    v_mfma_f32_16x16x32_bf16 v[48:51], v[216:219], v[144:147], v[48:51]
    v_mfma_f32_16x16x32_bf16 v[52:55], v[216:219], v[148:151], v[52:55]
    s_waitcnt lgkmcnt(0)
    s_waitcnt vmcnt(16)
    s_barrier
    ds_read_b128 v[200:203], v236 offset:18432
    ds_read_b128 v[204:207], v236 offset:20480
    ds_read_b128 v[208:211], v236 offset:22528
    ds_read_b128 v[212:215], v236 offset:24576
    s_and_b32 s89, s2, 7
    s_cmp_lg_u32 s36, 0
    s_cbranch_scc1 L_k2a_arr_5
    s_lshl_b32 s90, s89, 8
    s_add_u32 s90, s90, 55312384
    v_mov_b32 v124, 1
    v_mov_b32 v125, 0
    v_mov_b32 v126, 1073741824
    v_cmp_eq_u32 vcc, 0, v2
    s_nop 1
    v_cndmask_b32 v125, v126, v125, vcc
    buffer_atomic_add v124, v125, s[24:27], s90 offen sc1
L_k2a_arr_5:
    v_mfma_f32_16x16x32_bf16 v[56:59], v[220:223], v[144:147], v[56:59]
    v_mfma_f32_16x16x32_bf16 v[60:63], v[220:223], v[148:151], v[60:63]
    s_add_u32 m0, s57, 0
    s_nop 0
    buffer_load_dwordx4 v239, s[24:27], s53 offen lds
    v_mfma_f32_16x16x32_bf16 v[64:67], v[224:227], v[144:147], v[64:67]
    v_mfma_f32_16x16x32_bf16 v[68:71], v[224:227], v[148:151], v[68:71]
    v_mfma_f32_16x16x32_bf16 v[72:75], v[228:231], v[144:147], v[72:75]
    v_mfma_f32_16x16x32_bf16 v[76:79], v[228:231], v[148:151], v[76:79]
    s_add_u32 m0, s57, 4096
    s_nop 0
    buffer_load_dwordx4 v240, s[24:27], s53 offen lds
    v_mfma_f32_16x16x32_bf16 v[80:83], v[232:235], v[144:147], v[80:83]
    v_mfma_f32_16x16x32_bf16 v[84:87], v[232:235], v[148:151], v[84:87]
    s_waitcnt lgkmcnt(3)
    v_mfma_f32_16x16x32_bf16 v[16:19], v[200:203], v[152:155], v[16:19]
    ds_read_b128 v[216:219], v236 offset:26624
    v_mfma_f32_16x16x32_bf16 v[20:23], v[200:203], v[156:159], v[20:23]
    s_add_u32 m0, s57, 8192
    s_nop 0
    buffer_load_dwordx4 v241, s[24:27], s53 offen lds
    ds_read_b128 v[220:223], v236 offset:28672
    s_waitcnt lgkmcnt(4)
    v_mfma_f32_16x16x32_bf16 v[24:27], v[204:207], v[152:155], v[24:27]
    ds_read_b128 v[224:227], v236 offset:30720
    v_mfma_f32_16x16x32_bf16 v[28:31], v[204:207], v[156:159], v[28:31]
    s_waitcnt lgkmcnt(4)
    v_mfma_f32_16x16x32_bf16 v[32:35], v[208:211], v[152:155], v[32:35]
    ds_read_b128 v[228:231], v236 offset:32768
    v_mfma_f32_16x16x32_bf16 v[36:39], v[208:211], v[156:159], v[36:39]
    s_add_u32 m0, s57, 12288
    s_nop 0
    buffer_load_dwordx4 v242, s[24:27], s53 offen lds
    s_waitcnt lgkmcnt(4)
    v_mfma_f32_16x16x32_bf16 v[40:43], v[212:215], v[152:155], v[40:43]
    ds_read_b128 v[232:235], v236 offset:34816
    ds_read_b128 v[200:203], v236 offset:19456
    v_mfma_f32_16x16x32_bf16 v[44:47], v[212:215], v[156:159], v[44:47]
    s_waitcnt lgkmcnt(5)
    v_mfma_f32_16x16x32_bf16 v[48:51], v[216:219], v[152:155], v[48:51]
    ds_read_b128 v[204:207], v236 offset:21504
    v_mfma_f32_16x16x32_bf16 v[52:55], v[216:219], v[156:159], v[52:55]
    s_cmp_ge_u32 s36, 2
    s_cbranch_scc1 L_k2sp_sk_6
    s_add_u32 m0, s57, 16384
    s_nop 0
    buffer_load_dwordx4 v243, s[24:27], s53 offen lds
L_k2sp_sk_6:
    s_add_u32 s53, s53, 2048
    s_waitcnt lgkmcnt(5)
    v_mfma_f32_16x16x32_bf16 v[56:59], v[220:223], v[152:155], v[56:59]
    ds_read_b128 v[208:211], v236 offset:23552
    v_mfma_f32_16x16x32_bf16 v[60:63], v[220:223], v[156:159], v[60:63]
    s_waitcnt lgkmcnt(5)
    v_mfma_f32_16x16x32_bf16 v[64:67], v[224:227], v[152:155], v[64:67]
    ds_read_b128 v[212:215], v236 offset:25600
    v_mfma_f32_16x16x32_bf16 v[68:71], v[224:227], v[156:159], v[68:71]
    buffer_load_dwordx4 v[136:139], v236, s[24:27], s52 offen offset:0
    ds_read_b128 v[216:219], v236 offset:27648
    s_waitcnt lgkmcnt(6)
    v_mfma_f32_16x16x32_bf16 v[72:75], v[228:231], v[152:155], v[72:75]
    ds_read_b128 v[220:223], v236 offset:29696
    v_mfma_f32_16x16x32_bf16 v[76:79], v[228:231], v[156:159], v[76:79]
    s_waitcnt lgkmcnt(6)
    v_mfma_f32_16x16x32_bf16 v[80:83], v[232:235], v[152:155], v[80:83]
    ds_read_b128 v[224:227], v236 offset:31744
    v_mfma_f32_16x16x32_bf16 v[84:87], v[232:235], v[156:159], v[84:87]
    buffer_load_dwordx4 v[140:143], v244, s[24:27], s52 offen offset:0
    s_waitcnt lgkmcnt(6)
    v_mfma_f32_16x16x32_bf16 v[16:19], v[200:203], v[160:163], v[16:19]
    ds_read_b128 v[228:231], v236 offset:33792
    v_mfma_f32_16x16x32_bf16 v[20:23], v[200:203], v[164:167], v[20:23]
    s_waitcnt lgkmcnt(6)
    v_mfma_f32_16x16x32_bf16 v[24:27], v[204:207], v[160:163], v[24:27]
    ds_read_b128 v[232:235], v236 offset:35840
    v_mfma_f32_16x16x32_bf16 v[28:31], v[204:207], v[164:167], v[28:31]
    buffer_load_dwordx4 v[144:147], v236, s[24:27], s52 offen offset:1024
    s_waitcnt lgkmcnt(6)
    v_mfma_f32_16x16x32_bf16 v[32:35], v[208:211], v[160:163], v[32:35]
    v_mfma_f32_16x16x32_bf16 v[36:39], v[208:211], v[164:167], v[36:39]
    s_waitcnt lgkmcnt(5)
    v_mfma_f32_16x16x32_bf16 v[40:43], v[212:215], v[160:163], v[40:43]
    v_mfma_f32_16x16x32_bf16 v[44:47], v[212:215], v[164:167], v[44:47]
    buffer_load_dwordx4 v[148:151], v244, s[24:27], s52 offen offset:1024
    s_add_u32 s52, s52, 2048
    s_waitcnt lgkmcnt(4)
    v_mfma_f32_16x16x32_bf16 v[48:51], v[216:219], v[160:163], v[48:51]
    v_mfma_f32_16x16x32_bf16 v[52:55], v[216:219], v[164:167], v[52:55]
    s_waitcnt lgkmcnt(0)
    s_waitcnt vmcnt(16)
    s_barrier
    ds_read_b128 v[200:203], v237 offset:0
    ds_read_b128 v[204:207], v237 offset:2048
    ds_read_b128 v[208:211], v237 offset:4096
    ds_read_b128 v[212:215], v237 offset:6144
    v_mfma_f32_16x16x32_bf16 v[56:59], v[220:223], v[160:163], v[56:59]
    v_mfma_f32_16x16x32_bf16 v[60:63], v[220:223], v[164:167], v[60:63]
    s_add_u32 m0, s57, 18432
    s_nop 0
    buffer_load_dwordx4 v239, s[24:27], s53 offen lds
    v_mfma_f32_16x16x32_bf16 v[64:67], v[224:227], v[160:163], v[64:67]
    v_mfma_f32_16x16x32_bf16 v[68:71], v[224:227], v[164:167], v[68:71]
    v_mfma_f32_16x16x32_bf16 v[72:75], v[228:231], v[160:163], v[72:75]
    v_mfma_f32_16x16x32_bf16 v[76:79], v[228:231], v[164:167], v[76:79]
    s_add_u32 m0, s57, 22528
    s_nop 0
    buffer_load_dwordx4 v240, s[24:27], s53 offen lds
    v_mfma_f32_16x16x32_bf16 v[80:83], v[232:235], v[160:163], v[80:83]
    v_mfma_f32_16x16x32_bf16 v[84:87], v[232:235], v[164:167], v[84:87]
    s_waitcnt lgkmcnt(3)
    v_mfma_f32_16x16x32_bf16 v[16:19], v[200:203], v[168:171], v[16:19]
    ds_read_b128 v[216:219], v237 offset:8192
    v_mfma_f32_16x16x32_bf16 v[20:23], v[200:203], v[172:175], v[20:23]
    s_add_u32 m0, s57, 26624
    s_nop 0
    buffer_load_dwordx4 v241, s[24:27], s53 offen lds
    ds_read_b128 v[220:223], v237 offset:10240
    s_waitcnt lgkmcnt(4)
    v_mfma_f32_16x16x32_bf16 v[24:27], v[204:207], v[168:171], v[24:27]
    ds_read_b128 v[224:227], v237 offset:12288
    v_mfma_f32_16x16x32_bf16 v[28:31], v[204:207], v[172:175], v[28:31]
    s_waitcnt lgkmcnt(4)
    v_mfma_f32_16x16x32_bf16 v[32:35], v[208:211], v[168:171], v[32:35]
    ds_read_b128 v[228:231], v237 offset:14336
    v_mfma_f32_16x16x32_bf16 v[36:39], v[208:211], v[172:175], v[36:39]
    s_add_u32 m0, s57, 30720
    s_nop 0
    buffer_load_dwordx4 v242, s[24:27], s53 offen lds
    s_waitcnt lgkmcnt(4)
    v_mfma_f32_16x16x32_bf16 v[40:43], v[212:215], v[168:171], v[40:43]
    ds_read_b128 v[232:235], v237 offset:16384
    ds_read_b128 v[200:203], v237 offset:1024
    v_mfma_f32_16x16x32_bf16 v[44:47], v[212:215], v[172:175], v[44:47]
    s_waitcnt lgkmcnt(5)
    v_mfma_f32_16x16x32_bf16 v[48:51], v[216:219], v[168:171], v[48:51]
    ds_read_b128 v[204:207], v237 offset:3072
    v_mfma_f32_16x16x32_bf16 v[52:55], v[216:219], v[172:175], v[52:55]
    s_cmp_ge_u32 s36, 2
    s_cbranch_scc1 L_k2sp_sk_7
    s_add_u32 m0, s57, 34816
    s_nop 0
    buffer_load_dwordx4 v243, s[24:27], s53 offen lds
L_k2sp_sk_7:
    s_add_u32 s53, s53, 2048
    s_waitcnt lgkmcnt(5)
    v_mfma_f32_16x16x32_bf16 v[56:59], v[220:223], v[168:171], v[56:59]
    ds_read_b128 v[208:211], v237 offset:5120
    v_mfma_f32_16x16x32_bf16 v[60:63], v[220:223], v[172:175], v[60:63]
    s_waitcnt lgkmcnt(5)
    v_mfma_f32_16x16x32_bf16 v[64:67], v[224:227], v[168:171], v[64:67]
    ds_read_b128 v[212:215], v237 offset:7168
    v_mfma_f32_16x16x32_bf16 v[68:71], v[224:227], v[172:175], v[68:71]
    buffer_load_dwordx4 v[152:155], v236, s[24:27], s52 offen offset:0
    ds_read_b128 v[216:219], v237 offset:9216
    s_waitcnt lgkmcnt(6)
    v_mfma_f32_16x16x32_bf16 v[72:75], v[228:231], v[168:171], v[72:75]
    ds_read_b128 v[220:223], v237 offset:11264
    v_mfma_f32_16x16x32_bf16 v[76:79], v[228:231], v[172:175], v[76:79]
    s_waitcnt lgkmcnt(6)
    v_mfma_f32_16x16x32_bf16 v[80:83], v[232:235], v[168:171], v[80:83]
    ds_read_b128 v[224:227], v237 offset:13312
    v_mfma_f32_16x16x32_bf16 v[84:87], v[232:235], v[172:175], v[84:87]
    buffer_load_dwordx4 v[156:159], v244, s[24:27], s52 offen offset:0
    s_waitcnt lgkmcnt(6)
    v_mfma_f32_16x16x32_bf16 v[16:19], v[200:203], v[176:179], v[16:19]
    ds_read_b128 v[228:231], v237 offset:15360
    v_mfma_f32_16x16x32_bf16 v[20:23], v[200:203], v[180:183], v[20:23]
    s_waitcnt lgkmcnt(6)
    v_mfma_f32_16x16x32_bf16 v[24:27], v[204:207], v[176:179], v[24:27]
    ds_read_b128 v[232:235], v237 offset:17408
    v_mfma_f32_16x16x32_bf16 v[28:31], v[204:207], v[180:183], v[28:31]
    buffer_load_dwordx4 v[160:163], v236, s[24:27], s52 offen offset:1024
    s_waitcnt lgkmcnt(6)
    v_mfma_f32_16x16x32_bf16 v[32:35], v[208:211], v[176:179], v[32:35]
    v_mfma_f32_16x16x32_bf16 v[36:39], v[208:211], v[180:183], v[36:39]
    s_waitcnt lgkmcnt(5)
    v_mfma_f32_16x16x32_bf16 v[40:43], v[212:215], v[176:179], v[40:43]
    v_mfma_f32_16x16x32_bf16 v[44:47], v[212:215], v[180:183], v[44:47]
    buffer_load_dwordx4 v[164:167], v244, s[24:27], s52 offen offset:1024
    s_add_u32 s52, s52, 2048
    s_waitcnt lgkmcnt(4)
    v_mfma_f32_16x16x32_bf16 v[48:51], v[216:219], v[176:179], v[48:51]
    v_mfma_f32_16x16x32_bf16 v[52:55], v[216:219], v[180:183], v[52:55]
    s_waitcnt lgkmcnt(0)
    s_waitcnt vmcnt(16)
    s_barrier
    ds_read_b128 v[200:203], v237 offset:18432
    ds_read_b128 v[204:207], v237 offset:20480
    ds_read_b128 v[208:211], v237 offset:22528
    ds_read_b128 v[212:215], v237 offset:24576
    v_mfma_f32_16x16x32_bf16 v[56:59], v[220:223], v[176:179], v[56:59]
    v_mfma_f32_16x16x32_bf16 v[60:63], v[220:223], v[180:183], v[60:63]
    s_add_u32 m0, s57, 36864
    s_nop 0
    buffer_load_dwordx4 v239, s[24:27], s53 offen lds
    v_mfma_f32_16x16x32_bf16 v[64:67], v[224:227], v[176:179], v[64:67]
    v_mfma_f32_16x16x32_bf16 v[68:71], v[224:227], v[180:183], v[68:71]
    v_mfma_f32_16x16x32_bf16 v[72:75], v[228:231], v[176:179], v[72:75]
    v_mfma_f32_16x16x32_bf16 v[76:79], v[228:231], v[180:183], v[76:79]
    s_add_u32 m0, s57, 40960
    s_nop 0
    buffer_load_dwordx4 v240, s[24:27], s53 offen lds
    v_mfma_f32_16x16x32_bf16 v[80:83], v[232:235], v[176:179], v[80:83]
    v_mfma_f32_16x16x32_bf16 v[84:87], v[232:235], v[180:183], v[84:87]
    s_waitcnt lgkmcnt(3)
    v_mfma_f32_16x16x32_bf16 v[16:19], v[200:203], v[184:187], v[16:19]
    ds_read_b128 v[216:219], v237 offset:26624
    v_mfma_f32_16x16x32_bf16 v[20:23], v[200:203], v[188:191], v[20:23]
    s_add_u32 m0, s57, 45056
    s_nop 0
    buffer_load_dwordx4 v241, s[24:27], s53 offen lds
    ds_read_b128 v[220:223], v237 offset:28672
    s_waitcnt lgkmcnt(4)
    v_mfma_f32_16x16x32_bf16 v[24:27], v[204:207], v[184:187], v[24:27]
    ds_read_b128 v[224:227], v237 offset:30720
    v_mfma_f32_16x16x32_bf16 v[28:31], v[204:207], v[188:191], v[28:31]
    s_waitcnt lgkmcnt(4)
    v_mfma_f32_16x16x32_bf16 v[32:35], v[208:211], v[184:187], v[32:35]
    ds_read_b128 v[228:231], v237 offset:32768
    v_mfma_f32_16x16x32_bf16 v[36:39], v[208:211], v[188:191], v[36:39]
    s_add_u32 m0, s57, 49152
    s_nop 0
    buffer_load_dwordx4 v242, s[24:27], s53 offen lds
    s_waitcnt lgkmcnt(4)
    v_mfma_f32_16x16x32_bf16 v[40:43], v[212:215], v[184:187], v[40:43]
    ds_read_b128 v[232:235], v237 offset:34816
    ds_read_b128 v[200:203], v237 offset:19456
    v_mfma_f32_16x16x32_bf16 v[44:47], v[212:215], v[188:191], v[44:47]
    s_waitcnt lgkmcnt(5)
    v_mfma_f32_16x16x32_bf16 v[48:51], v[216:219], v[184:187], v[48:51]
    ds_read_b128 v[204:207], v237 offset:21504
    v_mfma_f32_16x16x32_bf16 v[52:55], v[216:219], v[188:191], v[52:55]
    s_cmp_ge_u32 s36, 2
    s_cbranch_scc1 L_k2sp_sk_8
    s_add_u32 m0, s57, 53248
    s_nop 0
    buffer_load_dwordx4 v243, s[24:27], s53 offen lds
L_k2sp_sk_8:
    s_add_u32 s53, s53, 2048
    s_waitcnt lgkmcnt(5)
    v_mfma_f32_16x16x32_bf16 v[56:59], v[220:223], v[184:187], v[56:59]
    ds_read_b128 v[208:211], v237 offset:23552
    v_mfma_f32_16x16x32_bf16 v[60:63], v[220:223], v[188:191], v[60:63]
    s_waitcnt lgkmcnt(5)
    v_mfma_f32_16x16x32_bf16 v[64:67], v[224:227], v[184:187], v[64:67]
    ds_read_b128 v[212:215], v237 offset:25600
    v_mfma_f32_16x16x32_bf16 v[68:71], v[224:227], v[188:191], v[68:71]
    buffer_load_dwordx4 v[168:171], v236, s[24:27], s52 offen offset:0
    ds_read_b128 v[216:219], v237 offset:27648
    s_waitcnt lgkmcnt(6)
    v_mfma_f32_16x16x32_bf16 v[72:75], v[228:231], v[184:187], v[72:75]
    ds_read_b128 v[220:223], v237 offset:29696
    v_mfma_f32_16x16x32_bf16 v[76:79], v[228:231], v[188:191], v[76:79]
    s_waitcnt lgkmcnt(6)
    v_mfma_f32_16x16x32_bf16 v[80:83], v[232:235], v[184:187], v[80:83]
    ds_read_b128 v[224:227], v237 offset:31744
    v_mfma_f32_16x16x32_bf16 v[84:87], v[232:235], v[188:191], v[84:87]
    buffer_load_dwordx4 v[172:175], v244, s[24:27], s52 offen offset:0
    s_waitcnt lgkmcnt(6)
    v_mfma_f32_16x16x32_bf16 v[16:19], v[200:203], v[192:195], v[16:19]
    ds_read_b128 v[228:231], v237 offset:33792
    v_mfma_f32_16x16x32_bf16 v[20:23], v[200:203], v[196:199], v[20:23]
    s_waitcnt lgkmcnt(6)
    v_mfma_f32_16x16x32_bf16 v[24:27], v[204:207], v[192:195], v[24:27]
    ds_read_b128 v[232:235], v237 offset:35840
    v_mfma_f32_16x16x32_bf16 v[28:31], v[204:207], v[196:199], v[28:31]
    buffer_load_dwordx4 v[176:179], v236, s[24:27], s52 offen offset:1024
    s_waitcnt lgkmcnt(6)
    v_mfma_f32_16x16x32_bf16 v[32:35], v[208:211], v[192:195], v[32:35]
    v_mfma_f32_16x16x32_bf16 v[36:39], v[208:211], v[196:199], v[36:39]
    s_waitcnt lgkmcnt(5)
    v_mfma_f32_16x16x32_bf16 v[40:43], v[212:215], v[192:195], v[40:43]
    v_mfma_f32_16x16x32_bf16 v[44:47], v[212:215], v[196:199], v[44:47]
    buffer_load_dwordx4 v[180:183], v244, s[24:27], s52 offen offset:1024
    s_add_u32 s52, s52, 2048
    s_waitcnt lgkmcnt(4)
    v_mfma_f32_16x16x32_bf16 v[48:51], v[216:219], v[192:195], v[48:51]
    v_mfma_f32_16x16x32_bf16 v[52:55], v[216:219], v[196:199], v[52:55]
    s_waitcnt lgkmcnt(0)
    s_waitcnt vmcnt(16)
    s_barrier
    ds_read_b128 v[200:203], v236 offset:0
    ds_read_b128 v[204:207], v236 offset:2048
    ds_read_b128 v[208:211], v236 offset:4096
    ds_read_b128 v[212:215], v236 offset:6144
    v_mfma_f32_16x16x32_bf16 v[56:59], v[220:223], v[192:195], v[56:59]
    v_mfma_f32_16x16x32_bf16 v[60:63], v[220:223], v[196:199], v[60:63]
    s_add_u32 m0, s57, 55296
    s_nop 0
    buffer_load_dwordx4 v239, s[24:27], s53 offen lds
    v_mfma_f32_16x16x32_bf16 v[64:67], v[224:227], v[192:195], v[64:67]
    v_mfma_f32_16x16x32_bf16 v[68:71], v[224:227], v[196:199], v[68:71]
    v_mfma_f32_16x16x32_bf16 v[72:75], v[228:231], v[192:195], v[72:75]
    v_mfma_f32_16x16x32_bf16 v[76:79], v[228:231], v[196:199], v[76:79]
    s_add_u32 m0, s57, 59392
    s_nop 0
    buffer_load_dwordx4 v240, s[24:27], s53 offen lds
    v_mfma_f32_16x16x32_bf16 v[80:83], v[232:235], v[192:195], v[80:83]
    v_mfma_f32_16x16x32_bf16 v[84:87], v[232:235], v[196:199], v[84:87]
    s_waitcnt lgkmcnt(3)
    v_mfma_f32_16x16x32_bf16 v[16:19], v[200:203], v[136:139], v[16:19]
    ds_read_b128 v[216:219], v236 offset:8192
    v_mfma_f32_16x16x32_bf16 v[20:23], v[200:203], v[140:143], v[20:23]
    s_add_u32 m0, s57, 63488
    s_nop 0
    buffer_load_dwordx4 v241, s[24:27], s53 offen lds
    ds_read_b128 v[220:223], v236 offset:10240
    s_waitcnt lgkmcnt(4)
    v_mfma_f32_16x16x32_bf16 v[24:27], v[204:207], v[136:139], v[24:27]
    ds_read_b128 v[224:227], v236 offset:12288
    v_mfma_f32_16x16x32_bf16 v[28:31], v[204:207], v[140:143], v[28:31]
    s_waitcnt lgkmcnt(4)
    v_mfma_f32_16x16x32_bf16 v[32:35], v[208:211], v[136:139], v[32:35]
    ds_read_b128 v[228:231], v236 offset:14336
    v_mfma_f32_16x16x32_bf16 v[36:39], v[208:211], v[140:143], v[36:39]
    s_add_u32 m0, s57, 67584
    s_nop 0
    buffer_load_dwordx4 v242, s[24:27], s53 offen lds
    s_waitcnt lgkmcnt(4)
    v_mfma_f32_16x16x32_bf16 v[40:43], v[212:215], v[136:139], v[40:43]
    ds_read_b128 v[232:235], v236 offset:16384
    ds_read_b128 v[200:203], v236 offset:1024
    v_mfma_f32_16x16x32_bf16 v[44:47], v[212:215], v[140:143], v[44:47]
    s_waitcnt lgkmcnt(5)
    v_mfma_f32_16x16x32_bf16 v[48:51], v[216:219], v[136:139], v[48:51]
    ds_read_b128 v[204:207], v236 offset:3072
    v_mfma_f32_16x16x32_bf16 v[52:55], v[216:219], v[140:143], v[52:55]
    s_cmp_ge_u32 s36, 2
    s_cbranch_scc1 L_k2sp_sk_9
    s_add_u32 m0, s57, 71680
    s_nop 0
    buffer_load_dwordx4 v243, s[24:27], s53 offen lds
L_k2sp_sk_9:
    s_add_u32 s53, s53, 2048
    s_waitcnt lgkmcnt(5)
    v_mfma_f32_16x16x32_bf16 v[56:59], v[220:223], v[136:139], v[56:59]
    ds_read_b128 v[208:211], v236 offset:5120
    v_mfma_f32_16x16x32_bf16 v[60:63], v[220:223], v[140:143], v[60:63]
    s_waitcnt lgkmcnt(5)
    v_mfma_f32_16x16x32_bf16 v[64:67], v[224:227], v[136:139], v[64:67]
    ds_read_b128 v[212:215], v236 offset:7168
    v_mfma_f32_16x16x32_bf16 v[68:71], v[224:227], v[140:143], v[68:71]
    buffer_load_dwordx4 v[184:187], v236, s[24:27], s52 offen offset:0
    ds_read_b128 v[216:219], v236 offset:9216
    s_waitcnt lgkmcnt(6)
    v_mfma_f32_16x16x32_bf16 v[72:75], v[228:231], v[136:139], v[72:75]
    ds_read_b128 v[220:223], v236 offset:11264
    v_mfma_f32_16x16x32_bf16 v[76:79], v[228:231], v[140:143], v[76:79]
    s_waitcnt lgkmcnt(6)
    v_mfma_f32_16x16x32_bf16 v[80:83], v[232:235], v[136:139], v[80:83]
    ds_read_b128 v[224:227], v236 offset:13312
    v_mfma_f32_16x16x32_bf16 v[84:87], v[232:235], v[140:143], v[84:87]
    buffer_load_dwordx4 v[188:191], v244, s[24:27], s52 offen offset:0
    s_waitcnt lgkmcnt(6)
    v_mfma_f32_16x16x32_bf16 v[16:19], v[200:203], v[144:147], v[16:19]
    ds_read_b128 v[228:231], v236 offset:15360
    v_mfma_f32_16x16x32_bf16 v[20:23], v[200:203], v[148:151], v[20:23]
    s_waitcnt lgkmcnt(6)
    v_mfma_f32_16x16x32_bf16 v[24:27], v[204:207], v[144:147], v[24:27]
    ds_read_b128 v[232:235], v236 offset:17408
    v_mfma_f32_16x16x32_bf16 v[28:31], v[204:207], v[148:151], v[28:31]
    buffer_load_dwordx4 v[192:195], v236, s[24:27], s52 offen offset:1024
    s_waitcnt lgkmcnt(6)
    v_mfma_f32_16x16x32_bf16 v[32:35], v[208:211], v[144:147], v[32:35]
    v_mfma_f32_16x16x32_bf16 v[36:39], v[208:211], v[148:151], v[36:39]
    s_waitcnt lgkmcnt(5)
    v_mfma_f32_16x16x32_bf16 v[40:43], v[212:215], v[144:147], v[40:43]
    v_mfma_f32_16x16x32_bf16 v[44:47], v[212:215], v[148:151], v[44:47]
    buffer_load_dwordx4 v[196:199], v244, s[24:27], s52 offen offset:1024
    s_add_u32 s52, s52, 2048
    s_waitcnt lgkmcnt(4)
    v_mfma_f32_16x16x32_bf16 v[48:51], v[216:219], v[144:147], v[48:51]
    v_mfma_f32_16x16x32_bf16 v[52:55], v[216:219], v[148:151], v[52:55]
    s_waitcnt lgkmcnt(0)
    s_waitcnt vmcnt(16)
    s_barrier
    ds_read_b128 v[200:203], v236 offset:18432
    ds_read_b128 v[204:207], v236 offset:20480
    ds_read_b128 v[208:211], v236 offset:22528
    ds_read_b128 v[212:215], v236 offset:24576
    v_mfma_f32_16x16x32_bf16 v[56:59], v[220:223], v[144:147], v[56:59]
    v_mfma_f32_16x16x32_bf16 v[60:63], v[220:223], v[148:151], v[60:63]
    s_add_u32 m0, s57, 0
    s_nop 0
    buffer_load_dwordx4 v239, s[24:27], s53 offen lds
    v_mfma_f32_16x16x32_bf16 v[64:67], v[224:227], v[144:147], v[64:67]
    v_mfma_f32_16x16x32_bf16 v[68:71], v[224:227], v[148:151], v[68:71]
    v_mfma_f32_16x16x32_bf16 v[72:75], v[228:231], v[144:147], v[72:75]
    v_mfma_f32_16x16x32_bf16 v[76:79], v[228:231], v[148:151], v[76:79]
    s_add_u32 m0, s57, 4096
    s_nop 0
    buffer_load_dwordx4 v240, s[24:27], s53 offen lds
    v_mfma_f32_16x16x32_bf16 v[80:83], v[232:235], v[144:147], v[80:83]
    v_mfma_f32_16x16x32_bf16 v[84:87], v[232:235], v[148:151], v[84:87]
    s_waitcnt lgkmcnt(3)
    v_mfma_f32_16x16x32_bf16 v[16:19], v[200:203], v[152:155], v[16:19]
    ds_read_b128 v[216:219], v236 offset:26624
    v_mfma_f32_16x16x32_bf16 v[20:23], v[200:203], v[156:159], v[20:23]
    s_add_u32 m0, s57, 8192
    s_nop 0
    buffer_load_dwordx4 v241, s[24:27], s53 offen lds
    ds_read_b128 v[220:223], v236 offset:28672
    s_waitcnt lgkmcnt(4)
    v_mfma_f32_16x16x32_bf16 v[24:27], v[204:207], v[152:155], v[24:27]
    ds_read_b128 v[224:227], v236 offset:30720
    v_mfma_f32_16x16x32_bf16 v[28:31], v[204:207], v[156:159], v[28:31]
    s_waitcnt lgkmcnt(4)
    v_mfma_f32_16x16x32_bf16 v[32:35], v[208:211], v[152:155], v[32:35]
    ds_read_b128 v[228:231], v236 offset:32768
    v_mfma_f32_16x16x32_bf16 v[36:39], v[208:211], v[156:159], v[36:39]
    s_add_u32 m0, s57, 12288
    s_nop 0
    buffer_load_dwordx4 v242, s[24:27], s53 offen lds
    s_waitcnt lgkmcnt(4)
    v_mfma_f32_16x16x32_bf16 v[40:43], v[212:215], v[152:155], v[40:43]
    ds_read_b128 v[232:235], v236 offset:34816
    ds_read_b128 v[200:203], v236 offset:19456
    v_mfma_f32_16x16x32_bf16 v[44:47], v[212:215], v[156:159], v[44:47]
    s_waitcnt lgkmcnt(5)
    v_mfma_f32_16x16x32_bf16 v[48:51], v[216:219], v[152:155], v[48:51]
    ds_read_b128 v[204:207], v236 offset:21504
    v_mfma_f32_16x16x32_bf16 v[52:55], v[216:219], v[156:159], v[52:55]
    s_cmp_ge_u32 s36, 2
    s_cbranch_scc1 L_k2sp_sk_10
    s_add_u32 m0, s57, 16384
    s_nop 0
    buffer_load_dwordx4 v243, s[24:27], s53 offen lds
L_k2sp_sk_10:
    s_add_u32 s53, s53, 2048
    s_waitcnt lgkmcnt(5)
    v_mfma_f32_16x16x32_bf16 v[56:59], v[220:223], v[152:155], v[56:59]
    ds_read_b128 v[208:211], v236 offset:23552
    v_mfma_f32_16x16x32_bf16 v[60:63], v[220:223], v[156:159], v[60:63]
    s_waitcnt lgkmcnt(5)
    v_mfma_f32_16x16x32_bf16 v[64:67], v[224:227], v[152:155], v[64:67]
    ds_read_b128 v[212:215], v236 offset:25600
    v_mfma_f32_16x16x32_bf16 v[68:71], v[224:227], v[156:159], v[68:71]
    buffer_load_dwordx4 v[136:139], v236, s[24:27], s52 offen offset:0
    ds_read_b128 v[216:219], v236 offset:27648
    s_waitcnt lgkmcnt(6)
    v_mfma_f32_16x16x32_bf16 v[72:75], v[228:231], v[152:155], v[72:75]
    ds_read_b128 v[220:223], v236 offset:29696
    v_mfma_f32_16x16x32_bf16 v[76:79], v[228:231], v[156:159], v[76:79]
    s_waitcnt lgkmcnt(6)
    v_mfma_f32_16x16x32_bf16 v[80:83], v[232:235], v[152:155], v[80:83]
    ds_read_b128 v[224:227], v236 offset:31744
    v_mfma_f32_16x16x32_bf16 v[84:87], v[232:235], v[156:159], v[84:87]
    buffer_load_dwordx4 v[140:143], v244, s[24:27], s52 offen offset:0
    s_waitcnt lgkmcnt(6)
    v_mfma_f32_16x16x32_bf16 v[16:19], v[200:203], v[160:163], v[16:19]
    ds_read_b128 v[228:231], v236 offset:33792
    v_mfma_f32_16x16x32_bf16 v[20:23], v[200:203], v[164:167], v[20:23]
    s_waitcnt lgkmcnt(6)
    v_mfma_f32_16x16x32_bf16 v[24:27], v[204:207], v[160:163], v[24:27]
    ds_read_b128 v[232:235], v236 offset:35840
    v_mfma_f32_16x16x32_bf16 v[28:31], v[204:207], v[164:167], v[28:31]
    buffer_load_dwordx4 v[144:147], v236, s[24:27], s52 offen offset:1024
    s_waitcnt lgkmcnt(6)
    v_mfma_f32_16x16x32_bf16 v[32:35], v[208:211], v[160:163], v[32:35]
    v_mfma_f32_16x16x32_bf16 v[36:39], v[208:211], v[164:167], v[36:39]
    s_waitcnt lgkmcnt(5)
    v_mfma_f32_16x16x32_bf16 v[40:43], v[212:215], v[160:163], v[40:43]
    v_mfma_f32_16x16x32_bf16 v[44:47], v[212:215], v[164:167], v[44:47]
    buffer_load_dwordx4 v[148:151], v244, s[24:27], s52 offen offset:1024
    s_add_u32 s52, s52, 2048
    s_waitcnt lgkmcnt(4)
    v_mfma_f32_16x16x32_bf16 v[48:51], v[216:219], v[160:163], v[48:51]
    v_mfma_f32_16x16x32_bf16 v[52:55], v[216:219], v[164:167], v[52:55]
    s_waitcnt lgkmcnt(0)
    s_waitcnt vmcnt(16)
    s_barrier
    ds_read_b128 v[200:203], v237 offset:0
    ds_read_b128 v[204:207], v237 offset:2048
    ds_read_b128 v[208:211], v237 offset:4096
    ds_read_b128 v[212:215], v237 offset:6144
    v_mfma_f32_16x16x32_bf16 v[56:59], v[220:223], v[160:163], v[56:59]
    v_mfma_f32_16x16x32_bf16 v[60:63], v[220:223], v[164:167], v[60:63]
    v_mfma_f32_16x16x32_bf16 v[64:67], v[224:227], v[160:163], v[64:67]
    v_mfma_f32_16x16x32_bf16 v[68:71], v[224:227], v[164:167], v[68:71]
    v_mfma_f32_16x16x32_bf16 v[72:75], v[228:231], v[160:163], v[72:75]
    v_mfma_f32_16x16x32_bf16 v[76:79], v[228:231], v[164:167], v[76:79]
    v_mfma_f32_16x16x32_bf16 v[80:83], v[232:235], v[160:163], v[80:83]
    v_mfma_f32_16x16x32_bf16 v[84:87], v[232:235], v[164:167], v[84:87]
    s_waitcnt lgkmcnt(3)
    v_mfma_f32_16x16x32_bf16 v[16:19], v[200:203], v[168:171], v[16:19]
    ds_read_b128 v[216:219], v237 offset:8192
    ds_read_b128 v[220:223], v237 offset:10240
    v_mfma_f32_16x16x32_bf16 v[20:23], v[200:203], v[172:175], v[20:23]
    s_waitcnt lgkmcnt(4)
    v_mfma_f32_16x16x32_bf16 v[24:27], v[204:207], v[168:171], v[24:27]
    ds_read_b128 v[224:227], v237 offset:12288
    v_mfma_f32_16x16x32_bf16 v[28:31], v[204:207], v[172:175], v[28:31]
    s_waitcnt lgkmcnt(4)
    v_mfma_f32_16x16x32_bf16 v[32:35], v[208:211], v[168:171], v[32:35]
    ds_read_b128 v[228:231], v237 offset:14336
    v_mfma_f32_16x16x32_bf16 v[36:39], v[208:211], v[172:175], v[36:39]
    s_waitcnt lgkmcnt(4)
    v_mfma_f32_16x16x32_bf16 v[40:43], v[212:215], v[168:171], v[40:43]
    ds_read_b128 v[232:235], v237 offset:16384
    ds_read_b128 v[200:203], v237 offset:1024
    v_mfma_f32_16x16x32_bf16 v[44:47], v[212:215], v[172:175], v[44:47]
    s_waitcnt lgkmcnt(5)
    v_mfma_f32_16x16x32_bf16 v[48:51], v[216:219], v[168:171], v[48:51]
    ds_read_b128 v[204:207], v237 offset:3072
    v_mfma_f32_16x16x32_bf16 v[52:55], v[216:219], v[172:175], v[52:55]
    s_waitcnt lgkmcnt(5)
    v_mfma_f32_16x16x32_bf16 v[56:59], v[220:223], v[168:171], v[56:59]
    ds_read_b128 v[208:211], v237 offset:5120
    v_mfma_f32_16x16x32_bf16 v[60:63], v[220:223], v[172:175], v[60:63]
    s_waitcnt lgkmcnt(5)
    v_mfma_f32_16x16x32_bf16 v[64:67], v[224:227], v[168:171], v[64:67]
    ds_read_b128 v[212:215], v237 offset:7168
    ds_read_b128 v[216:219], v237 offset:9216
    v_mfma_f32_16x16x32_bf16 v[68:71], v[224:227], v[172:175], v[68:71]
    s_waitcnt lgkmcnt(6)
    v_mfma_f32_16x16x32_bf16 v[72:75], v[228:231], v[168:171], v[72:75]
    ds_read_b128 v[220:223], v237 offset:11264
    v_mfma_f32_16x16x32_bf16 v[76:79], v[228:231], v[172:175], v[76:79]
    s_waitcnt lgkmcnt(6)
    v_mfma_f32_16x16x32_bf16 v[80:83], v[232:235], v[168:171], v[80:83]
    ds_read_b128 v[224:227], v237 offset:13312
    v_mfma_f32_16x16x32_bf16 v[84:87], v[232:235], v[172:175], v[84:87]
    s_waitcnt lgkmcnt(6)
    v_mfma_f32_16x16x32_bf16 v[16:19], v[200:203], v[176:179], v[16:19]
    ds_read_b128 v[228:231], v237 offset:15360
    v_mfma_f32_16x16x32_bf16 v[20:23], v[200:203], v[180:183], v[20:23]
    s_waitcnt lgkmcnt(6)
    v_mfma_f32_16x16x32_bf16 v[24:27], v[204:207], v[176:179], v[24:27]
    ds_read_b128 v[232:235], v237 offset:17408
    v_mfma_f32_16x16x32_bf16 v[28:31], v[204:207], v[180:183], v[28:31]
    s_waitcnt lgkmcnt(6)
    v_mfma_f32_16x16x32_bf16 v[32:35], v[208:211], v[176:179], v[32:35]
    v_mfma_f32_16x16x32_bf16 v[36:39], v[208:211], v[180:183], v[36:39]
    s_waitcnt lgkmcnt(5)
    v_mfma_f32_16x16x32_bf16 v[40:43], v[212:215], v[176:179], v[40:43]
    v_mfma_f32_16x16x32_bf16 v[44:47], v[212:215], v[180:183], v[44:47]
    s_waitcnt lgkmcnt(4)
    v_mfma_f32_16x16x32_bf16 v[48:51], v[216:219], v[176:179], v[48:51]
    v_mfma_f32_16x16x32_bf16 v[52:55], v[216:219], v[180:183], v[52:55]
    s_waitcnt lgkmcnt(0)
    s_waitcnt vmcnt(8)
    s_barrier
    ds_read_b128 v[200:203], v237 offset:18432
    ds_read_b128 v[204:207], v237 offset:20480
    ds_read_b128 v[208:211], v237 offset:22528
    ds_read_b128 v[212:215], v237 offset:24576
    v_mfma_f32_16x16x32_bf16 v[56:59], v[220:223], v[176:179], v[56:59]
    v_mfma_f32_16x16x32_bf16 v[60:63], v[220:223], v[180:183], v[60:63]
    v_mfma_f32_16x16x32_bf16 v[64:67], v[224:227], v[176:179], v[64:67]
    v_mfma_f32_16x16x32_bf16 v[68:71], v[224:227], v[180:183], v[68:71]
    v_mfma_f32_16x16x32_bf16 v[72:75], v[228:231], v[176:179], v[72:75]
    v_mfma_f32_16x16x32_bf16 v[76:79], v[228:231], v[180:183], v[76:79]
    v_mfma_f32_16x16x32_bf16 v[80:83], v[232:235], v[176:179], v[80:83]
    v_mfma_f32_16x16x32_bf16 v[84:87], v[232:235], v[180:183], v[84:87]
    s_waitcnt lgkmcnt(3)
    v_mfma_f32_16x16x32_bf16 v[16:19], v[200:203], v[184:187], v[16:19]
    ds_read_b128 v[216:219], v237 offset:26624
    ds_read_b128 v[220:223], v237 offset:28672
    v_mfma_f32_16x16x32_bf16 v[20:23], v[200:203], v[188:191], v[20:23]
    s_waitcnt lgkmcnt(4)
    v_mfma_f32_16x16x32_bf16 v[24:27], v[204:207], v[184:187], v[24:27]
    ds_read_b128 v[224:227], v237 offset:30720
    v_mfma_f32_16x16x32_bf16 v[28:31], v[204:207], v[188:191], v[28:31]
    s_waitcnt lgkmcnt(4)
    v_mfma_f32_16x16x32_bf16 v[32:35], v[208:211], v[184:187], v[32:35]
    ds_read_b128 v[228:231], v237 offset:32768
    v_mfma_f32_16x16x32_bf16 v[36:39], v[208:211], v[188:191], v[36:39]
    s_waitcnt lgkmcnt(4)
    v_mfma_f32_16x16x32_bf16 v[40:43], v[212:215], v[184:187], v[40:43]
    ds_read_b128 v[232:235], v237 offset:34816
    ds_read_b128 v[200:203], v237 offset:19456
    v_mfma_f32_16x16x32_bf16 v[44:47], v[212:215], v[188:191], v[44:47]
    s_waitcnt lgkmcnt(5)
    v_mfma_f32_16x16x32_bf16 v[48:51], v[216:219], v[184:187], v[48:51]
    ds_read_b128 v[204:207], v237 offset:21504
    v_mfma_f32_16x16x32_bf16 v[52:55], v[216:219], v[188:191], v[52:55]
    s_waitcnt lgkmcnt(5)
    v_mfma_f32_16x16x32_bf16 v[56:59], v[220:223], v[184:187], v[56:59]
    ds_read_b128 v[208:211], v237 offset:23552
    v_mfma_f32_16x16x32_bf16 v[60:63], v[220:223], v[188:191], v[60:63]
    s_waitcnt lgkmcnt(5)
    v_mfma_f32_16x16x32_bf16 v[64:67], v[224:227], v[184:187], v[64:67]
    ds_read_b128 v[212:215], v237 offset:25600
    ds_read_b128 v[216:219], v237 offset:27648
    v_mfma_f32_16x16x32_bf16 v[68:71], v[224:227], v[188:191], v[68:71]
    s_waitcnt lgkmcnt(6)
    v_mfma_f32_16x16x32_bf16 v[72:75], v[228:231], v[184:187], v[72:75]
    ds_read_b128 v[220:223], v237 offset:29696
    v_mfma_f32_16x16x32_bf16 v[76:79], v[228:231], v[188:191], v[76:79]
    s_waitcnt lgkmcnt(6)
    v_mfma_f32_16x16x32_bf16 v[80:83], v[232:235], v[184:187], v[80:83]
    ds_read_b128 v[224:227], v237 offset:31744
    v_mfma_f32_16x16x32_bf16 v[84:87], v[232:235], v[188:191], v[84:87]
    s_waitcnt lgkmcnt(6)
    v_mfma_f32_16x16x32_bf16 v[16:19], v[200:203], v[192:195], v[16:19]
    ds_read_b128 v[228:231], v237 offset:33792
    v_mfma_f32_16x16x32_bf16 v[20:23], v[200:203], v[196:199], v[20:23]
    s_waitcnt lgkmcnt(6)
    v_mfma_f32_16x16x32_bf16 v[24:27], v[204:207], v[192:195], v[24:27]
    ds_read_b128 v[232:235], v237 offset:35840
    v_mfma_f32_16x16x32_bf16 v[28:31], v[204:207], v[196:199], v[28:31]
    s_waitcnt lgkmcnt(6)
    v_mfma_f32_16x16x32_bf16 v[32:35], v[208:211], v[192:195], v[32:35]
    v_mfma_f32_16x16x32_bf16 v[36:39], v[208:211], v[196:199], v[36:39]
    s_waitcnt lgkmcnt(5)
    v_mfma_f32_16x16x32_bf16 v[40:43], v[212:215], v[192:195], v[40:43]
    v_mfma_f32_16x16x32_bf16 v[44:47], v[212:215], v[196:199], v[44:47]
    s_waitcnt lgkmcnt(4)
    v_mfma_f32_16x16x32_bf16 v[48:51], v[216:219], v[192:195], v[48:51]
    v_mfma_f32_16x16x32_bf16 v[52:55], v[216:219], v[196:199], v[52:55]
    s_waitcnt lgkmcnt(0)
    s_waitcnt vmcnt(0)
    s_barrier
    ds_read_b128 v[200:203], v236 offset:0
    ds_read_b128 v[204:207], v236 offset:2048
    ds_read_b128 v[208:211], v236 offset:4096
    ds_read_b128 v[212:215], v236 offset:6144
    s_cmp_lg_u32 s36, 0
    s_cbranch_scc1 L_k2e_11
    v_and_b32 v125, 7, v2
    v_lshlrev_b32 v125, 8, v125
    s_mov_b32 s91, 55312384
    buffer_load_dword v124, v125, s[24:27], s91 offen sc1
L_k2e_11:
    v_mfma_f32_16x16x32_bf16 v[56:59], v[220:223], v[192:195], v[56:59]
    v_mfma_f32_16x16x32_bf16 v[60:63], v[220:223], v[196:199], v[60:63]
    v_mfma_f32_16x16x32_bf16 v[64:67], v[224:227], v[192:195], v[64:67]
    v_mfma_f32_16x16x32_bf16 v[68:71], v[224:227], v[196:199], v[68:71]
    v_mfma_f32_16x16x32_bf16 v[72:75], v[228:231], v[192:195], v[72:75]
    v_mfma_f32_16x16x32_bf16 v[76:79], v[228:231], v[196:199], v[76:79]
    v_mfma_f32_16x16x32_bf16 v[80:83], v[232:235], v[192:195], v[80:83]
    v_mfma_f32_16x16x32_bf16 v[84:87], v[232:235], v[196:199], v[84:87]
    s_waitcnt lgkmcnt(3)
    v_mfma_f32_16x16x32_bf16 v[16:19], v[200:203], v[136:139], v[16:19]
    ds_read_b128 v[216:219], v236 offset:8192
    ds_read_b128 v[220:223], v236 offset:10240
    v_mfma_f32_16x16x32_bf16 v[20:23], v[200:203], v[140:143], v[20:23]
    s_waitcnt lgkmcnt(4)
    v_mfma_f32_16x16x32_bf16 v[24:27], v[204:207], v[136:139], v[24:27]
    ds_read_b128 v[224:227], v236 offset:12288
    v_mfma_f32_16x16x32_bf16 v[28:31], v[204:207], v[140:143], v[28:31]
    s_waitcnt lgkmcnt(4)
    v_mfma_f32_16x16x32_bf16 v[32:35], v[208:211], v[136:139], v[32:35]
    ds_read_b128 v[228:231], v236 offset:14336
    v_mfma_f32_16x16x32_bf16 v[36:39], v[208:211], v[140:143], v[36:39]
    s_waitcnt lgkmcnt(4)
    v_mfma_f32_16x16x32_bf16 v[40:43], v[212:215], v[136:139], v[40:43]
    ds_read_b128 v[232:235], v236 offset:16384
    ds_read_b128 v[200:203], v236 offset:1024
    v_mfma_f32_16x16x32_bf16 v[44:47], v[212:215], v[140:143], v[44:47]
    s_waitcnt lgkmcnt(5)
    v_mfma_f32_16x16x32_bf16 v[48:51], v[216:219], v[136:139], v[48:51]
    ds_read_b128 v[204:207], v236 offset:3072
    v_mfma_f32_16x16x32_bf16 v[52:55], v[216:219], v[140:143], v[52:55]
    s_waitcnt lgkmcnt(5)
    v_mfma_f32_16x16x32_bf16 v[56:59], v[220:223], v[136:139], v[56:59]
    ds_read_b128 v[208:211], v236 offset:5120
    v_mfma_f32_16x16x32_bf16 v[60:63], v[220:223], v[140:143], v[60:63]
    s_waitcnt lgkmcnt(5)
    v_mfma_f32_16x16x32_bf16 v[64:67], v[224:227], v[136:139], v[64:67]
    ds_read_b128 v[212:215], v236 offset:7168
    ds_read_b128 v[216:219], v236 offset:9216
    v_mfma_f32_16x16x32_bf16 v[68:71], v[224:227], v[140:143], v[68:71]
    s_waitcnt lgkmcnt(6)
    v_mfma_f32_16x16x32_bf16 v[72:75], v[228:231], v[136:139], v[72:75]
    ds_read_b128 v[220:223], v236 offset:11264
    v_mfma_f32_16x16x32_bf16 v[76:79], v[228:231], v[140:143], v[76:79]
    s_waitcnt lgkmcnt(6)
    v_mfma_f32_16x16x32_bf16 v[80:83], v[232:235], v[136:139], v[80:83]
    ds_read_b128 v[224:227], v236 offset:13312
    v_mfma_f32_16x16x32_bf16 v[84:87], v[232:235], v[140:143], v[84:87]
    s_waitcnt lgkmcnt(6)
    v_mfma_f32_16x16x32_bf16 v[16:19], v[200:203], v[144:147], v[16:19]
    ds_read_b128 v[228:231], v236 offset:15360
    v_mfma_f32_16x16x32_bf16 v[20:23], v[200:203], v[148:151], v[20:23]
    s_waitcnt lgkmcnt(6)
    v_mfma_f32_16x16x32_bf16 v[24:27], v[204:207], v[144:147], v[24:27]
    ds_read_b128 v[232:235], v236 offset:17408
    v_mfma_f32_16x16x32_bf16 v[28:31], v[204:207], v[148:151], v[28:31]
    s_waitcnt lgkmcnt(6)
    v_mfma_f32_16x16x32_bf16 v[32:35], v[208:211], v[144:147], v[32:35]
    v_mfma_f32_16x16x32_bf16 v[36:39], v[208:211], v[148:151], v[36:39]
    s_waitcnt lgkmcnt(5)
    v_mfma_f32_16x16x32_bf16 v[40:43], v[212:215], v[144:147], v[40:43]
    v_mfma_f32_16x16x32_bf16 v[44:47], v[212:215], v[148:151], v[44:47]
    s_waitcnt lgkmcnt(4)
    v_mfma_f32_16x16x32_bf16 v[48:51], v[216:219], v[144:147], v[48:51]
    v_mfma_f32_16x16x32_bf16 v[52:55], v[216:219], v[148:151], v[52:55]
    s_waitcnt lgkmcnt(3)
    v_mfma_f32_16x16x32_bf16 v[56:59], v[220:223], v[144:147], v[56:59]
    v_mfma_f32_16x16x32_bf16 v[60:63], v[220:223], v[148:151], v[60:63]
    s_waitcnt lgkmcnt(2)
    v_mfma_f32_16x16x32_bf16 v[64:67], v[224:227], v[144:147], v[64:67]
    v_mfma_f32_16x16x32_bf16 v[68:71], v[224:227], v[148:151], v[68:71]
    s_waitcnt lgkmcnt(1)
    v_mfma_f32_16x16x32_bf16 v[72:75], v[228:231], v[144:147], v[72:75]
    v_mfma_f32_16x16x32_bf16 v[76:79], v[228:231], v[148:151], v[76:79]
    s_waitcnt lgkmcnt(0)
    v_mfma_f32_16x16x32_bf16 v[80:83], v[232:235], v[144:147], v[80:83]
    v_mfma_f32_16x16x32_bf16 v[84:87], v[232:235], v[148:151], v[84:87]
    s_setprio 3
    s_cmp_lg_u32 s36, 0
    s_cbranch_scc1 L_k2c_12
    s_waitcnt vmcnt(0)
L_k2c_poll_13:
    v_cmp_gt_u32 vcc, 32, v124
    s_nop 1
    s_and_b32 s90, vcc_lo, 255
    s_cmp_eq_u32 s90, 0
    s_cbranch_scc1 L_k2c_poll_13_ok
    s_sleep 16
    buffer_load_dword v124, v125, s[24:27], s91 offen sc1
    s_waitcnt vmcnt(0)
    s_branch L_k2c_poll_13
L_k2c_poll_13_ok:
L_k2c_12:
    s_waitcnt vmcnt(0)
    s_barrier
    v_and_b32 v6, 15, v2
    s_lshl_b32 s44, s56, 4
    v_add_u32 v6, s44, v6
    v_lshlrev_b32 v7, 1, v6
    buffer_load_ushort v128, v7, s[32:35], 0 offen
    buffer_load_ushort v129, v7, s[32:35], 0 offen offset:32
    v_lshlrev_b32 v7, 2, v6
    s_mov_b32 s45, 31457280
    buffer_load_dword v130, v7, s[24:27], s45 offen
    buffer_load_dword v131, v7, s[24:27], s45 offen offset:64
    s_mul_i32 s52, s56, 65536
    s_add_u32 s52, s52, 22020096
    s_mul_i32 s53, s38, 589824
    s_add_u32 s53, s53, 32505856
    v_add_u32 v244, 65536, v236
    buffer_load_dwordx4 v[136:139], v236, s[24:27], s52 offen offset:0 sc1
    buffer_load_dwordx4 v[140:143], v244, s[24:27], s52 offen offset:0 sc1
    buffer_load_dwordx4 v[144:147], v236, s[24:27], s52 offen offset:1024 sc1
    buffer_load_dwordx4 v[148:151], v244, s[24:27], s52 offen offset:1024 sc1
    s_add_u32 s52, s52, 2048
    s_add_u32 m0, s57, 0
    s_nop 0
    buffer_load_dwordx4 v245, s[24:27], s53 offen sc1 lds
    s_add_u32 m0, s57, 4096
    s_nop 0
    buffer_load_dwordx4 v246, s[24:27], s53 offen sc1 lds
    s_add_u32 m0, s57, 8192
    s_nop 0
    buffer_load_dwordx4 v247, s[24:27], s53 offen sc1 lds
    s_add_u32 m0, s57, 12288
    s_nop 0
    buffer_load_dwordx4 v248, s[24:27], s53 offen sc1 lds
    s_cmp_ge_u32 s36, 2
    s_cbranch_scc1 L_k2sp_sk_14
    s_add_u32 m0, s57, 16384
    s_nop 0
    buffer_load_dwordx4 v249, s[24:27], s53 offen sc1 lds
L_k2sp_sk_14:
    s_add_u32 s53, s53, 2048
    buffer_load_dwordx4 v[152:155], v236, s[24:27], s52 offen offset:0 sc1
    buffer_load_dwordx4 v[156:159], v244, s[24:27], s52 offen offset:0 sc1
    buffer_load_dwordx4 v[160:163], v236, s[24:27], s52 offen offset:1024 sc1
    buffer_load_dwordx4 v[164:167], v244, s[24:27], s52 offen offset:1024 sc1
    s_add_u32 s52, s52, 2048
    s_add_u32 m0, s57, 18432
    s_nop 0
    buffer_load_dwordx4 v245, s[24:27], s53 offen sc1 lds
    s_add_u32 m0, s57, 22528
    s_nop 0
    buffer_load_dwordx4 v246, s[24:27], s53 offen sc1 lds
    s_add_u32 m0, s57, 26624
    s_nop 0
    buffer_load_dwordx4 v247, s[24:27], s53 offen sc1 lds
    s_add_u32 m0, s57, 30720
    s_nop 0
    buffer_load_dwordx4 v248, s[24:27], s53 offen sc1 lds
    s_cmp_ge_u32 s36, 2
    s_cbranch_scc1 L_k2sp_sk_15
    s_add_u32 m0, s57, 34816
    s_nop 0
    buffer_load_dwordx4 v249, s[24:27], s53 offen sc1 lds
L_k2sp_sk_15:
    s_add_u32 s53, s53, 2048
    buffer_load_dwordx4 v[168:171], v236, s[24:27], s52 offen offset:0 sc1
    buffer_load_dwordx4 v[172:175], v244, s[24:27], s52 offen offset:0 sc1
    buffer_load_dwordx4 v[176:179], v236, s[24:27], s52 offen offset:1024 sc1
    buffer_load_dwordx4 v[180:183], v244, s[24:27], s52 offen offset:1024 sc1
    s_add_u32 s52, s52, 2048
    s_add_u32 m0, s57, 36864
    s_nop 0
    buffer_load_dwordx4 v245, s[24:27], s53 offen sc1 lds
    s_add_u32 m0, s57, 40960
    s_nop 0
    buffer_load_dwordx4 v246, s[24:27], s53 offen sc1 lds
    s_add_u32 m0, s57, 45056
    s_nop 0
    buffer_load_dwordx4 v247, s[24:27], s53 offen sc1 lds
    s_add_u32 m0, s57, 49152
    s_nop 0
    buffer_load_dwordx4 v248, s[24:27], s53 offen sc1 lds
    s_cmp_ge_u32 s36, 2
    s_cbranch_scc1 L_k2sp_sk_16
    s_add_u32 m0, s57, 53248
    s_nop 0
    buffer_load_dwordx4 v249, s[24:27], s53 offen sc1 lds
L_k2sp_sk_16:
    s_add_u32 s53, s53, 2048
    v_mov_b32 v6, 0xc0135761
    v_mov_b32 v7, 0xc0135761
    s_mov_b32 s50, 0xbdd2d3e8
    s_mov_b32 s51, 0xbdd2d3e8
    v_mov_b32 v8, 1.0
    v_mov_b32 v9, 1.0
    v_pk_mul_f32 v[200:201], v[16:17], v[16:17]
    v_pk_mul_f32 v[202:203], v[18:19], v[18:19]
    v_pk_mul_f32 v[204:205], v[20:21], v[20:21]
    v_pk_mul_f32 v[206:207], v[22:23], v[22:23]
    v_pk_mul_f32 v[208:209], v[24:25], v[24:25]
    v_pk_mul_f32 v[210:211], v[26:27], v[26:27]
    v_pk_fma_f32 v[200:201], v[200:201], s[50:51], v[6:7]
    v_pk_fma_f32 v[202:203], v[202:203], s[50:51], v[6:7]
    v_pk_fma_f32 v[204:205], v[204:205], s[50:51], v[6:7]
    v_pk_fma_f32 v[206:207], v[206:207], s[50:51], v[6:7]
    v_pk_fma_f32 v[208:209], v[208:209], s[50:51], v[6:7]
    v_pk_fma_f32 v[210:211], v[210:211], s[50:51], v[6:7]
    v_pk_mul_f32 v[200:201], v[200:201], v[16:17]
    v_pk_mul_f32 v[202:203], v[202:203], v[18:19]
    v_pk_mul_f32 v[204:205], v[204:205], v[20:21]
    v_pk_mul_f32 v[206:207], v[206:207], v[22:23]
    v_pk_mul_f32 v[208:209], v[208:209], v[24:25]
    v_pk_mul_f32 v[210:211], v[210:211], v[26:27]
    v_exp_f32 v200, v200
    v_exp_f32 v201, v201
    v_exp_f32 v202, v202
    v_exp_f32 v203, v203
    v_exp_f32 v204, v204
    v_exp_f32 v205, v205
    v_exp_f32 v206, v206
    v_exp_f32 v207, v207
    v_exp_f32 v208, v208
    v_exp_f32 v209, v209
    v_exp_f32 v210, v210
    v_exp_f32 v211, v211
    v_pk_add_f32 v[200:201], v[200:201], v[8:9]
    v_pk_add_f32 v[202:203], v[202:203], v[8:9]
    v_pk_add_f32 v[204:205], v[204:205], v[8:9]
    v_pk_add_f32 v[206:207], v[206:207], v[8:9]
    v_pk_add_f32 v[208:209], v[208:209], v[8:9]
    v_pk_add_f32 v[210:211], v[210:211], v[8:9]
    v_rcp_f32 v200, v200
    v_rcp_f32 v201, v201
    v_rcp_f32 v202, v202
    v_rcp_f32 v203, v203
    v_rcp_f32 v204, v204
    v_rcp_f32 v205, v205
    v_rcp_f32 v206, v206
    v_rcp_f32 v207, v207
    v_rcp_f32 v208, v208
    v_rcp_f32 v209, v209
    v_rcp_f32 v210, v210
    v_rcp_f32 v211, v211
    v_pk_mul_f32 v[16:17], v[16:17], v[200:201]
    v_pk_mul_f32 v[18:19], v[18:19], v[202:203]
    v_pk_mul_f32 v[20:21], v[20:21], v[204:205]
    v_pk_mul_f32 v[22:23], v[22:23], v[206:207]
    v_pk_mul_f32 v[24:25], v[24:25], v[208:209]
    v_pk_mul_f32 v[26:27], v[26:27], v[210:211]
    v_pk_mul_f32 v[200:201], v[28:29], v[28:29]
    v_pk_mul_f32 v[202:203], v[30:31], v[30:31]
    v_pk_mul_f32 v[204:205], v[32:33], v[32:33]
    v_pk_mul_f32 v[206:207], v[34:35], v[34:35]
    v_pk_mul_f32 v[208:209], v[36:37], v[36:37]
    v_pk_mul_f32 v[210:211], v[38:39], v[38:39]
    v_pk_fma_f32 v[200:201], v[200:201], s[50:51], v[6:7]
    v_pk_fma_f32 v[202:203], v[202:203], s[50:51], v[6:7]
    v_pk_fma_f32 v[204:205], v[204:205], s[50:51], v[6:7]
    v_pk_fma_f32 v[206:207], v[206:207], s[50:51], v[6:7]
    v_pk_fma_f32 v[208:209], v[208:209], s[50:51], v[6:7]
    v_pk_fma_f32 v[210:211], v[210:211], s[50:51], v[6:7]
    v_pk_mul_f32 v[200:201], v[200:201], v[28:29]
    v_pk_mul_f32 v[202:203], v[202:203], v[30:31]
    v_pk_mul_f32 v[204:205], v[204:205], v[32:33]
    v_pk_mul_f32 v[206:207], v[206:207], v[34:35]
    v_pk_mul_f32 v[208:209], v[208:209], v[36:37]
    v_pk_mul_f32 v[210:211], v[210:211], v[38:39]
    v_exp_f32 v200, v200
    v_exp_f32 v201, v201
    v_exp_f32 v202, v202
    v_exp_f32 v203, v203
    v_exp_f32 v204, v204
    v_exp_f32 v205, v205
    v_exp_f32 v206, v206
    v_exp_f32 v207, v207
    v_exp_f32 v208, v208
    v_exp_f32 v209, v209
    v_exp_f32 v210, v210
    v_exp_f32 v211, v211
    v_pk_add_f32 v[200:201], v[200:201], v[8:9]
    v_pk_add_f32 v[202:203], v[202:203], v[8:9]
    v_pk_add_f32 v[204:205], v[204:205], v[8:9]
    v_pk_add_f32 v[206:207], v[206:207], v[8:9]
    v_pk_add_f32 v[208:209], v[208:209], v[8:9]
    v_pk_add_f32 v[210:211], v[210:211], v[8:9]
    v_rcp_f32 v200, v200
    v_rcp_f32 v201, v201
    v_rcp_f32 v202, v202
    v_rcp_f32 v203, v203
    v_rcp_f32 v204, v204
    v_rcp_f32 v205, v205
    v_rcp_f32 v206, v206
    v_rcp_f32 v207, v207
    v_rcp_f32 v208, v208
    v_rcp_f32 v209, v209
    v_rcp_f32 v210, v210
    v_rcp_f32 v211, v211
    v_pk_mul_f32 v[28:29], v[28:29], v[200:201]
    v_pk_mul_f32 v[30:31], v[30:31], v[202:203]
    v_pk_mul_f32 v[32:33], v[32:33], v[204:205]
    v_pk_mul_f32 v[34:35], v[34:35], v[206:207]
    v_pk_mul_f32 v[36:37], v[36:37], v[208:209]
    v_pk_mul_f32 v[38:39], v[38:39], v[210:211]
    v_pk_mul_f32 v[200:201], v[40:41], v[40:41]
    v_pk_mul_f32 v[202:203], v[42:43], v[42:43]
    v_pk_mul_f32 v[204:205], v[44:45], v[44:45]
    v_pk_mul_f32 v[206:207], v[46:47], v[46:47]
    v_pk_mul_f32 v[208:209], v[48:49], v[48:49]
    v_pk_mul_f32 v[210:211], v[50:51], v[50:51]
    v_pk_fma_f32 v[200:201], v[200:201], s[50:51], v[6:7]
    v_pk_fma_f32 v[202:203], v[202:203], s[50:51], v[6:7]
    v_pk_fma_f32 v[204:205], v[204:205], s[50:51], v[6:7]
    v_pk_fma_f32 v[206:207], v[206:207], s[50:51], v[6:7]
    v_pk_fma_f32 v[208:209], v[208:209], s[50:51], v[6:7]
    v_pk_fma_f32 v[210:211], v[210:211], s[50:51], v[6:7]
    v_pk_mul_f32 v[200:201], v[200:201], v[40:41]
    v_pk_mul_f32 v[202:203], v[202:203], v[42:43]
    v_pk_mul_f32 v[204:205], v[204:205], v[44:45]
    v_pk_mul_f32 v[206:207], v[206:207], v[46:47]
    v_pk_mul_f32 v[208:209], v[208:209], v[48:49]
    v_pk_mul_f32 v[210:211], v[210:211], v[50:51]
    v_exp_f32 v200, v200
    v_exp_f32 v201, v201
    v_exp_f32 v202, v202
    v_exp_f32 v203, v203
    v_exp_f32 v204, v204
    v_exp_f32 v205, v205
    v_exp_f32 v206, v206
    v_exp_f32 v207, v207
    v_exp_f32 v208, v208
    v_exp_f32 v209, v209
    v_exp_f32 v210, v210
    v_exp_f32 v211, v211
    v_pk_add_f32 v[200:201], v[200:201], v[8:9]
    v_pk_add_f32 v[202:203], v[202:203], v[8:9]
    v_pk_add_f32 v[204:205], v[204:205], v[8:9]
    v_pk_add_f32 v[206:207], v[206:207], v[8:9]
    v_pk_add_f32 v[208:209], v[208:209], v[8:9]
    v_pk_add_f32 v[210:211], v[210:211], v[8:9]
    v_rcp_f32 v200, v200
    v_rcp_f32 v201, v201
    v_rcp_f32 v202, v202
    v_rcp_f32 v203, v203
    v_rcp_f32 v204, v204
    v_rcp_f32 v205, v205
    v_rcp_f32 v206, v206
    v_rcp_f32 v207, v207
    v_rcp_f32 v208, v208
    v_rcp_f32 v209, v209
    v_rcp_f32 v210, v210
    v_rcp_f32 v211, v211
    v_pk_mul_f32 v[40:41], v[40:41], v[200:201]
    v_pk_mul_f32 v[42:43], v[42:43], v[202:203]
    v_pk_mul_f32 v[44:45], v[44:45], v[204:205]
    v_pk_mul_f32 v[46:47], v[46:47], v[206:207]
    v_pk_mul_f32 v[48:49], v[48:49], v[208:209]
    v_pk_mul_f32 v[50:51], v[50:51], v[210:211]
    v_pk_mul_f32 v[200:201], v[52:53], v[52:53]
    v_pk_mul_f32 v[202:203], v[54:55], v[54:55]
    v_pk_mul_f32 v[204:205], v[56:57], v[56:57]
    v_pk_mul_f32 v[206:207], v[58:59], v[58:59]
    v_pk_mul_f32 v[208:209], v[60:61], v[60:61]
    v_pk_mul_f32 v[210:211], v[62:63], v[62:63]
    v_pk_fma_f32 v[200:201], v[200:201], s[50:51], v[6:7]
    v_pk_fma_f32 v[202:203], v[202:203], s[50:51], v[6:7]
    v_pk_fma_f32 v[204:205], v[204:205], s[50:51], v[6:7]
    v_pk_fma_f32 v[206:207], v[206:207], s[50:51], v[6:7]
    v_pk_fma_f32 v[208:209], v[208:209], s[50:51], v[6:7]
    v_pk_fma_f32 v[210:211], v[210:211], s[50:51], v[6:7]
    v_pk_mul_f32 v[200:201], v[200:201], v[52:53]
    v_pk_mul_f32 v[202:203], v[202:203], v[54:55]
    v_pk_mul_f32 v[204:205], v[204:205], v[56:57]
    v_pk_mul_f32 v[206:207], v[206:207], v[58:59]
    v_pk_mul_f32 v[208:209], v[208:209], v[60:61]
    v_pk_mul_f32 v[210:211], v[210:211], v[62:63]
    v_exp_f32 v200, v200
    v_exp_f32 v201, v201
    v_exp_f32 v202, v202
    v_exp_f32 v203, v203
    v_exp_f32 v204, v204
    v_exp_f32 v205, v205
    v_exp_f32 v206, v206
    v_exp_f32 v207, v207
    v_exp_f32 v208, v208
    v_exp_f32 v209, v209
    v_exp_f32 v210, v210
    v_exp_f32 v211, v211
    v_pk_add_f32 v[200:201], v[200:201], v[8:9]
    v_pk_add_f32 v[202:203], v[202:203], v[8:9]
    v_pk_add_f32 v[204:205], v[204:205], v[8:9]
    v_pk_add_f32 v[206:207], v[206:207], v[8:9]
    v_pk_add_f32 v[208:209], v[208:209], v[8:9]
    v_pk_add_f32 v[210:211], v[210:211], v[8:9]
    v_rcp_f32 v200, v200
    v_rcp_f32 v201, v201
    v_rcp_f32 v202, v202
    v_rcp_f32 v203, v203
    v_rcp_f32 v204, v204
    v_rcp_f32 v205, v205
    v_rcp_f32 v206, v206
    v_rcp_f32 v207, v207
    v_rcp_f32 v208, v208
    v_rcp_f32 v209, v209
    v_rcp_f32 v210, v210
    v_rcp_f32 v211, v211
    v_pk_mul_f32 v[52:53], v[52:53], v[200:201]
    v_pk_mul_f32 v[54:55], v[54:55], v[202:203]
    v_pk_mul_f32 v[56:57], v[56:57], v[204:205]
    v_pk_mul_f32 v[58:59], v[58:59], v[206:207]
    v_pk_mul_f32 v[60:61], v[60:61], v[208:209]
    v_pk_mul_f32 v[62:63], v[62:63], v[210:211]
    v_pk_mul_f32 v[200:201], v[64:65], v[64:65]
    v_pk_mul_f32 v[202:203], v[66:67], v[66:67]
    v_pk_mul_f32 v[204:205], v[68:69], v[68:69]
    v_pk_mul_f32 v[206:207], v[70:71], v[70:71]
    v_pk_mul_f32 v[208:209], v[72:73], v[72:73]
    v_pk_mul_f32 v[210:211], v[74:75], v[74:75]
    v_pk_fma_f32 v[200:201], v[200:201], s[50:51], v[6:7]
    v_pk_fma_f32 v[202:203], v[202:203], s[50:51], v[6:7]
    v_pk_fma_f32 v[204:205], v[204:205], s[50:51], v[6:7]
    v_pk_fma_f32 v[206:207], v[206:207], s[50:51], v[6:7]
    v_pk_fma_f32 v[208:209], v[208:209], s[50:51], v[6:7]
    v_pk_fma_f32 v[210:211], v[210:211], s[50:51], v[6:7]
    v_pk_mul_f32 v[200:201], v[200:201], v[64:65]
    v_pk_mul_f32 v[202:203], v[202:203], v[66:67]
    v_pk_mul_f32 v[204:205], v[204:205], v[68:69]
    v_pk_mul_f32 v[206:207], v[206:207], v[70:71]
    v_pk_mul_f32 v[208:209], v[208:209], v[72:73]
    v_pk_mul_f32 v[210:211], v[210:211], v[74:75]
    v_exp_f32 v200, v200
    v_exp_f32 v201, v201
    v_exp_f32 v202, v202
    v_exp_f32 v203, v203
    v_exp_f32 v204, v204
    v_exp_f32 v205, v205
    v_exp_f32 v206, v206
    v_exp_f32 v207, v207
    v_exp_f32 v208, v208
    v_exp_f32 v209, v209
    v_exp_f32 v210, v210
    v_exp_f32 v211, v211
    v_pk_add_f32 v[200:201], v[200:201], v[8:9]
    v_pk_add_f32 v[202:203], v[202:203], v[8:9]
    v_pk_add_f32 v[204:205], v[204:205], v[8:9]
    v_pk_add_f32 v[206:207], v[206:207], v[8:9]
    v_pk_add_f32 v[208:209], v[208:209], v[8:9]
    v_pk_add_f32 v[210:211], v[210:211], v[8:9]
    v_rcp_f32 v200, v200
    v_rcp_f32 v201, v201
    v_rcp_f32 v202, v202
    v_rcp_f32 v203, v203
    v_rcp_f32 v204, v204
    v_rcp_f32 v205, v205
    v_rcp_f32 v206, v206
    v_rcp_f32 v207, v207
    v_rcp_f32 v208, v208
    v_rcp_f32 v209, v209
    v_rcp_f32 v210, v210
    v_rcp_f32 v211, v211
    v_pk_mul_f32 v[64:65], v[64:65], v[200:201]
    v_pk_mul_f32 v[66:67], v[66:67], v[202:203]
    v_pk_mul_f32 v[68:69], v[68:69], v[204:205]
    v_pk_mul_f32 v[70:71], v[70:71], v[206:207]
    v_pk_mul_f32 v[72:73], v[72:73], v[208:209]
    v_pk_mul_f32 v[74:75], v[74:75], v[210:211]
    v_pk_mul_f32 v[200:201], v[76:77], v[76:77]
    v_pk_mul_f32 v[202:203], v[78:79], v[78:79]
    v_pk_mul_f32 v[204:205], v[80:81], v[80:81]
    v_pk_mul_f32 v[206:207], v[82:83], v[82:83]
    v_pk_mul_f32 v[208:209], v[84:85], v[84:85]
    v_pk_mul_f32 v[210:211], v[86:87], v[86:87]
    v_pk_fma_f32 v[200:201], v[200:201], s[50:51], v[6:7]
    v_pk_fma_f32 v[202:203], v[202:203], s[50:51], v[6:7]
    v_pk_fma_f32 v[204:205], v[204:205], s[50:51], v[6:7]
    v_pk_fma_f32 v[206:207], v[206:207], s[50:51], v[6:7]
    v_pk_fma_f32 v[208:209], v[208:209], s[50:51], v[6:7]
    v_pk_fma_f32 v[210:211], v[210:211], s[50:51], v[6:7]
    v_pk_mul_f32 v[200:201], v[200:201], v[76:77]
    v_pk_mul_f32 v[202:203], v[202:203], v[78:79]
    v_pk_mul_f32 v[204:205], v[204:205], v[80:81]
    v_pk_mul_f32 v[206:207], v[206:207], v[82:83]
    v_pk_mul_f32 v[208:209], v[208:209], v[84:85]
    v_pk_mul_f32 v[210:211], v[210:211], v[86:87]
    v_exp_f32 v200, v200
    v_exp_f32 v201, v201
    v_exp_f32 v202, v202
    v_exp_f32 v203, v203
    v_exp_f32 v204, v204
    v_exp_f32 v205, v205
    v_exp_f32 v206, v206
    v_exp_f32 v207, v207
    v_exp_f32 v208, v208
    v_exp_f32 v209, v209
    v_exp_f32 v210, v210
    v_exp_f32 v211, v211
    v_pk_add_f32 v[200:201], v[200:201], v[8:9]
    v_pk_add_f32 v[202:203], v[202:203], v[8:9]
    v_pk_add_f32 v[204:205], v[204:205], v[8:9]
    v_pk_add_f32 v[206:207], v[206:207], v[8:9]
    v_pk_add_f32 v[208:209], v[208:209], v[8:9]
    v_pk_add_f32 v[210:211], v[210:211], v[8:9]
    v_rcp_f32 v200, v200
    v_rcp_f32 v201, v201
    v_rcp_f32 v202, v202
    v_rcp_f32 v203, v203
    v_rcp_f32 v204, v204
    v_rcp_f32 v205, v205
    v_rcp_f32 v206, v206
    v_rcp_f32 v207, v207
    v_rcp_f32 v208, v208
    v_rcp_f32 v209, v209
    v_rcp_f32 v210, v210
    v_rcp_f32 v211, v211
    v_pk_mul_f32 v[76:77], v[76:77], v[200:201]
    v_pk_mul_f32 v[78:79], v[78:79], v[202:203]
    v_pk_mul_f32 v[80:81], v[80:81], v[204:205]
    v_pk_mul_f32 v[82:83], v[82:83], v[206:207]
    v_pk_mul_f32 v[84:85], v[84:85], v[208:209]
    v_pk_mul_f32 v[86:87], v[86:87], v[210:211]
    v_cvt_pk_bf16_f32 v88, v16, v17
    v_cvt_pk_bf16_f32 v89, v18, v19
    v_cvt_pk_bf16_f32 v90, v20, v21
    v_cvt_pk_bf16_f32 v91, v22, v23
    v_cvt_pk_bf16_f32 v92, v24, v25
    v_cvt_pk_bf16_f32 v93, v26, v27
    v_cvt_pk_bf16_f32 v94, v28, v29
    v_cvt_pk_bf16_f32 v95, v30, v31
    v_cvt_pk_bf16_f32 v96, v32, v33
    v_cvt_pk_bf16_f32 v97, v34, v35
    v_cvt_pk_bf16_f32 v98, v36, v37
    v_cvt_pk_bf16_f32 v99, v38, v39
    v_cvt_pk_bf16_f32 v100, v40, v41
    v_cvt_pk_bf16_f32 v101, v42, v43
    v_cvt_pk_bf16_f32 v102, v44, v45
    v_cvt_pk_bf16_f32 v103, v46, v47
    v_cvt_pk_bf16_f32 v104, v48, v49
    v_cvt_pk_bf16_f32 v105, v50, v51
    v_cvt_pk_bf16_f32 v106, v52, v53
    v_cvt_pk_bf16_f32 v107, v54, v55
    v_cvt_pk_bf16_f32 v108, v56, v57
    v_cvt_pk_bf16_f32 v109, v58, v59
    v_cvt_pk_bf16_f32 v110, v60, v61
    v_cvt_pk_bf16_f32 v111, v62, v63
    v_cvt_pk_bf16_f32 v112, v64, v65
    v_cvt_pk_bf16_f32 v113, v66, v67
    v_cvt_pk_bf16_f32 v114, v68, v69
    v_cvt_pk_bf16_f32 v115, v70, v71
    v_cvt_pk_bf16_f32 v116, v72, v73
    v_cvt_pk_bf16_f32 v117, v74, v75
    v_cvt_pk_bf16_f32 v118, v76, v77
    v_cvt_pk_bf16_f32 v119, v78, v79
    v_cvt_pk_bf16_f32 v120, v80, v81
    v_cvt_pk_bf16_f32 v121, v82, v83
    v_cvt_pk_bf16_f32 v122, v84, v85
    v_cvt_pk_bf16_f32 v123, v86, v87
    v_mov_b64 v[16:17], 0
    v_mov_b64 v[18:19], 0
    v_mov_b64 v[20:21], 0
    v_mov_b64 v[22:23], 0
    v_mov_b64 v[24:25], 0
    v_mov_b64 v[26:27], 0
    v_mov_b64 v[28:29], 0
    v_mov_b64 v[30:31], 0
    v_mov_b64 v[32:33], 0
    v_mov_b64 v[34:35], 0
    v_mov_b64 v[36:37], 0
    v_mov_b64 v[38:39], 0
    v_mov_b64 v[40:41], 0
    v_mov_b64 v[42:43], 0
    v_mov_b64 v[44:45], 0
    v_mov_b64 v[46:47], 0
    v_mov_b64 v[48:49], 0
    v_mov_b64 v[50:51], 0
    v_mov_b64 v[52:53], 0
    v_mov_b64 v[54:55], 0
    v_mov_b64 v[56:57], 0
    v_mov_b64 v[58:59], 0
    v_mov_b64 v[60:61], 0
    v_mov_b64 v[62:63], 0
    v_mov_b64 v[64:65], 0
    v_mov_b64 v[66:67], 0
    v_mov_b64 v[68:69], 0
    v_mov_b64 v[70:71], 0
    v_mov_b64 v[72:73], 0
    v_mov_b64 v[74:75], 0
    v_mov_b64 v[76:77], 0
    v_mov_b64 v[78:79], 0
    v_mov_b64 v[80:81], 0
    v_mov_b64 v[82:83], 0
    v_mov_b64 v[84:85], 0
    v_mov_b64 v[86:87], 0
    s_setprio 3
    s_waitcnt vmcnt(16)
    s_barrier
    ds_read_b128 v[200:203], v236 offset:0
    ds_read_b128 v[204:207], v236 offset:2048
    ds_read_b128 v[208:211], v236 offset:4096
    ds_read_b128 v[212:215], v236 offset:6144
    s_add_u32 m0, s57, 55296
    s_nop 0
    buffer_load_dwordx4 v245, s[24:27], s53 offen sc1 lds
    s_add_u32 m0, s57, 59392
    s_nop 0
    buffer_load_dwordx4 v246, s[24:27], s53 offen sc1 lds
    s_waitcnt lgkmcnt(3)
    s_mov_b32 s55, 0
.p2align 6
L_k2sp_sp_loop:
    v_mfma_f32_16x16x32_bf16 v[16:19], v[200:203], v[136:139], v[16:19]
    ds_read_b128 v[216:219], v236 offset:8192
    v_mfma_f32_16x16x32_bf16 v[20:23], v[200:203], v[140:143], v[20:23]
    s_add_u32 m0, s57, 63488
    s_nop 0
    buffer_load_dwordx4 v247, s[24:27], s53 offen sc1 lds
    ds_read_b128 v[220:223], v236 offset:10240
    s_waitcnt lgkmcnt(4)
    v_mfma_f32_16x16x32_bf16 v[24:27], v[204:207], v[136:139], v[24:27]
    ds_read_b128 v[224:227], v236 offset:12288
    v_mfma_f32_16x16x32_bf16 v[28:31], v[204:207], v[140:143], v[28:31]
    s_waitcnt lgkmcnt(4)
    v_mfma_f32_16x16x32_bf16 v[32:35], v[208:211], v[136:139], v[32:35]
    ds_read_b128 v[228:231], v236 offset:14336
    v_mfma_f32_16x16x32_bf16 v[36:39], v[208:211], v[140:143], v[36:39]
    s_add_u32 m0, s57, 67584
    s_nop 0
    buffer_load_dwordx4 v248, s[24:27], s53 offen sc1 lds
    s_waitcnt lgkmcnt(4)
    v_mfma_f32_16x16x32_bf16 v[40:43], v[212:215], v[136:139], v[40:43]
    ds_read_b128 v[232:235], v236 offset:16384
    ds_read_b128 v[200:203], v236 offset:1024
    v_mfma_f32_16x16x32_bf16 v[44:47], v[212:215], v[140:143], v[44:47]
    s_waitcnt lgkmcnt(5)
    v_mfma_f32_16x16x32_bf16 v[48:51], v[216:219], v[136:139], v[48:51]
    ds_read_b128 v[204:207], v236 offset:3072
    v_mfma_f32_16x16x32_bf16 v[52:55], v[216:219], v[140:143], v[52:55]
    s_cmp_ge_u32 s36, 2
    s_cbranch_scc1 L_k2sp_sk_17
    s_add_u32 m0, s57, 71680
    s_nop 0
    buffer_load_dwordx4 v249, s[24:27], s53 offen sc1 lds
L_k2sp_sk_17:
    s_add_u32 s53, s53, 2048
    s_waitcnt lgkmcnt(5)
    v_mfma_f32_16x16x32_bf16 v[56:59], v[220:223], v[136:139], v[56:59]
    ds_read_b128 v[208:211], v236 offset:5120
    v_mfma_f32_16x16x32_bf16 v[60:63], v[220:223], v[140:143], v[60:63]
    s_waitcnt lgkmcnt(5)
    v_mfma_f32_16x16x32_bf16 v[64:67], v[224:227], v[136:139], v[64:67]
    ds_read_b128 v[212:215], v236 offset:7168
    v_mfma_f32_16x16x32_bf16 v[68:71], v[224:227], v[140:143], v[68:71]
    buffer_load_dwordx4 v[184:187], v236, s[24:27], s52 offen offset:0 sc1
    ds_read_b128 v[216:219], v236 offset:9216
    s_waitcnt lgkmcnt(6)
    v_mfma_f32_16x16x32_bf16 v[72:75], v[228:231], v[136:139], v[72:75]
    ds_read_b128 v[220:223], v236 offset:11264
    v_mfma_f32_16x16x32_bf16 v[76:79], v[228:231], v[140:143], v[76:79]
    s_waitcnt lgkmcnt(6)
    v_mfma_f32_16x16x32_bf16 v[80:83], v[232:235], v[136:139], v[80:83]
    ds_read_b128 v[224:227], v236 offset:13312
    v_mfma_f32_16x16x32_bf16 v[84:87], v[232:235], v[140:143], v[84:87]
    buffer_load_dwordx4 v[188:191], v244, s[24:27], s52 offen offset:0 sc1
    s_waitcnt lgkmcnt(6)
    v_mfma_f32_16x16x32_bf16 v[16:19], v[200:203], v[144:147], v[16:19]
    ds_read_b128 v[228:231], v236 offset:15360
    v_mfma_f32_16x16x32_bf16 v[20:23], v[200:203], v[148:151], v[20:23]
    s_waitcnt lgkmcnt(6)
    v_mfma_f32_16x16x32_bf16 v[24:27], v[204:207], v[144:147], v[24:27]
    ds_read_b128 v[232:235], v236 offset:17408
    v_mfma_f32_16x16x32_bf16 v[28:31], v[204:207], v[148:151], v[28:31]
    buffer_load_dwordx4 v[192:195], v236, s[24:27], s52 offen offset:1024 sc1
    s_waitcnt lgkmcnt(6)
    v_mfma_f32_16x16x32_bf16 v[32:35], v[208:211], v[144:147], v[32:35]
    v_mfma_f32_16x16x32_bf16 v[36:39], v[208:211], v[148:151], v[36:39]
    s_waitcnt lgkmcnt(5)
    v_mfma_f32_16x16x32_bf16 v[40:43], v[212:215], v[144:147], v[40:43]
    v_mfma_f32_16x16x32_bf16 v[44:47], v[212:215], v[148:151], v[44:47]
    buffer_load_dwordx4 v[196:199], v244, s[24:27], s52 offen offset:1024 sc1
    s_add_u32 s52, s52, 2048
    s_waitcnt lgkmcnt(4)
    v_mfma_f32_16x16x32_bf16 v[48:51], v[216:219], v[144:147], v[48:51]
    v_mfma_f32_16x16x32_bf16 v[52:55], v[216:219], v[148:151], v[52:55]
    s_waitcnt lgkmcnt(0)
    s_waitcnt vmcnt(16)
    s_barrier
    ds_read_b128 v[200:203], v236 offset:18432
    ds_read_b128 v[204:207], v236 offset:20480
    ds_read_b128 v[208:211], v236 offset:22528
    ds_read_b128 v[212:215], v236 offset:24576
    v_mfma_f32_16x16x32_bf16 v[56:59], v[220:223], v[144:147], v[56:59]
    v_mfma_f32_16x16x32_bf16 v[60:63], v[220:223], v[148:151], v[60:63]
    s_add_u32 m0, s57, 0
    s_nop 0
    buffer_load_dwordx4 v245, s[24:27], s53 offen sc1 lds
    v_mfma_f32_16x16x32_bf16 v[64:67], v[224:227], v[144:147], v[64:67]
    v_mfma_f32_16x16x32_bf16 v[68:71], v[224:227], v[148:151], v[68:71]
    v_mfma_f32_16x16x32_bf16 v[72:75], v[228:231], v[144:147], v[72:75]
    v_mfma_f32_16x16x32_bf16 v[76:79], v[228:231], v[148:151], v[76:79]
    s_add_u32 m0, s57, 4096
    s_nop 0
    buffer_load_dwordx4 v246, s[24:27], s53 offen sc1 lds
    v_mfma_f32_16x16x32_bf16 v[80:83], v[232:235], v[144:147], v[80:83]
    v_mfma_f32_16x16x32_bf16 v[84:87], v[232:235], v[148:151], v[84:87]
    s_waitcnt lgkmcnt(3)
    v_mfma_f32_16x16x32_bf16 v[16:19], v[200:203], v[152:155], v[16:19]
    ds_read_b128 v[216:219], v236 offset:26624
    v_mfma_f32_16x16x32_bf16 v[20:23], v[200:203], v[156:159], v[20:23]
    s_add_u32 m0, s57, 8192
    s_nop 0
    buffer_load_dwordx4 v247, s[24:27], s53 offen sc1 lds
    ds_read_b128 v[220:223], v236 offset:28672
    s_waitcnt lgkmcnt(4)
    v_mfma_f32_16x16x32_bf16 v[24:27], v[204:207], v[152:155], v[24:27]
    ds_read_b128 v[224:227], v236 offset:30720
    v_mfma_f32_16x16x32_bf16 v[28:31], v[204:207], v[156:159], v[28:31]
    s_waitcnt lgkmcnt(4)
    v_mfma_f32_16x16x32_bf16 v[32:35], v[208:211], v[152:155], v[32:35]
    ds_read_b128 v[228:231], v236 offset:32768
    v_mfma_f32_16x16x32_bf16 v[36:39], v[208:211], v[156:159], v[36:39]
    s_add_u32 m0, s57, 12288
    s_nop 0
    buffer_load_dwordx4 v248, s[24:27], s53 offen sc1 lds
    s_waitcnt lgkmcnt(4)
    v_mfma_f32_16x16x32_bf16 v[40:43], v[212:215], v[152:155], v[40:43]
    ds_read_b128 v[232:235], v236 offset:34816
    ds_read_b128 v[200:203], v236 offset:19456
    v_mfma_f32_16x16x32_bf16 v[44:47], v[212:215], v[156:159], v[44:47]
    s_waitcnt lgkmcnt(5)
    v_mfma_f32_16x16x32_bf16 v[48:51], v[216:219], v[152:155], v[48:51]
    ds_read_b128 v[204:207], v236 offset:21504
    v_mfma_f32_16x16x32_bf16 v[52:55], v[216:219], v[156:159], v[52:55]
    s_cmp_ge_u32 s36, 2
    s_cbranch_scc1 L_k2sp_sk_18
    s_add_u32 m0, s57, 16384
    s_nop 0
    buffer_load_dwordx4 v249, s[24:27], s53 offen sc1 lds
L_k2sp_sk_18:
    s_add_u32 s53, s53, 2048
    s_waitcnt lgkmcnt(5)
    v_mfma_f32_16x16x32_bf16 v[56:59], v[220:223], v[152:155], v[56:59]
    ds_read_b128 v[208:211], v236 offset:23552
    v_mfma_f32_16x16x32_bf16 v[60:63], v[220:223], v[156:159], v[60:63]
    s_waitcnt lgkmcnt(5)
    v_mfma_f32_16x16x32_bf16 v[64:67], v[224:227], v[152:155], v[64:67]
    ds_read_b128 v[212:215], v236 offset:25600
    v_mfma_f32_16x16x32_bf16 v[68:71], v[224:227], v[156:159], v[68:71]
    buffer_load_dwordx4 v[136:139], v236, s[24:27], s52 offen offset:0 sc1
    ds_read_b128 v[216:219], v236 offset:27648
    s_waitcnt lgkmcnt(6)
    v_mfma_f32_16x16x32_bf16 v[72:75], v[228:231], v[152:155], v[72:75]
    ds_read_b128 v[220:223], v236 offset:29696
    v_mfma_f32_16x16x32_bf16 v[76:79], v[228:231], v[156:159], v[76:79]
    s_waitcnt lgkmcnt(6)
    v_mfma_f32_16x16x32_bf16 v[80:83], v[232:235], v[152:155], v[80:83]
    ds_read_b128 v[224:227], v236 offset:31744
    v_mfma_f32_16x16x32_bf16 v[84:87], v[232:235], v[156:159], v[84:87]
    buffer_load_dwordx4 v[140:143], v244, s[24:27], s52 offen offset:0 sc1
    s_waitcnt lgkmcnt(6)
    v_mfma_f32_16x16x32_bf16 v[16:19], v[200:203], v[160:163], v[16:19]
    ds_read_b128 v[228:231], v236 offset:33792
    v_mfma_f32_16x16x32_bf16 v[20:23], v[200:203], v[164:167], v[20:23]
    s_waitcnt lgkmcnt(6)
    v_mfma_f32_16x16x32_bf16 v[24:27], v[204:207], v[160:163], v[24:27]
    ds_read_b128 v[232:235], v236 offset:35840
    v_mfma_f32_16x16x32_bf16 v[28:31], v[204:207], v[164:167], v[28:31]
    buffer_load_dwordx4 v[144:147], v236, s[24:27], s52 offen offset:1024 sc1
    s_waitcnt lgkmcnt(6)
    v_mfma_f32_16x16x32_bf16 v[32:35], v[208:211], v[160:163], v[32:35]
    v_mfma_f32_16x16x32_bf16 v[36:39], v[208:211], v[164:167], v[36:39]
    s_waitcnt lgkmcnt(5)
    v_mfma_f32_16x16x32_bf16 v[40:43], v[212:215], v[160:163], v[40:43]
    v_mfma_f32_16x16x32_bf16 v[44:47], v[212:215], v[164:167], v[44:47]
    buffer_load_dwordx4 v[148:151], v244, s[24:27], s52 offen offset:1024 sc1
    s_add_u32 s52, s52, 2048
    s_waitcnt lgkmcnt(4)
    v_mfma_f32_16x16x32_bf16 v[48:51], v[216:219], v[160:163], v[48:51]
    v_mfma_f32_16x16x32_bf16 v[52:55], v[216:219], v[164:167], v[52:55]
    s_waitcnt lgkmcnt(0)
    s_waitcnt vmcnt(16)
    s_barrier
    ds_read_b128 v[200:203], v237 offset:0
    ds_read_b128 v[204:207], v237 offset:2048
    ds_read_b128 v[208:211], v237 offset:4096
    ds_read_b128 v[212:215], v237 offset:6144
    v_mfma_f32_16x16x32_bf16 v[56:59], v[220:223], v[160:163], v[56:59]
    v_mfma_f32_16x16x32_bf16 v[60:63], v[220:223], v[164:167], v[60:63]
    s_add_u32 m0, s57, 18432
    s_nop 0
    buffer_load_dwordx4 v245, s[24:27], s53 offen sc1 lds
    v_mfma_f32_16x16x32_bf16 v[64:67], v[224:227], v[160:163], v[64:67]
    v_mfma_f32_16x16x32_bf16 v[68:71], v[224:227], v[164:167], v[68:71]
    v_mfma_f32_16x16x32_bf16 v[72:75], v[228:231], v[160:163], v[72:75]
    v_mfma_f32_16x16x32_bf16 v[76:79], v[228:231], v[164:167], v[76:79]
    s_add_u32 m0, s57, 22528
    s_nop 0
    buffer_load_dwordx4 v246, s[24:27], s53 offen sc1 lds
    v_mfma_f32_16x16x32_bf16 v[80:83], v[232:235], v[160:163], v[80:83]
    v_mfma_f32_16x16x32_bf16 v[84:87], v[232:235], v[164:167], v[84:87]
    s_waitcnt lgkmcnt(3)
    v_mfma_f32_16x16x32_bf16 v[16:19], v[200:203], v[168:171], v[16:19]
    ds_read_b128 v[216:219], v237 offset:8192
    v_mfma_f32_16x16x32_bf16 v[20:23], v[200:203], v[172:175], v[20:23]
    s_add_u32 m0, s57, 26624
    s_nop 0
    buffer_load_dwordx4 v247, s[24:27], s53 offen sc1 lds
    ds_read_b128 v[220:223], v237 offset:10240
    s_waitcnt lgkmcnt(4)
    v_mfma_f32_16x16x32_bf16 v[24:27], v[204:207], v[168:171], v[24:27]
    ds_read_b128 v[224:227], v237 offset:12288
    v_mfma_f32_16x16x32_bf16 v[28:31], v[204:207], v[172:175], v[28:31]
    s_waitcnt lgkmcnt(4)
    v_mfma_f32_16x16x32_bf16 v[32:35], v[208:211], v[168:171], v[32:35]
    ds_read_b128 v[228:231], v237 offset:14336
    v_mfma_f32_16x16x32_bf16 v[36:39], v[208:211], v[172:175], v[36:39]
    s_add_u32 m0, s57, 30720
    s_nop 0
    buffer_load_dwordx4 v248, s[24:27], s53 offen sc1 lds
    s_waitcnt lgkmcnt(4)
    v_mfma_f32_16x16x32_bf16 v[40:43], v[212:215], v[168:171], v[40:43]
    ds_read_b128 v[232:235], v237 offset:16384
    ds_read_b128 v[200:203], v237 offset:1024
    v_mfma_f32_16x16x32_bf16 v[44:47], v[212:215], v[172:175], v[44:47]
    s_waitcnt lgkmcnt(5)
    v_mfma_f32_16x16x32_bf16 v[48:51], v[216:219], v[168:171], v[48:51]
    ds_read_b128 v[204:207], v237 offset:3072
    v_mfma_f32_16x16x32_bf16 v[52:55], v[216:219], v[172:175], v[52:55]
    s_cmp_ge_u32 s36, 2
    s_cbranch_scc1 L_k2sp_sk_19
    s_add_u32 m0, s57, 34816
    s_nop 0
    buffer_load_dwordx4 v249, s[24:27], s53 offen sc1 lds
L_k2sp_sk_19:
    s_add_u32 s53, s53, 2048
    s_waitcnt lgkmcnt(5)
    v_mfma_f32_16x16x32_bf16 v[56:59], v[220:223], v[168:171], v[56:59]
    ds_read_b128 v[208:211], v237 offset:5120
    v_mfma_f32_16x16x32_bf16 v[60:63], v[220:223], v[172:175], v[60:63]
    s_waitcnt lgkmcnt(5)
    v_mfma_f32_16x16x32_bf16 v[64:67], v[224:227], v[168:171], v[64:67]
    ds_read_b128 v[212:215], v237 offset:7168
    v_mfma_f32_16x16x32_bf16 v[68:71], v[224:227], v[172:175], v[68:71]
    buffer_load_dwordx4 v[152:155], v236, s[24:27], s52 offen offset:0 sc1
    ds_read_b128 v[216:219], v237 offset:9216
    s_waitcnt lgkmcnt(6)
    v_mfma_f32_16x16x32_bf16 v[72:75], v[228:231], v[168:171], v[72:75]
    ds_read_b128 v[220:223], v237 offset:11264
    v_mfma_f32_16x16x32_bf16 v[76:79], v[228:231], v[172:175], v[76:79]
    s_waitcnt lgkmcnt(6)
    v_mfma_f32_16x16x32_bf16 v[80:83], v[232:235], v[168:171], v[80:83]
    ds_read_b128 v[224:227], v237 offset:13312
    v_mfma_f32_16x16x32_bf16 v[84:87], v[232:235], v[172:175], v[84:87]
    buffer_load_dwordx4 v[156:159], v244, s[24:27], s52 offen offset:0 sc1
    s_waitcnt lgkmcnt(6)
    v_mfma_f32_16x16x32_bf16 v[16:19], v[200:203], v[176:179], v[16:19]
    ds_read_b128 v[228:231], v237 offset:15360
    v_mfma_f32_16x16x32_bf16 v[20:23], v[200:203], v[180:183], v[20:23]
    s_waitcnt lgkmcnt(6)
    v_mfma_f32_16x16x32_bf16 v[24:27], v[204:207], v[176:179], v[24:27]
    ds_read_b128 v[232:235], v237 offset:17408
    v_mfma_f32_16x16x32_bf16 v[28:31], v[204:207], v[180:183], v[28:31]
    buffer_load_dwordx4 v[160:163], v236, s[24:27], s52 offen offset:1024 sc1
    s_waitcnt lgkmcnt(6)
    v_mfma_f32_16x16x32_bf16 v[32:35], v[208:211], v[176:179], v[32:35]
    v_mfma_f32_16x16x32_bf16 v[36:39], v[208:211], v[180:183], v[36:39]
    s_waitcnt lgkmcnt(5)
    v_mfma_f32_16x16x32_bf16 v[40:43], v[212:215], v[176:179], v[40:43]
    v_mfma_f32_16x16x32_bf16 v[44:47], v[212:215], v[180:183], v[44:47]
    buffer_load_dwordx4 v[164:167], v244, s[24:27], s52 offen offset:1024 sc1
    s_add_u32 s52, s52, 2048
    s_waitcnt lgkmcnt(4)
    v_mfma_f32_16x16x32_bf16 v[48:51], v[216:219], v[176:179], v[48:51]
    v_mfma_f32_16x16x32_bf16 v[52:55], v[216:219], v[180:183], v[52:55]
    s_waitcnt lgkmcnt(0)
    s_waitcnt vmcnt(16)
    s_barrier
    ds_read_b128 v[200:203], v237 offset:18432
    ds_read_b128 v[204:207], v237 offset:20480
    ds_read_b128 v[208:211], v237 offset:22528
    ds_read_b128 v[212:215], v237 offset:24576
    v_mfma_f32_16x16x32_bf16 v[56:59], v[220:223], v[176:179], v[56:59]
    v_mfma_f32_16x16x32_bf16 v[60:63], v[220:223], v[180:183], v[60:63]
    s_add_u32 m0, s57, 36864
    s_nop 0
    buffer_load_dwordx4 v245, s[24:27], s53 offen sc1 lds
    v_mfma_f32_16x16x32_bf16 v[64:67], v[224:227], v[176:179], v[64:67]
    v_mfma_f32_16x16x32_bf16 v[68:71], v[224:227], v[180:183], v[68:71]
    v_mfma_f32_16x16x32_bf16 v[72:75], v[228:231], v[176:179], v[72:75]
    v_mfma_f32_16x16x32_bf16 v[76:79], v[228:231], v[180:183], v[76:79]
    s_add_u32 m0, s57, 40960
    s_nop 0
    buffer_load_dwordx4 v246, s[24:27], s53 offen sc1 lds
    v_mfma_f32_16x16x32_bf16 v[80:83], v[232:235], v[176:179], v[80:83]
    v_mfma_f32_16x16x32_bf16 v[84:87], v[232:235], v[180:183], v[84:87]
    s_waitcnt lgkmcnt(3)
    v_mfma_f32_16x16x32_bf16 v[16:19], v[200:203], v[184:187], v[16:19]
    ds_read_b128 v[216:219], v237 offset:26624
    v_mfma_f32_16x16x32_bf16 v[20:23], v[200:203], v[188:191], v[20:23]
    s_add_u32 m0, s57, 45056
    s_nop 0
    buffer_load_dwordx4 v247, s[24:27], s53 offen sc1 lds
    ds_read_b128 v[220:223], v237 offset:28672
    s_waitcnt lgkmcnt(4)
    v_mfma_f32_16x16x32_bf16 v[24:27], v[204:207], v[184:187], v[24:27]
    ds_read_b128 v[224:227], v237 offset:30720
    v_mfma_f32_16x16x32_bf16 v[28:31], v[204:207], v[188:191], v[28:31]
    s_waitcnt lgkmcnt(4)
    v_mfma_f32_16x16x32_bf16 v[32:35], v[208:211], v[184:187], v[32:35]
    ds_read_b128 v[228:231], v237 offset:32768
    v_mfma_f32_16x16x32_bf16 v[36:39], v[208:211], v[188:191], v[36:39]
    s_add_u32 m0, s57, 49152
    s_nop 0
    buffer_load_dwordx4 v248, s[24:27], s53 offen sc1 lds
    s_waitcnt lgkmcnt(4)
    v_mfma_f32_16x16x32_bf16 v[40:43], v[212:215], v[184:187], v[40:43]
    ds_read_b128 v[232:235], v237 offset:34816
    ds_read_b128 v[200:203], v237 offset:19456
    v_mfma_f32_16x16x32_bf16 v[44:47], v[212:215], v[188:191], v[44:47]
    s_waitcnt lgkmcnt(5)
    v_mfma_f32_16x16x32_bf16 v[48:51], v[216:219], v[184:187], v[48:51]
    ds_read_b128 v[204:207], v237 offset:21504
    v_mfma_f32_16x16x32_bf16 v[52:55], v[216:219], v[188:191], v[52:55]
    s_cmp_ge_u32 s36, 2
    s_cbranch_scc1 L_k2sp_sk_20
    s_add_u32 m0, s57, 53248
    s_nop 0
    buffer_load_dwordx4 v249, s[24:27], s53 offen sc1 lds
L_k2sp_sk_20:
    s_add_u32 s53, s53, 2048
    s_waitcnt lgkmcnt(5)
    v_mfma_f32_16x16x32_bf16 v[56:59], v[220:223], v[184:187], v[56:59]
    ds_read_b128 v[208:211], v237 offset:23552
    v_mfma_f32_16x16x32_bf16 v[60:63], v[220:223], v[188:191], v[60:63]
    s_waitcnt lgkmcnt(5)
    v_mfma_f32_16x16x32_bf16 v[64:67], v[224:227], v[184:187], v[64:67]
    ds_read_b128 v[212:215], v237 offset:25600
    v_mfma_f32_16x16x32_bf16 v[68:71], v[224:227], v[188:191], v[68:71]
    buffer_load_dwordx4 v[168:171], v236, s[24:27], s52 offen offset:0 sc1
    ds_read_b128 v[216:219], v237 offset:27648
    s_waitcnt lgkmcnt(6)
    v_mfma_f32_16x16x32_bf16 v[72:75], v[228:231], v[184:187], v[72:75]
    ds_read_b128 v[220:223], v237 offset:29696
    v_mfma_f32_16x16x32_bf16 v[76:79], v[228:231], v[188:191], v[76:79]
    s_waitcnt lgkmcnt(6)
    v_mfma_f32_16x16x32_bf16 v[80:83], v[232:235], v[184:187], v[80:83]
    ds_read_b128 v[224:227], v237 offset:31744
    v_mfma_f32_16x16x32_bf16 v[84:87], v[232:235], v[188:191], v[84:87]
    buffer_load_dwordx4 v[172:175], v244, s[24:27], s52 offen offset:0 sc1
    s_waitcnt lgkmcnt(6)
    v_mfma_f32_16x16x32_bf16 v[16:19], v[200:203], v[192:195], v[16:19]
    ds_read_b128 v[228:231], v237 offset:33792
    v_mfma_f32_16x16x32_bf16 v[20:23], v[200:203], v[196:199], v[20:23]
    s_waitcnt lgkmcnt(6)
    v_mfma_f32_16x16x32_bf16 v[24:27], v[204:207], v[192:195], v[24:27]
    ds_read_b128 v[232:235], v237 offset:35840
    v_mfma_f32_16x16x32_bf16 v[28:31], v[204:207], v[196:199], v[28:31]
    buffer_load_dwordx4 v[176:179], v236, s[24:27], s52 offen offset:1024 sc1
    s_waitcnt lgkmcnt(6)
    v_mfma_f32_16x16x32_bf16 v[32:35], v[208:211], v[192:195], v[32:35]
    v_mfma_f32_16x16x32_bf16 v[36:39], v[208:211], v[196:199], v[36:39]
    s_waitcnt lgkmcnt(5)
    v_mfma_f32_16x16x32_bf16 v[40:43], v[212:215], v[192:195], v[40:43]
    v_mfma_f32_16x16x32_bf16 v[44:47], v[212:215], v[196:199], v[44:47]
    buffer_load_dwordx4 v[180:183], v244, s[24:27], s52 offen offset:1024 sc1
    s_add_u32 s52, s52, 2048
    s_waitcnt lgkmcnt(4)
    v_mfma_f32_16x16x32_bf16 v[48:51], v[216:219], v[192:195], v[48:51]
    v_mfma_f32_16x16x32_bf16 v[52:55], v[216:219], v[196:199], v[52:55]
    s_waitcnt lgkmcnt(0)
    s_waitcnt vmcnt(16)
    s_barrier
    ds_read_b128 v[200:203], v236 offset:0
    ds_read_b128 v[204:207], v236 offset:2048
    ds_read_b128 v[208:211], v236 offset:4096
    ds_read_b128 v[212:215], v236 offset:6144
    v_mfma_f32_16x16x32_bf16 v[56:59], v[220:223], v[192:195], v[56:59]
    v_mfma_f32_16x16x32_bf16 v[60:63], v[220:223], v[196:199], v[60:63]
    s_add_u32 m0, s57, 55296
    s_nop 0
    buffer_load_dwordx4 v245, s[24:27], s53 offen sc1 lds
    v_mfma_f32_16x16x32_bf16 v[64:67], v[224:227], v[192:195], v[64:67]
    v_mfma_f32_16x16x32_bf16 v[68:71], v[224:227], v[196:199], v[68:71]
    v_mfma_f32_16x16x32_bf16 v[72:75], v[228:231], v[192:195], v[72:75]
    v_mfma_f32_16x16x32_bf16 v[76:79], v[228:231], v[196:199], v[76:79]
    s_add_u32 m0, s57, 59392
    s_nop 0
    buffer_load_dwordx4 v246, s[24:27], s53 offen sc1 lds
    v_mfma_f32_16x16x32_bf16 v[80:83], v[232:235], v[192:195], v[80:83]
    v_mfma_f32_16x16x32_bf16 v[84:87], v[232:235], v[196:199], v[84:87]
    s_waitcnt lgkmcnt(3)
    s_add_u32 s55, s55, 1
    s_cmp_lt_u32 s55, 7
    s_cbranch_scc1 L_k2sp_sp_loop
    v_mfma_f32_16x16x32_bf16 v[16:19], v[200:203], v[136:139], v[16:19]
    ds_read_b128 v[216:219], v236 offset:8192
    v_mfma_f32_16x16x32_bf16 v[20:23], v[200:203], v[140:143], v[20:23]
    s_add_u32 m0, s57, 63488
    s_nop 0
    buffer_load_dwordx4 v247, s[24:27], s53 offen sc1 lds
    ds_read_b128 v[220:223], v236 offset:10240
    s_waitcnt lgkmcnt(4)
    v_mfma_f32_16x16x32_bf16 v[24:27], v[204:207], v[136:139], v[24:27]
    ds_read_b128 v[224:227], v236 offset:12288
    v_mfma_f32_16x16x32_bf16 v[28:31], v[204:207], v[140:143], v[28:31]
    s_waitcnt lgkmcnt(4)
    v_mfma_f32_16x16x32_bf16 v[32:35], v[208:211], v[136:139], v[32:35]
    ds_read_b128 v[228:231], v236 offset:14336
    v_mfma_f32_16x16x32_bf16 v[36:39], v[208:211], v[140:143], v[36:39]
    s_add_u32 m0, s57, 67584
    s_nop 0
    buffer_load_dwordx4 v248, s[24:27], s53 offen sc1 lds
    s_waitcnt lgkmcnt(4)
    v_mfma_f32_16x16x32_bf16 v[40:43], v[212:215], v[136:139], v[40:43]
    ds_read_b128 v[232:235], v236 offset:16384
    ds_read_b128 v[200:203], v236 offset:1024
    v_mfma_f32_16x16x32_bf16 v[44:47], v[212:215], v[140:143], v[44:47]
    s_waitcnt lgkmcnt(5)
    v_mfma_f32_16x16x32_bf16 v[48:51], v[216:219], v[136:139], v[48:51]
    ds_read_b128 v[204:207], v236 offset:3072
    v_mfma_f32_16x16x32_bf16 v[52:55], v[216:219], v[140:143], v[52:55]
    s_cmp_ge_u32 s36, 2
    s_cbranch_scc1 L_k2sp_sk_21
    s_add_u32 m0, s57, 71680
    s_nop 0
    buffer_load_dwordx4 v249, s[24:27], s53 offen sc1 lds
L_k2sp_sk_21:
    s_add_u32 s53, s53, 2048
    s_waitcnt lgkmcnt(5)
    v_mfma_f32_16x16x32_bf16 v[56:59], v[220:223], v[136:139], v[56:59]
    ds_read_b128 v[208:211], v236 offset:5120
    v_mfma_f32_16x16x32_bf16 v[60:63], v[220:223], v[140:143], v[60:63]
    s_waitcnt lgkmcnt(5)
    v_mfma_f32_16x16x32_bf16 v[64:67], v[224:227], v[136:139], v[64:67]
    ds_read_b128 v[212:215], v236 offset:7168
    v_mfma_f32_16x16x32_bf16 v[68:71], v[224:227], v[140:143], v[68:71]
    buffer_load_dwordx4 v[184:187], v236, s[24:27], s52 offen offset:0 sc1
    ds_read_b128 v[216:219], v236 offset:9216
    s_waitcnt lgkmcnt(6)
    v_mfma_f32_16x16x32_bf16 v[72:75], v[228:231], v[136:139], v[72:75]
    ds_read_b128 v[220:223], v236 offset:11264
    v_mfma_f32_16x16x32_bf16 v[76:79], v[228:231], v[140:143], v[76:79]
    s_waitcnt lgkmcnt(6)
    v_mfma_f32_16x16x32_bf16 v[80:83], v[232:235], v[136:139], v[80:83]
    ds_read_b128 v[224:227], v236 offset:13312
    v_mfma_f32_16x16x32_bf16 v[84:87], v[232:235], v[140:143], v[84:87]
    buffer_load_dwordx4 v[188:191], v244, s[24:27], s52 offen offset:0 sc1
    s_waitcnt lgkmcnt(6)
    v_mfma_f32_16x16x32_bf16 v[16:19], v[200:203], v[144:147], v[16:19]
    ds_read_b128 v[228:231], v236 offset:15360
    v_mfma_f32_16x16x32_bf16 v[20:23], v[200:203], v[148:151], v[20:23]
    s_waitcnt lgkmcnt(6)
    v_mfma_f32_16x16x32_bf16 v[24:27], v[204:207], v[144:147], v[24:27]
    ds_read_b128 v[232:235], v236 offset:17408
    v_mfma_f32_16x16x32_bf16 v[28:31], v[204:207], v[148:151], v[28:31]
    buffer_load_dwordx4 v[192:195], v236, s[24:27], s52 offen offset:1024 sc1
    s_waitcnt lgkmcnt(6)
    v_mfma_f32_16x16x32_bf16 v[32:35], v[208:211], v[144:147], v[32:35]
    v_mfma_f32_16x16x32_bf16 v[36:39], v[208:211], v[148:151], v[36:39]
    s_waitcnt lgkmcnt(5)
    v_mfma_f32_16x16x32_bf16 v[40:43], v[212:215], v[144:147], v[40:43]
    v_mfma_f32_16x16x32_bf16 v[44:47], v[212:215], v[148:151], v[44:47]
    buffer_load_dwordx4 v[196:199], v244, s[24:27], s52 offen offset:1024 sc1
    s_add_u32 s52, s52, 2048
    s_waitcnt lgkmcnt(4)
    v_mfma_f32_16x16x32_bf16 v[48:51], v[216:219], v[144:147], v[48:51]
    v_mfma_f32_16x16x32_bf16 v[52:55], v[216:219], v[148:151], v[52:55]
    s_waitcnt lgkmcnt(0)
    s_waitcnt vmcnt(16)
    s_barrier
    ds_read_b128 v[200:203], v236 offset:18432
    ds_read_b128 v[204:207], v236 offset:20480
    ds_read_b128 v[208:211], v236 offset:22528
    ds_read_b128 v[212:215], v236 offset:24576
    v_mfma_f32_16x16x32_bf16 v[56:59], v[220:223], v[144:147], v[56:59]
    v_mfma_f32_16x16x32_bf16 v[60:63], v[220:223], v[148:151], v[60:63]
    v_mfma_f32_16x16x32_bf16 v[64:67], v[224:227], v[144:147], v[64:67]
    v_mfma_f32_16x16x32_bf16 v[68:71], v[224:227], v[148:151], v[68:71]
    v_mfma_f32_16x16x32_bf16 v[72:75], v[228:231], v[144:147], v[72:75]
    v_mfma_f32_16x16x32_bf16 v[76:79], v[228:231], v[148:151], v[76:79]
    v_mfma_f32_16x16x32_bf16 v[80:83], v[232:235], v[144:147], v[80:83]
    v_mfma_f32_16x16x32_bf16 v[84:87], v[232:235], v[148:151], v[84:87]
    s_waitcnt lgkmcnt(3)
    v_mfma_f32_16x16x32_bf16 v[16:19], v[200:203], v[152:155], v[16:19]
    ds_read_b128 v[216:219], v236 offset:26624
    ds_read_b128 v[220:223], v236 offset:28672
    v_mfma_f32_16x16x32_bf16 v[20:23], v[200:203], v[156:159], v[20:23]
    s_waitcnt lgkmcnt(4)
    v_mfma_f32_16x16x32_bf16 v[24:27], v[204:207], v[152:155], v[24:27]
    ds_read_b128 v[224:227], v236 offset:30720
    v_mfma_f32_16x16x32_bf16 v[28:31], v[204:207], v[156:159], v[28:31]
    s_waitcnt lgkmcnt(4)
    v_mfma_f32_16x16x32_bf16 v[32:35], v[208:211], v[152:155], v[32:35]
    ds_read_b128 v[228:231], v236 offset:32768
    v_mfma_f32_16x16x32_bf16 v[36:39], v[208:211], v[156:159], v[36:39]
    s_waitcnt lgkmcnt(4)
    v_mfma_f32_16x16x32_bf16 v[40:43], v[212:215], v[152:155], v[40:43]
    ds_read_b128 v[232:235], v236 offset:34816
    ds_read_b128 v[200:203], v236 offset:19456
    v_mfma_f32_16x16x32_bf16 v[44:47], v[212:215], v[156:159], v[44:47]
    s_waitcnt lgkmcnt(5)
    v_mfma_f32_16x16x32_bf16 v[48:51], v[216:219], v[152:155], v[48:51]
    ds_read_b128 v[204:207], v236 offset:21504
    v_mfma_f32_16x16x32_bf16 v[52:55], v[216:219], v[156:159], v[52:55]
    s_waitcnt lgkmcnt(5)
    v_mfma_f32_16x16x32_bf16 v[56:59], v[220:223], v[152:155], v[56:59]
    ds_read_b128 v[208:211], v236 offset:23552
    v_mfma_f32_16x16x32_bf16 v[60:63], v[220:223], v[156:159], v[60:63]
    s_waitcnt lgkmcnt(5)
    v_mfma_f32_16x16x32_bf16 v[64:67], v[224:227], v[152:155], v[64:67]
    ds_read_b128 v[212:215], v236 offset:25600
    ds_read_b128 v[216:219], v236 offset:27648
    v_mfma_f32_16x16x32_bf16 v[68:71], v[224:227], v[156:159], v[68:71]
    s_waitcnt lgkmcnt(6)
    v_mfma_f32_16x16x32_bf16 v[72:75], v[228:231], v[152:155], v[72:75]
    ds_read_b128 v[220:223], v236 offset:29696
    v_mfma_f32_16x16x32_bf16 v[76:79], v[228:231], v[156:159], v[76:79]
    s_waitcnt lgkmcnt(6)
    v_mfma_f32_16x16x32_bf16 v[80:83], v[232:235], v[152:155], v[80:83]
    ds_read_b128 v[224:227], v236 offset:31744
    v_mfma_f32_16x16x32_bf16 v[84:87], v[232:235], v[156:159], v[84:87]
    s_waitcnt lgkmcnt(6)
    v_mfma_f32_16x16x32_bf16 v[16:19], v[200:203], v[160:163], v[16:19]
    ds_read_b128 v[228:231], v236 offset:33792
    v_mfma_f32_16x16x32_bf16 v[20:23], v[200:203], v[164:167], v[20:23]
    s_waitcnt lgkmcnt(6)
    v_mfma_f32_16x16x32_bf16 v[24:27], v[204:207], v[160:163], v[24:27]
    ds_read_b128 v[232:235], v236 offset:35840
    v_mfma_f32_16x16x32_bf16 v[28:31], v[204:207], v[164:167], v[28:31]
    s_waitcnt lgkmcnt(6)
    v_mfma_f32_16x16x32_bf16 v[32:35], v[208:211], v[160:163], v[32:35]
    v_mfma_f32_16x16x32_bf16 v[36:39], v[208:211], v[164:167], v[36:39]
    s_waitcnt lgkmcnt(5)
    v_mfma_f32_16x16x32_bf16 v[40:43], v[212:215], v[160:163], v[40:43]
    v_mfma_f32_16x16x32_bf16 v[44:47], v[212:215], v[164:167], v[44:47]
    s_waitcnt lgkmcnt(4)
    v_mfma_f32_16x16x32_bf16 v[48:51], v[216:219], v[160:163], v[48:51]
    v_mfma_f32_16x16x32_bf16 v[52:55], v[216:219], v[164:167], v[52:55]
    s_waitcnt lgkmcnt(0)
    s_waitcnt vmcnt(8)
    s_barrier
    ds_read_b128 v[200:203], v237 offset:0
    ds_read_b128 v[204:207], v237 offset:2048
    ds_read_b128 v[208:211], v237 offset:4096
    ds_read_b128 v[212:215], v237 offset:6144
    v_mfma_f32_16x16x32_bf16 v[56:59], v[220:223], v[160:163], v[56:59]
    v_mfma_f32_16x16x32_bf16 v[60:63], v[220:223], v[164:167], v[60:63]
    v_mfma_f32_16x16x32_bf16 v[64:67], v[224:227], v[160:163], v[64:67]
    v_mfma_f32_16x16x32_bf16 v[68:71], v[224:227], v[164:167], v[68:71]
    v_mfma_f32_16x16x32_bf16 v[72:75], v[228:231], v[160:163], v[72:75]
    v_mfma_f32_16x16x32_bf16 v[76:79], v[228:231], v[164:167], v[76:79]
    v_mfma_f32_16x16x32_bf16 v[80:83], v[232:235], v[160:163], v[80:83]
    v_mfma_f32_16x16x32_bf16 v[84:87], v[232:235], v[164:167], v[84:87]
    s_waitcnt lgkmcnt(3)
    v_mfma_f32_16x16x32_bf16 v[16:19], v[200:203], v[168:171], v[16:19]
    ds_read_b128 v[216:219], v237 offset:8192
    ds_read_b128 v[220:223], v237 offset:10240
    v_mfma_f32_16x16x32_bf16 v[20:23], v[200:203], v[172:175], v[20:23]
    s_waitcnt lgkmcnt(4)
    v_mfma_f32_16x16x32_bf16 v[24:27], v[204:207], v[168:171], v[24:27]
    ds_read_b128 v[224:227], v237 offset:12288
    v_mfma_f32_16x16x32_bf16 v[28:31], v[204:207], v[172:175], v[28:31]
    s_waitcnt lgkmcnt(4)
    v_mfma_f32_16x16x32_bf16 v[32:35], v[208:211], v[168:171], v[32:35]
    ds_read_b128 v[228:231], v237 offset:14336
    v_mfma_f32_16x16x32_bf16 v[36:39], v[208:211], v[172:175], v[36:39]
    s_waitcnt lgkmcnt(4)
    v_mfma_f32_16x16x32_bf16 v[40:43], v[212:215], v[168:171], v[40:43]
    ds_read_b128 v[232:235], v237 offset:16384
    ds_read_b128 v[200:203], v237 offset:1024
    v_mfma_f32_16x16x32_bf16 v[44:47], v[212:215], v[172:175], v[44:47]
    s_waitcnt lgkmcnt(5)
    v_mfma_f32_16x16x32_bf16 v[48:51], v[216:219], v[168:171], v[48:51]
    ds_read_b128 v[204:207], v237 offset:3072
    v_mfma_f32_16x16x32_bf16 v[52:55], v[216:219], v[172:175], v[52:55]
    s_waitcnt lgkmcnt(5)
    v_mfma_f32_16x16x32_bf16 v[56:59], v[220:223], v[168:171], v[56:59]
    ds_read_b128 v[208:211], v237 offset:5120
    v_mfma_f32_16x16x32_bf16 v[60:63], v[220:223], v[172:175], v[60:63]
    s_waitcnt lgkmcnt(5)
    v_mfma_f32_16x16x32_bf16 v[64:67], v[224:227], v[168:171], v[64:67]
    ds_read_b128 v[212:215], v237 offset:7168
    ds_read_b128 v[216:219], v237 offset:9216
    v_mfma_f32_16x16x32_bf16 v[68:71], v[224:227], v[172:175], v[68:71]
    s_waitcnt lgkmcnt(6)
    v_mfma_f32_16x16x32_bf16 v[72:75], v[228:231], v[168:171], v[72:75]
    ds_read_b128 v[220:223], v237 offset:11264
    v_mfma_f32_16x16x32_bf16 v[76:79], v[228:231], v[172:175], v[76:79]
    s_waitcnt lgkmcnt(6)
    v_mfma_f32_16x16x32_bf16 v[80:83], v[232:235], v[168:171], v[80:83]
    ds_read_b128 v[224:227], v237 offset:13312
    v_mfma_f32_16x16x32_bf16 v[84:87], v[232:235], v[172:175], v[84:87]
    s_waitcnt lgkmcnt(6)
    v_mfma_f32_16x16x32_bf16 v[16:19], v[200:203], v[176:179], v[16:19]
    ds_read_b128 v[228:231], v237 offset:15360
    v_mfma_f32_16x16x32_bf16 v[20:23], v[200:203], v[180:183], v[20:23]
    s_waitcnt lgkmcnt(6)
    v_mfma_f32_16x16x32_bf16 v[24:27], v[204:207], v[176:179], v[24:27]
    ds_read_b128 v[232:235], v237 offset:17408
    v_mfma_f32_16x16x32_bf16 v[28:31], v[204:207], v[180:183], v[28:31]
    s_waitcnt lgkmcnt(6)
    v_mfma_f32_16x16x32_bf16 v[32:35], v[208:211], v[176:179], v[32:35]
    v_mfma_f32_16x16x32_bf16 v[36:39], v[208:211], v[180:183], v[36:39]
    s_waitcnt lgkmcnt(5)
    v_mfma_f32_16x16x32_bf16 v[40:43], v[212:215], v[176:179], v[40:43]
    v_mfma_f32_16x16x32_bf16 v[44:47], v[212:215], v[180:183], v[44:47]
    s_waitcnt lgkmcnt(4)
    v_mfma_f32_16x16x32_bf16 v[48:51], v[216:219], v[176:179], v[48:51]
    v_mfma_f32_16x16x32_bf16 v[52:55], v[216:219], v[180:183], v[52:55]
    s_waitcnt lgkmcnt(0)
    s_waitcnt vmcnt(0)
    s_barrier
    ds_read_b128 v[200:203], v237 offset:18432
    ds_read_b128 v[204:207], v237 offset:20480
    ds_read_b128 v[208:211], v237 offset:22528
    ds_read_b128 v[212:215], v237 offset:24576
    v_mfma_f32_16x16x32_bf16 v[56:59], v[220:223], v[176:179], v[56:59]
    v_mfma_f32_16x16x32_bf16 v[60:63], v[220:223], v[180:183], v[60:63]
    v_mfma_f32_16x16x32_bf16 v[64:67], v[224:227], v[176:179], v[64:67]
    v_mfma_f32_16x16x32_bf16 v[68:71], v[224:227], v[180:183], v[68:71]
    v_mfma_f32_16x16x32_bf16 v[72:75], v[228:231], v[176:179], v[72:75]
    v_mfma_f32_16x16x32_bf16 v[76:79], v[228:231], v[180:183], v[76:79]
    v_mfma_f32_16x16x32_bf16 v[80:83], v[232:235], v[176:179], v[80:83]
    v_mfma_f32_16x16x32_bf16 v[84:87], v[232:235], v[180:183], v[84:87]
    s_waitcnt lgkmcnt(3)
    v_mfma_f32_16x16x32_bf16 v[16:19], v[200:203], v[184:187], v[16:19]
    ds_read_b128 v[216:219], v237 offset:26624
    ds_read_b128 v[220:223], v237 offset:28672
    v_mfma_f32_16x16x32_bf16 v[20:23], v[200:203], v[188:191], v[20:23]
    s_waitcnt lgkmcnt(4)
    v_mfma_f32_16x16x32_bf16 v[24:27], v[204:207], v[184:187], v[24:27]
    ds_read_b128 v[224:227], v237 offset:30720
    v_mfma_f32_16x16x32_bf16 v[28:31], v[204:207], v[188:191], v[28:31]
    s_waitcnt lgkmcnt(4)
    v_mfma_f32_16x16x32_bf16 v[32:35], v[208:211], v[184:187], v[32:35]
    ds_read_b128 v[228:231], v237 offset:32768
    v_mfma_f32_16x16x32_bf16 v[36:39], v[208:211], v[188:191], v[36:39]
    s_waitcnt lgkmcnt(4)
    v_mfma_f32_16x16x32_bf16 v[40:43], v[212:215], v[184:187], v[40:43]
    ds_read_b128 v[232:235], v237 offset:34816
    ds_read_b128 v[200:203], v237 offset:19456
    v_mfma_f32_16x16x32_bf16 v[44:47], v[212:215], v[188:191], v[44:47]
    s_waitcnt lgkmcnt(5)
    v_mfma_f32_16x16x32_bf16 v[48:51], v[216:219], v[184:187], v[48:51]
    ds_read_b128 v[204:207], v237 offset:21504
    v_mfma_f32_16x16x32_bf16 v[52:55], v[216:219], v[188:191], v[52:55]
    s_waitcnt lgkmcnt(5)
    v_mfma_f32_16x16x32_bf16 v[56:59], v[220:223], v[184:187], v[56:59]
    ds_read_b128 v[208:211], v237 offset:23552
    v_mfma_f32_16x16x32_bf16 v[60:63], v[220:223], v[188:191], v[60:63]
    s_waitcnt lgkmcnt(5)
    v_mfma_f32_16x16x32_bf16 v[64:67], v[224:227], v[184:187], v[64:67]
    ds_read_b128 v[212:215], v237 offset:25600
    ds_read_b128 v[216:219], v237 offset:27648
    v_mfma_f32_16x16x32_bf16 v[68:71], v[224:227], v[188:191], v[68:71]
    s_waitcnt lgkmcnt(6)
    v_mfma_f32_16x16x32_bf16 v[72:75], v[228:231], v[184:187], v[72:75]
    ds_read_b128 v[220:223], v237 offset:29696
    v_mfma_f32_16x16x32_bf16 v[76:79], v[228:231], v[188:191], v[76:79]
    s_waitcnt lgkmcnt(6)
    v_mfma_f32_16x16x32_bf16 v[80:83], v[232:235], v[184:187], v[80:83]
    ds_read_b128 v[224:227], v237 offset:31744
    v_mfma_f32_16x16x32_bf16 v[84:87], v[232:235], v[188:191], v[84:87]
    s_waitcnt lgkmcnt(6)
    v_mfma_f32_16x16x32_bf16 v[16:19], v[200:203], v[192:195], v[16:19]
    ds_read_b128 v[228:231], v237 offset:33792
    v_mfma_f32_16x16x32_bf16 v[20:23], v[200:203], v[196:199], v[20:23]
    s_waitcnt lgkmcnt(6)
    v_mfma_f32_16x16x32_bf16 v[24:27], v[204:207], v[192:195], v[24:27]
    ds_read_b128 v[232:235], v237 offset:35840
    v_mfma_f32_16x16x32_bf16 v[28:31], v[204:207], v[196:199], v[28:31]
    s_waitcnt lgkmcnt(6)
    v_mfma_f32_16x16x32_bf16 v[32:35], v[208:211], v[192:195], v[32:35]
    v_mfma_f32_16x16x32_bf16 v[36:39], v[208:211], v[196:199], v[36:39]
    s_waitcnt lgkmcnt(5)
    v_mfma_f32_16x16x32_bf16 v[40:43], v[212:215], v[192:195], v[40:43]
    v_mfma_f32_16x16x32_bf16 v[44:47], v[212:215], v[196:199], v[44:47]
    s_waitcnt lgkmcnt(4)
    v_mfma_f32_16x16x32_bf16 v[48:51], v[216:219], v[192:195], v[48:51]
    v_mfma_f32_16x16x32_bf16 v[52:55], v[216:219], v[196:199], v[52:55]
    s_waitcnt lgkmcnt(3)
    v_mfma_f32_16x16x32_bf16 v[56:59], v[220:223], v[192:195], v[56:59]
    v_mfma_f32_16x16x32_bf16 v[60:63], v[220:223], v[196:199], v[60:63]
    s_waitcnt lgkmcnt(2)
    v_mfma_f32_16x16x32_bf16 v[64:67], v[224:227], v[192:195], v[64:67]
    v_mfma_f32_16x16x32_bf16 v[68:71], v[224:227], v[196:199], v[68:71]
    s_waitcnt lgkmcnt(1)
    v_mfma_f32_16x16x32_bf16 v[72:75], v[228:231], v[192:195], v[72:75]
    v_mfma_f32_16x16x32_bf16 v[76:79], v[228:231], v[196:199], v[76:79]
    s_waitcnt lgkmcnt(0)
    v_mfma_f32_16x16x32_bf16 v[80:83], v[232:235], v[192:195], v[80:83]
    v_mfma_f32_16x16x32_bf16 v[84:87], v[232:235], v[196:199], v[84:87]
    s_setprio 3
    s_lshr_b32 s46, s38, 1
    s_and_b32 s47, s38, 1
    s_mul_i32 s46, s46, 9
    s_mul_i32 s48, s47, 5
    s_add_u32 s48, s48, s46
    s_add_u32 s48, s48, 18
    s_add_u32 s46, s46, 22
    s_mul_i32 s49, s56, 92160
    s_add_u32 s49, s49, 42991616
    s_lshl_b32 s48, s48, 10
    s_add_u32 s48, s48, s49
    s_lshl_b32 s46, s46, 10
    s_add_u32 s46, s46, s49
    s_lshl_b32 s47, s47, 9
    s_add_u32 s46, s46, s47
    v_lshrrev_b32 v3, 4, v2
    v_and_b32 v4, 15, v2
    v_lshrrev_b32 v5, 1, v3
    v_lshlrev_b32 v5, 8, v5
    v_lshl_add_u32 v5, v4, 4, v5
    v_mov_b32 v4, 1073741824
    v_and_b32 v3, 1, v3
    v_cmp_eq_u32 vcc, 0, v3
    s_nop 1
    v_cndmask_b32 v5, v4, v5, vcc
    v_lshlrev_b32 v8, 16, v128
    v_lshlrev_b32 v9, 16, v129
    v_sub_f32 v10, 1.0, v130
    v_sub_f32 v11, 1.0, v131
    v_add_f32 v16, v16, v8
    v_add_f32 v17, v17, v8
    v_add_f32 v18, v18, v8
    v_add_f32 v19, v19, v8
    v_lshlrev_b32 v12, 16, v88
    v_and_b32 v13, 0xffff0000, v88
    v_lshlrev_b32 v14, 16, v89
    v_and_b32 v15, 0xffff0000, v89
    v_mul_f32 v12, v12, v10
    v_mul_f32 v13, v13, v10
    v_mul_f32 v14, v14, v10
    v_mul_f32 v15, v15, v10
    v_pk_mul_f32 v[16:17], v[16:17], v[12:13]
    v_pk_mul_f32 v[18:19], v[18:19], v[14:15]
    v_add_f32 v24, v24, v8
    v_add_f32 v25, v25, v8
    v_add_f32 v26, v26, v8
    v_add_f32 v27, v27, v8
    v_lshlrev_b32 v12, 16, v92
    v_and_b32 v13, 0xffff0000, v92
    v_lshlrev_b32 v14, 16, v93
    v_and_b32 v15, 0xffff0000, v93
    v_mul_f32 v12, v12, v10
    v_mul_f32 v13, v13, v10
    v_mul_f32 v14, v14, v10
    v_mul_f32 v15, v15, v10
    v_pk_mul_f32 v[24:25], v[24:25], v[12:13]
    v_pk_mul_f32 v[26:27], v[26:27], v[14:15]
    v_cvt_pk_bf16_f32 v136, v16, v17
    v_cvt_pk_bf16_f32 v137, v18, v19
    v_cvt_pk_bf16_f32 v138, v24, v25
    v_cvt_pk_bf16_f32 v139, v26, v27
    s_add_u32 s45, s48, 0
    buffer_store_dwordx4 v[136:139], v236, s[24:27], s45 offen sc1
    v_add_f32 v32, v32, v8
    v_add_f32 v33, v33, v8
    v_add_f32 v34, v34, v8
    v_add_f32 v35, v35, v8
    v_lshlrev_b32 v12, 16, v96
    v_and_b32 v13, 0xffff0000, v96
    v_lshlrev_b32 v14, 16, v97
    v_and_b32 v15, 0xffff0000, v97
    v_mul_f32 v12, v12, v10
    v_mul_f32 v13, v13, v10
    v_mul_f32 v14, v14, v10
    v_mul_f32 v15, v15, v10
    v_pk_mul_f32 v[32:33], v[32:33], v[12:13]
    v_pk_mul_f32 v[34:35], v[34:35], v[14:15]
    v_add_f32 v40, v40, v8
    v_add_f32 v41, v41, v8
    v_add_f32 v42, v42, v8
    v_add_f32 v43, v43, v8
    v_lshlrev_b32 v12, 16, v100
    v_and_b32 v13, 0xffff0000, v100
    v_lshlrev_b32 v14, 16, v101
    v_and_b32 v15, 0xffff0000, v101
    v_mul_f32 v12, v12, v10
    v_mul_f32 v13, v13, v10
    v_mul_f32 v14, v14, v10
    v_mul_f32 v15, v15, v10
    v_pk_mul_f32 v[40:41], v[40:41], v[12:13]
    v_pk_mul_f32 v[42:43], v[42:43], v[14:15]
    v_cvt_pk_bf16_f32 v140, v32, v33
    v_cvt_pk_bf16_f32 v141, v34, v35
    v_cvt_pk_bf16_f32 v142, v40, v41
    v_cvt_pk_bf16_f32 v143, v42, v43
    s_add_u32 s45, s48, 1024
    buffer_store_dwordx4 v[140:143], v236, s[24:27], s45 offen sc1
    v_add_f32 v48, v48, v8
    v_add_f32 v49, v49, v8
    v_add_f32 v50, v50, v8
    v_add_f32 v51, v51, v8
    v_lshlrev_b32 v12, 16, v104
    v_and_b32 v13, 0xffff0000, v104
    v_lshlrev_b32 v14, 16, v105
    v_and_b32 v15, 0xffff0000, v105
    v_mul_f32 v12, v12, v10
    v_mul_f32 v13, v13, v10
    v_mul_f32 v14, v14, v10
    v_mul_f32 v15, v15, v10
    v_pk_mul_f32 v[48:49], v[48:49], v[12:13]
    v_pk_mul_f32 v[50:51], v[50:51], v[14:15]
    v_add_f32 v56, v56, v8
    v_add_f32 v57, v57, v8
    v_add_f32 v58, v58, v8
    v_add_f32 v59, v59, v8
    v_lshlrev_b32 v12, 16, v108
    v_and_b32 v13, 0xffff0000, v108
    v_lshlrev_b32 v14, 16, v109
    v_and_b32 v15, 0xffff0000, v109
    v_mul_f32 v12, v12, v10
    v_mul_f32 v13, v13, v10
    v_mul_f32 v14, v14, v10
    v_mul_f32 v15, v15, v10
    v_pk_mul_f32 v[56:57], v[56:57], v[12:13]
    v_pk_mul_f32 v[58:59], v[58:59], v[14:15]
    v_cvt_pk_bf16_f32 v144, v48, v49
    v_cvt_pk_bf16_f32 v145, v50, v51
    v_cvt_pk_bf16_f32 v146, v56, v57
    v_cvt_pk_bf16_f32 v147, v58, v59
    s_add_u32 s45, s48, 2048
    buffer_store_dwordx4 v[144:147], v236, s[24:27], s45 offen sc1
    v_add_f32 v64, v64, v8
    v_add_f32 v65, v65, v8
    v_add_f32 v66, v66, v8
    v_add_f32 v67, v67, v8
    v_lshlrev_b32 v12, 16, v112
    v_and_b32 v13, 0xffff0000, v112
    v_lshlrev_b32 v14, 16, v113
    v_and_b32 v15, 0xffff0000, v113
    v_mul_f32 v12, v12, v10
    v_mul_f32 v13, v13, v10
    v_mul_f32 v14, v14, v10
    v_mul_f32 v15, v15, v10
    v_pk_mul_f32 v[64:65], v[64:65], v[12:13]
    v_pk_mul_f32 v[66:67], v[66:67], v[14:15]
    v_add_f32 v72, v72, v8
    v_add_f32 v73, v73, v8
    v_add_f32 v74, v74, v8
    v_add_f32 v75, v75, v8
    v_lshlrev_b32 v12, 16, v116
    v_and_b32 v13, 0xffff0000, v116
    v_lshlrev_b32 v14, 16, v117
    v_and_b32 v15, 0xffff0000, v117
    v_mul_f32 v12, v12, v10
    v_mul_f32 v13, v13, v10
    v_mul_f32 v14, v14, v10
    v_mul_f32 v15, v15, v10
    v_pk_mul_f32 v[72:73], v[72:73], v[12:13]
    v_pk_mul_f32 v[74:75], v[74:75], v[14:15]
    v_cvt_pk_bf16_f32 v148, v64, v65
    v_cvt_pk_bf16_f32 v149, v66, v67
    v_cvt_pk_bf16_f32 v150, v72, v73
    v_cvt_pk_bf16_f32 v151, v74, v75
    s_add_u32 s45, s48, 3072
    buffer_store_dwordx4 v[148:151], v236, s[24:27], s45 offen sc1
    v_add_f32 v80, v80, v8
    v_add_f32 v81, v81, v8
    v_add_f32 v82, v82, v8
    v_add_f32 v83, v83, v8
    v_lshlrev_b32 v12, 16, v120
    v_and_b32 v13, 0xffff0000, v120
    v_lshlrev_b32 v14, 16, v121
    v_and_b32 v15, 0xffff0000, v121
    v_mul_f32 v12, v12, v10
    v_mul_f32 v13, v13, v10
    v_mul_f32 v14, v14, v10
    v_mul_f32 v15, v15, v10
    v_pk_mul_f32 v[80:81], v[80:81], v[12:13]
    v_pk_mul_f32 v[82:83], v[82:83], v[14:15]
    v_cvt_pk_bf16_f32 v152, v80, v81
    v_cvt_pk_bf16_f32 v153, v82, v83
    v_mov_b32 v12, v152
    v_mov_b32 v154, v152
    v_mov_b32 v13, v153
    v_mov_b32 v155, v153
    v_permlane16_swap_b32 v12, v154
    s_nop 0
    v_permlane16_swap_b32 v13, v155
    s_add_u32 s45, s46, 0
    buffer_store_dwordx4 v[152:155], v5, s[24:27], s45 offen sc1
    v_add_f32 v20, v20, v9
    v_add_f32 v21, v21, v9
    v_add_f32 v22, v22, v9
    v_add_f32 v23, v23, v9
    v_lshlrev_b32 v12, 16, v90
    v_and_b32 v13, 0xffff0000, v90
    v_lshlrev_b32 v14, 16, v91
    v_and_b32 v15, 0xffff0000, v91
    v_mul_f32 v12, v12, v11
    v_mul_f32 v13, v13, v11
    v_mul_f32 v14, v14, v11
    v_mul_f32 v15, v15, v11
    v_pk_mul_f32 v[20:21], v[20:21], v[12:13]
    v_pk_mul_f32 v[22:23], v[22:23], v[14:15]
    v_add_f32 v28, v28, v9
    v_add_f32 v29, v29, v9
    v_add_f32 v30, v30, v9
    v_add_f32 v31, v31, v9
    v_lshlrev_b32 v12, 16, v94
    v_and_b32 v13, 0xffff0000, v94
    v_lshlrev_b32 v14, 16, v95
    v_and_b32 v15, 0xffff0000, v95
    v_mul_f32 v12, v12, v11
    v_mul_f32 v13, v13, v11
    v_mul_f32 v14, v14, v11
    v_mul_f32 v15, v15, v11
    v_pk_mul_f32 v[28:29], v[28:29], v[12:13]
    v_pk_mul_f32 v[30:31], v[30:31], v[14:15]
    v_cvt_pk_bf16_f32 v156, v20, v21
    v_cvt_pk_bf16_f32 v157, v22, v23
    v_cvt_pk_bf16_f32 v158, v28, v29
    v_cvt_pk_bf16_f32 v159, v30, v31
    s_add_u32 s45, s48, 92160
    buffer_store_dwordx4 v[156:159], v236, s[24:27], s45 offen sc1
    v_add_f32 v36, v36, v9
    v_add_f32 v37, v37, v9
    v_add_f32 v38, v38, v9
    v_add_f32 v39, v39, v9
    v_lshlrev_b32 v12, 16, v98
    v_and_b32 v13, 0xffff0000, v98
    v_lshlrev_b32 v14, 16, v99
    v_and_b32 v15, 0xffff0000, v99
    v_mul_f32 v12, v12, v11
    v_mul_f32 v13, v13, v11
    v_mul_f32 v14, v14, v11
    v_mul_f32 v15, v15, v11
    v_pk_mul_f32 v[36:37], v[36:37], v[12:13]
    v_pk_mul_f32 v[38:39], v[38:39], v[14:15]
    v_add_f32 v44, v44, v9
    v_add_f32 v45, v45, v9
    v_add_f32 v46, v46, v9
    v_add_f32 v47, v47, v9
    v_lshlrev_b32 v12, 16, v102
    v_and_b32 v13, 0xffff0000, v102
    v_lshlrev_b32 v14, 16, v103
    v_and_b32 v15, 0xffff0000, v103
    v_mul_f32 v12, v12, v11
    v_mul_f32 v13, v13, v11
    v_mul_f32 v14, v14, v11
    v_mul_f32 v15, v15, v11
    v_pk_mul_f32 v[44:45], v[44:45], v[12:13]
    v_pk_mul_f32 v[46:47], v[46:47], v[14:15]
    v_cvt_pk_bf16_f32 v160, v36, v37
    v_cvt_pk_bf16_f32 v161, v38, v39
    v_cvt_pk_bf16_f32 v162, v44, v45
    v_cvt_pk_bf16_f32 v163, v46, v47
    s_add_u32 s45, s48, 93184
    buffer_store_dwordx4 v[160:163], v236, s[24:27], s45 offen sc1
    v_add_f32 v52, v52, v9
    v_add_f32 v53, v53, v9
    v_add_f32 v54, v54, v9
    v_add_f32 v55, v55, v9
    v_lshlrev_b32 v12, 16, v106
    v_and_b32 v13, 0xffff0000, v106
    v_lshlrev_b32 v14, 16, v107
    v_and_b32 v15, 0xffff0000, v107
    v_mul_f32 v12, v12, v11
    v_mul_f32 v13, v13, v11
    v_mul_f32 v14, v14, v11
    v_mul_f32 v15, v15, v11
    v_pk_mul_f32 v[52:53], v[52:53], v[12:13]
    v_pk_mul_f32 v[54:55], v[54:55], v[14:15]
    v_add_f32 v60, v60, v9
    v_add_f32 v61, v61, v9
    v_add_f32 v62, v62, v9
    v_add_f32 v63, v63, v9
    v_lshlrev_b32 v12, 16, v110
    v_and_b32 v13, 0xffff0000, v110
    v_lshlrev_b32 v14, 16, v111
    v_and_b32 v15, 0xffff0000, v111
    v_mul_f32 v12, v12, v11
    v_mul_f32 v13, v13, v11
    v_mul_f32 v14, v14, v11
    v_mul_f32 v15, v15, v11
    v_pk_mul_f32 v[60:61], v[60:61], v[12:13]
    v_pk_mul_f32 v[62:63], v[62:63], v[14:15]
    v_cvt_pk_bf16_f32 v164, v52, v53
    v_cvt_pk_bf16_f32 v165, v54, v55
    v_cvt_pk_bf16_f32 v166, v60, v61
    v_cvt_pk_bf16_f32 v167, v62, v63
    s_add_u32 s45, s48, 94208
    buffer_store_dwordx4 v[164:167], v236, s[24:27], s45 offen sc1
    v_add_f32 v68, v68, v9
    v_add_f32 v69, v69, v9
    v_add_f32 v70, v70, v9
    v_add_f32 v71, v71, v9
    v_lshlrev_b32 v12, 16, v114
    v_and_b32 v13, 0xffff0000, v114
    v_lshlrev_b32 v14, 16, v115
    v_and_b32 v15, 0xffff0000, v115
    v_mul_f32 v12, v12, v11
    v_mul_f32 v13, v13, v11
    v_mul_f32 v14, v14, v11
    v_mul_f32 v15, v15, v11
    v_pk_mul_f32 v[68:69], v[68:69], v[12:13]
    v_pk_mul_f32 v[70:71], v[70:71], v[14:15]
    v_add_f32 v76, v76, v9
    v_add_f32 v77, v77, v9
    v_add_f32 v78, v78, v9
    v_add_f32 v79, v79, v9
    v_lshlrev_b32 v12, 16, v118
    v_and_b32 v13, 0xffff0000, v118
    v_lshlrev_b32 v14, 16, v119
    v_and_b32 v15, 0xffff0000, v119
    v_mul_f32 v12, v12, v11
    v_mul_f32 v13, v13, v11
    v_mul_f32 v14, v14, v11
    v_mul_f32 v15, v15, v11
    v_pk_mul_f32 v[76:77], v[76:77], v[12:13]
    v_pk_mul_f32 v[78:79], v[78:79], v[14:15]
    v_cvt_pk_bf16_f32 v136, v68, v69
    v_cvt_pk_bf16_f32 v137, v70, v71
    v_cvt_pk_bf16_f32 v138, v76, v77
    v_cvt_pk_bf16_f32 v139, v78, v79
    s_add_u32 s45, s48, 95232
    buffer_store_dwordx4 v[136:139], v236, s[24:27], s45 offen sc1
    v_add_f32 v84, v84, v9
    v_add_f32 v85, v85, v9
    v_add_f32 v86, v86, v9
    v_add_f32 v87, v87, v9
    v_lshlrev_b32 v12, 16, v122
    v_and_b32 v13, 0xffff0000, v122
    v_lshlrev_b32 v14, 16, v123
    v_and_b32 v15, 0xffff0000, v123
    v_mul_f32 v12, v12, v11
    v_mul_f32 v13, v13, v11
    v_mul_f32 v14, v14, v11
    v_mul_f32 v15, v15, v11
    v_pk_mul_f32 v[84:85], v[84:85], v[12:13]
    v_pk_mul_f32 v[86:87], v[86:87], v[14:15]
    v_cvt_pk_bf16_f32 v140, v84, v85
    v_cvt_pk_bf16_f32 v141, v86, v87
    v_mov_b32 v12, v140
    v_mov_b32 v142, v140
    v_mov_b32 v13, v141
    v_mov_b32 v143, v141
    v_permlane16_swap_b32 v12, v142
    s_nop 0
    v_permlane16_swap_b32 v13, v143
    s_add_u32 s45, s46, 92160
    buffer_store_dwordx4 v[140:143], v5, s[24:27], s45 offen sc1
    s_waitcnt lgkmcnt(0)
    s_barrier
    s_mov_b32 s3, s2
    s_load_dwordx2 s[10:11], s[0:1], 16
    s_load_dwordx2 s[12:13], s[0:1], 56
    s_load_dwordx2 s[14:15], s[0:1], 72
    s_and_b32 s48, s3, 7
    s_lshr_b32 s49, s3, 3
    s_lshl_b32 s48, s48, 5
    s_add_u32 s48, s48, s49
    s_waitcnt lgkmcnt(0)
    s_cmp_ge_u32 s48, 234
    s_cbranch_scc1 L_k2fi_skip
    s_mul_i32 s49, s48, 7282
    s_lshr_b32 s49, s49, 16
    s_mul_i32 s50, s49, 9
    s_sub_u32 s50, s48, s50
    s_mov_b32 s28, s10
    s_and_b32 s29, s11, 0xffff
    s_mov_b32 s30, 0xa2000
    s_mov_b32 s31, 0x20000
    s_mov_b32 s32, s12
    s_and_b32 s33, s13, 0xffff
    s_mov_b32 s34, 0x288000
    s_mov_b32 s35, 0x20000
    s_mov_b32 s40, s14
    s_and_b32 s41, s15, 0xffff
    s_mov_b32 s42, 0x240000
    s_mov_b32 s43, 0x20000
    s_add_u32 s44, s8, 42991616
    s_addc_u32 s45, s9, 0
    s_and_b32 s45, s45, 0xffff
    s_mov_b32 s46, 11796480
    s_mov_b32 s47, 0x20000
    v_lshlrev_b32 v3, 4, v2
    v_lshrrev_b32 v10, 3, v2
    v_and_b32 v11, 7, v2
    v_bfe_u32 v12, v10, 1, 2
    v_lshlrev_b32 v12, 1, v12
    v_xor_b32 v11, v11, v12
    v_lshlrev_b32 v11, 4, v11
    s_lshl_b32 s51, s50, 7
    v_add_u32 v11, s51, v11
    v_mul_u32_u24 v12, 1152, v10
    v_add_u32 v4, v12, v11
    v_lshrrev_b32 v12, 2, v10
    v_lshlrev_b32 v12, 3, v12
    v_and_b32 v13, 3, v10
    v_add_u32 v12, v12, v13
    v_mul_u32_u24 v12, 1152, v12
    v_add_u32 v14, v12, v11
    v_lshrrev_b32 v12, 2, v10
    v_lshlrev_b32 v12, 2, v12
    v_bfe_u32 v13, v10, 1, 1
    v_add_u32 v12, v12, v13
    v_mul_u32_u24 v12, 18, v12
    v_and_b32 v13, 1, v10
    v_add_u32 v12, v12, v13
    v_mul_u32_u24 v12, 1152, v12
    v_add_u32 v5, v12, v11
    s_cmp_lt_u32 s36, 2
    s_cselect_b32 s52, 0, 1073741824
    v_add_u32 v5, s52, v5
    s_mul_i32 s57, s36, 20480
    s_mul_i32 s56, s49, 460800
    s_mul_i32 s53, s36, 18432
    s_add_u32 s53, s53, s56
    s_add_u32 s53, s53, 18432
    s_lshl_b32 s54, s36, 10
    s_add_u32 s54, s54, s56
    s_mul_i32 s55, s36, 663552
    s_mul_i32 s58, s36, 41472
    s_and_b32 s59, s36, 1
    s_mul_i32 s59, s59, 331776
    s_add_u32 s59, s59, 18432
    v_lshrrev_b32 v10, 4, v2
    v_bfe_u32 v11, v2, 2, 2
    v_lshl_add_u32 v10, v10, 2, v11
    v_bfe_u32 v11, v10, 1, 2
    v_lshlrev_b32 v11, 5, v11
    v_lshlrev_b32 v10, 7, v10
    v_and_b32 v12, 3, v2
    v_lshl_add_u32 v10, v12, 3, v10
    v_add_u32 v10, s57, v10
    v_xor_b32 v12, 0, v11
    v_add_u32 v6, v10, v12
    v_xor_b32 v12, 32, v11
    v_add_u32 v7, v10, v12
    v_xor_b32 v12, 64, v11
    v_add_u32 v8, v10, v12
    v_xor_b32 v12, 96, v11
    v_add_u32 v9, v10, v12
    v_add_u32 v228, 92160, v3
    v_add_u32 v229, 184320, v3
    v_add_u32 v230, 276480, v3
    v_add_u32 v231, 368640, v3
    v_lshrrev_b32 v10, 4, v2
    v_lshlrev_b32 v10, 15, v10
    v_and_b32 v11, 15, v2
    v_lshl_add_u32 v10, v11, 2, v10
    s_cmp_lt_u32 s36, 2
    s_cselect_b32 s52, 0, 1073741824
    v_add_u32 v10, s52, v10
    s_and_b32 s62, s36, 1
    s_lshl_b32 s62, s62, 17
    s_mul_i32 s60, s49, 320
    s_add_u32 s62, s62, s60
    s_add_u32 s62, s62, 55050240
    v_add_u32 v232, 0, v10
    v_add_u32 v233, 64, v10
    v_add_u32 v234, 128, v10
    v_add_u32 v235, 192, v10
    v_add_u32 v236, 256, v10
    v_mov_b64 v[16:17], 0
    v_mov_b64 v[18:19], 0
    v_mov_b64 v[20:21], 0
    v_mov_b64 v[22:23], 0
    v_mov_b64 v[24:25], 0
    v_mov_b64 v[26:27], 0
    v_mov_b64 v[28:29], 0
    v_mov_b64 v[30:31], 0
    v_mov_b64 v[32:33], 0
    v_mov_b64 v[34:35], 0
    v_mov_b64 v[36:37], 0
    v_mov_b64 v[38:39], 0
    v_mov_b64 v[40:41], 0
    v_mov_b64 v[42:43], 0
    v_mov_b64 v[44:45], 0
    v_mov_b64 v[46:47], 0
    v_mov_b64 v[48:49], 0
    v_mov_b64 v[50:51], 0
    v_mov_b64 v[52:53], 0
    v_mov_b64 v[54:55], 0
    v_mov_b64 v[56:57], 0
    v_mov_b64 v[58:59], 0
    v_mov_b64 v[60:61], 0
    v_mov_b64 v[62:63], 0
    v_mov_b64 v[64:65], 0
    v_mov_b64 v[66:67], 0
    v_mov_b64 v[68:69], 0
    v_mov_b64 v[70:71], 0
    v_mov_b64 v[72:73], 0
    v_mov_b64 v[74:75], 0
    v_mov_b64 v[76:77], 0
    v_mov_b64 v[78:79], 0
    v_mov_b64 v[80:81], 0
    v_mov_b64 v[82:83], 0
    v_mov_b64 v[84:85], 0
    v_mov_b64 v[86:87], 0
    v_mov_b64 v[88:89], 0
    v_mov_b64 v[90:91], 0
    v_mov_b64 v[92:93], 0
    v_mov_b64 v[94:95], 0
    s_add_u32 s89, s37, 8
    s_waitcnt vmcnt(0)
    s_barrier
    s_cmp_lg_u32 s36, 0
    s_cbranch_scc1 L_k2ua_arr_22
    s_lshl_b32 s90, s89, 8
    s_add_u32 s90, s90, 55312384
    v_mov_b32 v237, 1
    v_mov_b32 v238, 0
    v_mov_b32 v239, 1073741824
    v_cmp_eq_u32 vcc, 0, v2
    s_nop 1
    v_cndmask_b32 v238, v239, v238, vcc
    buffer_atomic_add v237, v238, s[24:27], s90 offen sc1
L_k2ua_arr_22:
    s_add_u32 m0, s57, 0
    s_add_u32 s60, s55, 0
    buffer_load_dwordx4 v4, s[32:35], s60 offen lds
    s_add_u32 m0, s57, 1024
    s_add_u32 s60, s55, 9216
    buffer_load_dwordx4 v4, s[32:35], s60 offen lds
    s_add_u32 m0, s57, 2048
    s_add_u32 s60, s55, 18432
    buffer_load_dwordx4 v4, s[32:35], s60 offen lds
    s_add_u32 m0, s57, 3072
    s_add_u32 s60, s55, 27648
    buffer_load_dwordx4 v4, s[32:35], s60 offen lds
    s_add_u32 m0, s57, 4096
    s_add_u32 s60, s55, 36864
    buffer_load_dwordx4 v4, s[32:35], s60 offen lds
    s_add_u32 m0, s57, 5120
    s_add_u32 s60, s55, 46080
    buffer_load_dwordx4 v4, s[32:35], s60 offen lds
    s_add_u32 m0, s57, 6144
    s_add_u32 s60, s55, 55296
    buffer_load_dwordx4 v4, s[32:35], s60 offen lds
    s_add_u32 m0, s57, 7168
    s_add_u32 s60, s55, 64512
    buffer_load_dwordx4 v4, s[32:35], s60 offen lds
    s_add_u32 m0, s57, 8192
    s_add_u32 s60, s55, 73728
    buffer_load_dwordx4 v4, s[32:35], s60 offen lds
    s_add_u32 m0, s57, 9216
    s_add_u32 s60, s55, 82944
    buffer_load_dwordx4 v4, s[32:35], s60 offen lds
    s_add_u32 m0, s57, 10240
    s_add_u32 s60, s55, 92160
    buffer_load_dwordx4 v4, s[32:35], s60 offen lds
    s_add_u32 m0, s57, 11264
    s_add_u32 s60, s55, 101376
    buffer_load_dwordx4 v4, s[32:35], s60 offen lds
    s_add_u32 m0, s57, 12288
    s_add_u32 s60, s55, 110592
    buffer_load_dwordx4 v4, s[32:35], s60 offen lds
    s_add_u32 m0, s57, 13312
    s_add_u32 s60, s55, 119808
    buffer_load_dwordx4 v4, s[32:35], s60 offen lds
    s_add_u32 m0, s57, 14336
    s_add_u32 s60, s55, 129024
    buffer_load_dwordx4 v4, s[32:35], s60 offen lds
    s_add_u32 m0, s57, 15360
    s_add_u32 s60, s55, 138240
    buffer_load_dwordx4 v4, s[32:35], s60 offen lds
    s_cmp_lg_u32 s36, 0
    s_cbranch_scc1 L_k2wu_np_23
    s_mul_i32 s88, s49, 80
    s_add_u32 s89, s88, 79
    s_min_u32 s89, s89, 2047
    s_lshr_b32 s90, s88, 7
    s_add_u32 s90, s90, 8
    s_lshl_b32 s90, s90, 8
    v_mov_b32 v241, s90
    s_lshr_b32 s90, s89, 7
    s_add_u32 s90, s90, 8
    s_lshl_b32 s90, s90, 8
    v_writelane_b32 v241, s90, 1
    s_mov_b32 s91, 55312384
L_k2wu_poll_24:
    buffer_load_dword v240, v241, s[24:27], s91 offen sc1
    s_waitcnt vmcnt(0)
    v_cmp_gt_u32 vcc, 16, v240
    s_nop 1
    s_and_b32 s90, vcc_lo, 3
    s_cmp_eq_u32 s90, 0
    s_cbranch_scc1 L_k2wu_poll_24_ok
    s_sleep 8
    s_branch L_k2wu_poll_24
L_k2wu_poll_24_ok:
L_k2wu_np_23:
    s_barrier
    s_add_u32 s61, s53, 0
    buffer_load_dwordx4 v[96:99], v3, s[44:47], s61 offen sc1
    s_add_u32 s61, s53, 0
    buffer_load_dwordx4 v[100:103], v228, s[44:47], s61 offen sc1
    s_add_u32 s61, s53, 0
    buffer_load_dwordx4 v[104:107], v229, s[44:47], s61 offen sc1
    s_add_u32 s61, s53, 0
    buffer_load_dwordx4 v[108:111], v230, s[44:47], s61 offen sc1
    s_add_u32 s61, s53, 0
    buffer_load_dwordx4 v[112:115], v231, s[44:47], s61 offen sc1
    s_add_u32 s61, s53, 1024
    buffer_load_dwordx4 v[116:119], v3, s[44:47], s61 offen sc1
    s_add_u32 s61, s53, 1024
    buffer_load_dwordx4 v[120:123], v228, s[44:47], s61 offen sc1
    s_add_u32 s61, s53, 1024
    buffer_load_dwordx4 v[124:127], v229, s[44:47], s61 offen sc1
    s_add_u32 s61, s53, 1024
    buffer_load_dwordx4 v[128:131], v230, s[44:47], s61 offen sc1
    s_add_u32 s61, s53, 1024
    buffer_load_dwordx4 v[132:135], v231, s[44:47], s61 offen sc1
    s_add_u32 s61, s53, 2048
    buffer_load_dwordx4 v[136:139], v3, s[44:47], s61 offen sc1
    s_add_u32 s61, s53, 2048
    buffer_load_dwordx4 v[140:143], v228, s[44:47], s61 offen sc1
    s_add_u32 s61, s53, 2048
    buffer_load_dwordx4 v[144:147], v229, s[44:47], s61 offen sc1
    s_add_u32 s61, s53, 2048
    buffer_load_dwordx4 v[148:151], v230, s[44:47], s61 offen sc1
    s_add_u32 s61, s53, 2048
    buffer_load_dwordx4 v[152:155], v231, s[44:47], s61 offen sc1
    s_add_u32 s61, s53, 3072
    buffer_load_dwordx4 v[156:159], v3, s[44:47], s61 offen sc1
    s_add_u32 s61, s53, 3072
    buffer_load_dwordx4 v[160:163], v228, s[44:47], s61 offen sc1
    s_add_u32 s61, s53, 3072
    buffer_load_dwordx4 v[164:167], v229, s[44:47], s61 offen sc1
    s_add_u32 s61, s53, 3072
    buffer_load_dwordx4 v[168:171], v230, s[44:47], s61 offen sc1
    s_add_u32 s61, s53, 3072
    buffer_load_dwordx4 v[172:175], v231, s[44:47], s61 offen sc1
    s_setprio 0
    s_waitcnt vmcnt(15)
    ds_read_b64_tr_b16 v[196:197], v6 offset:0
    ds_read_b64_tr_b16 v[198:199], v6 offset:2048
    ds_read_b64_tr_b16 v[200:201], v7 offset:0
    ds_read_b64_tr_b16 v[202:203], v7 offset:2048
    ds_read_b64_tr_b16 v[204:205], v8 offset:0
    ds_read_b64_tr_b16 v[206:207], v8 offset:2048
    ds_read_b64_tr_b16 v[208:209], v9 offset:0
    ds_read_b64_tr_b16 v[210:211], v9 offset:2048
    s_waitcnt lgkmcnt(6)
    v_mfma_f32_16x16x32_bf16 v[16:19], v[196:199], v[96:99], v[16:19]
    v_mfma_f32_16x16x32_bf16 v[32:35], v[196:199], v[100:103], v[32:35]
    s_add_u32 m0, s57, 16384
    s_add_u32 s60, s55, 147456
    buffer_load_dwordx4 v14, s[32:35], s60 offen lds
    v_mfma_f32_16x16x32_bf16 v[48:51], v[196:199], v[104:107], v[48:51]
    v_mfma_f32_16x16x32_bf16 v[64:67], v[196:199], v[108:111], v[64:67]
    s_add_u32 m0, s57, 17408
    s_add_u32 s60, s55, 313344
    buffer_load_dwordx4 v14, s[32:35], s60 offen lds
    v_mfma_f32_16x16x32_bf16 v[80:83], v[196:199], v[112:115], v[80:83]
    s_waitcnt lgkmcnt(4)
    v_mfma_f32_16x16x32_bf16 v[20:23], v[200:203], v[96:99], v[20:23]
    s_add_u32 m0, s57, 18432
    s_add_u32 s60, s55, 152064
    buffer_load_dwordx4 v14, s[32:35], s60 offen lds
    v_mfma_f32_16x16x32_bf16 v[36:39], v[200:203], v[100:103], v[36:39]
    v_mfma_f32_16x16x32_bf16 v[52:55], v[200:203], v[104:107], v[52:55]
    s_add_u32 m0, s57, 19456
    s_add_u32 s60, s55, 317952
    buffer_load_dwordx4 v14, s[32:35], s60 offen lds
    v_mfma_f32_16x16x32_bf16 v[68:71], v[200:203], v[108:111], v[68:71]
    v_mfma_f32_16x16x32_bf16 v[84:87], v[200:203], v[112:115], v[84:87]
    s_add_u32 s61, s53, 4096
    buffer_load_dwordx4 v[176:179], v3, s[44:47], s61 offen sc1
    s_waitcnt lgkmcnt(2)
    v_mfma_f32_16x16x32_bf16 v[24:27], v[204:207], v[96:99], v[24:27]
    v_mfma_f32_16x16x32_bf16 v[40:43], v[204:207], v[100:103], v[40:43]
    s_add_u32 s61, s53, 4096
    buffer_load_dwordx4 v[180:183], v228, s[44:47], s61 offen sc1
    v_mfma_f32_16x16x32_bf16 v[56:59], v[204:207], v[104:107], v[56:59]
    v_mfma_f32_16x16x32_bf16 v[72:75], v[204:207], v[108:111], v[72:75]
    s_add_u32 s61, s53, 4096
    buffer_load_dwordx4 v[184:187], v229, s[44:47], s61 offen sc1
    v_mfma_f32_16x16x32_bf16 v[88:91], v[204:207], v[112:115], v[88:91]
    s_waitcnt lgkmcnt(0)
    v_mfma_f32_16x16x32_bf16 v[28:31], v[208:211], v[96:99], v[28:31]
    s_add_u32 s61, s53, 4096
    buffer_load_dwordx4 v[188:191], v230, s[44:47], s61 offen sc1
    v_mfma_f32_16x16x32_bf16 v[44:47], v[208:211], v[100:103], v[44:47]
    v_mfma_f32_16x16x32_bf16 v[60:63], v[208:211], v[104:107], v[60:63]
    s_add_u32 s61, s53, 4096
    buffer_load_dwordx4 v[192:195], v231, s[44:47], s61 offen sc1
    v_mfma_f32_16x16x32_bf16 v[76:79], v[208:211], v[108:111], v[76:79]
    v_mfma_f32_16x16x32_bf16 v[92:95], v[208:211], v[112:115], v[92:95]
    s_waitcnt vmcnt(19)
    ds_read_b64_tr_b16 v[212:213], v6 offset:4096
    ds_read_b64_tr_b16 v[214:215], v6 offset:6144
    ds_read_b64_tr_b16 v[216:217], v7 offset:4096
    ds_read_b64_tr_b16 v[218:219], v7 offset:6144
    ds_read_b64_tr_b16 v[220:221], v8 offset:4096
    ds_read_b64_tr_b16 v[222:223], v8 offset:6144
    ds_read_b64_tr_b16 v[224:225], v9 offset:4096
    ds_read_b64_tr_b16 v[226:227], v9 offset:6144
    s_waitcnt lgkmcnt(6)
    v_mfma_f32_16x16x32_bf16 v[16:19], v[212:215], v[116:119], v[16:19]
    v_mfma_f32_16x16x32_bf16 v[32:35], v[212:215], v[120:123], v[32:35]
    s_add_u32 m0, s57, 0
    s_add_u32 s60, s55, 165888
    buffer_load_dwordx4 v4, s[32:35], s60 offen lds
    v_mfma_f32_16x16x32_bf16 v[48:51], v[212:215], v[124:127], v[48:51]
    v_mfma_f32_16x16x32_bf16 v[64:67], v[212:215], v[128:131], v[64:67]
    s_add_u32 m0, s57, 1024
    s_add_u32 s60, s55, 175104
    buffer_load_dwordx4 v4, s[32:35], s60 offen lds
    v_mfma_f32_16x16x32_bf16 v[80:83], v[212:215], v[132:135], v[80:83]
    s_waitcnt lgkmcnt(4)
    v_mfma_f32_16x16x32_bf16 v[20:23], v[216:219], v[116:119], v[20:23]
    s_add_u32 m0, s57, 2048
    s_add_u32 s60, s55, 184320
    buffer_load_dwordx4 v4, s[32:35], s60 offen lds
    v_mfma_f32_16x16x32_bf16 v[36:39], v[216:219], v[120:123], v[36:39]
    v_mfma_f32_16x16x32_bf16 v[52:55], v[216:219], v[124:127], v[52:55]
    s_add_u32 m0, s57, 3072
    s_add_u32 s60, s55, 193536
    buffer_load_dwordx4 v4, s[32:35], s60 offen lds
    v_mfma_f32_16x16x32_bf16 v[68:71], v[216:219], v[128:131], v[68:71]
    v_mfma_f32_16x16x32_bf16 v[84:87], v[216:219], v[132:135], v[84:87]
    s_add_u32 s61, s53, 5120
    buffer_load_dwordx4 v[96:99], v3, s[44:47], s61 offen sc1
    s_waitcnt lgkmcnt(2)
    v_mfma_f32_16x16x32_bf16 v[24:27], v[220:223], v[116:119], v[24:27]
    v_mfma_f32_16x16x32_bf16 v[40:43], v[220:223], v[120:123], v[40:43]
    s_add_u32 s61, s53, 5120
    buffer_load_dwordx4 v[100:103], v228, s[44:47], s61 offen sc1
    v_mfma_f32_16x16x32_bf16 v[56:59], v[220:223], v[124:127], v[56:59]
    v_mfma_f32_16x16x32_bf16 v[72:75], v[220:223], v[128:131], v[72:75]
    s_add_u32 s61, s53, 5120
    buffer_load_dwordx4 v[104:107], v229, s[44:47], s61 offen sc1
    v_mfma_f32_16x16x32_bf16 v[88:91], v[220:223], v[132:135], v[88:91]
    s_waitcnt lgkmcnt(0)
    v_mfma_f32_16x16x32_bf16 v[28:31], v[224:227], v[116:119], v[28:31]
    s_add_u32 s61, s53, 5120
    buffer_load_dwordx4 v[108:111], v230, s[44:47], s61 offen sc1
    v_mfma_f32_16x16x32_bf16 v[44:47], v[224:227], v[120:123], v[44:47]
    v_mfma_f32_16x16x32_bf16 v[60:63], v[224:227], v[124:127], v[60:63]
    s_add_u32 s61, s53, 5120
    buffer_load_dwordx4 v[112:115], v231, s[44:47], s61 offen sc1
    v_mfma_f32_16x16x32_bf16 v[76:79], v[224:227], v[128:131], v[76:79]
    v_mfma_f32_16x16x32_bf16 v[92:95], v[224:227], v[132:135], v[92:95]
    s_waitcnt vmcnt(23)
    ds_read_b64_tr_b16 v[196:197], v6 offset:8192
    ds_read_b64_tr_b16 v[198:199], v6 offset:10240
    ds_read_b64_tr_b16 v[200:201], v7 offset:8192
    ds_read_b64_tr_b16 v[202:203], v7 offset:10240
    ds_read_b64_tr_b16 v[204:205], v8 offset:8192
    ds_read_b64_tr_b16 v[206:207], v8 offset:10240
    ds_read_b64_tr_b16 v[208:209], v9 offset:8192
    ds_read_b64_tr_b16 v[210:211], v9 offset:10240
    s_waitcnt lgkmcnt(6)
    v_mfma_f32_16x16x32_bf16 v[16:19], v[196:199], v[136:139], v[16:19]
    v_mfma_f32_16x16x32_bf16 v[32:35], v[196:199], v[140:143], v[32:35]
    s_add_u32 m0, s57, 4096
    s_add_u32 s60, s55, 202752
    buffer_load_dwordx4 v4, s[32:35], s60 offen lds
    v_mfma_f32_16x16x32_bf16 v[48:51], v[196:199], v[144:147], v[48:51]
    v_mfma_f32_16x16x32_bf16 v[64:67], v[196:199], v[148:151], v[64:67]
    s_add_u32 m0, s57, 5120
    s_add_u32 s60, s55, 211968
    buffer_load_dwordx4 v4, s[32:35], s60 offen lds
    v_mfma_f32_16x16x32_bf16 v[80:83], v[196:199], v[152:155], v[80:83]
    s_waitcnt lgkmcnt(4)
    v_mfma_f32_16x16x32_bf16 v[20:23], v[200:203], v[136:139], v[20:23]
    s_add_u32 m0, s57, 6144
    s_add_u32 s60, s55, 221184
    buffer_load_dwordx4 v4, s[32:35], s60 offen lds
    v_mfma_f32_16x16x32_bf16 v[36:39], v[200:203], v[140:143], v[36:39]
    v_mfma_f32_16x16x32_bf16 v[52:55], v[200:203], v[144:147], v[52:55]
    s_add_u32 m0, s57, 7168
    s_add_u32 s60, s55, 230400
    buffer_load_dwordx4 v4, s[32:35], s60 offen lds
    v_mfma_f32_16x16x32_bf16 v[68:71], v[200:203], v[148:151], v[68:71]
    v_mfma_f32_16x16x32_bf16 v[84:87], v[200:203], v[152:155], v[84:87]
    s_add_u32 s61, s53, 6144
    buffer_load_dwordx4 v[116:119], v3, s[44:47], s61 offen sc1
    s_waitcnt lgkmcnt(2)
    v_mfma_f32_16x16x32_bf16 v[24:27], v[204:207], v[136:139], v[24:27]
    v_mfma_f32_16x16x32_bf16 v[40:43], v[204:207], v[140:143], v[40:43]
    s_add_u32 s61, s53, 6144
    buffer_load_dwordx4 v[120:123], v228, s[44:47], s61 offen sc1
    v_mfma_f32_16x16x32_bf16 v[56:59], v[204:207], v[144:147], v[56:59]
    v_mfma_f32_16x16x32_bf16 v[72:75], v[204:207], v[148:151], v[72:75]
    s_add_u32 s61, s53, 6144
    buffer_load_dwordx4 v[124:127], v229, s[44:47], s61 offen sc1
    v_mfma_f32_16x16x32_bf16 v[88:91], v[204:207], v[152:155], v[88:91]
    s_waitcnt lgkmcnt(0)
    v_mfma_f32_16x16x32_bf16 v[28:31], v[208:211], v[136:139], v[28:31]
    s_add_u32 s61, s53, 6144
    buffer_load_dwordx4 v[128:131], v230, s[44:47], s61 offen sc1
    v_mfma_f32_16x16x32_bf16 v[44:47], v[208:211], v[140:143], v[44:47]
    v_mfma_f32_16x16x32_bf16 v[60:63], v[208:211], v[144:147], v[60:63]
    s_add_u32 s61, s53, 6144
    buffer_load_dwordx4 v[132:135], v231, s[44:47], s61 offen sc1
    v_mfma_f32_16x16x32_bf16 v[76:79], v[208:211], v[148:151], v[76:79]
    v_mfma_f32_16x16x32_bf16 v[92:95], v[208:211], v[152:155], v[92:95]
    s_waitcnt vmcnt(27)
    ds_read_b64_tr_b16 v[212:213], v6 offset:12288
    ds_read_b64_tr_b16 v[214:215], v6 offset:14336
    ds_read_b64_tr_b16 v[216:217], v7 offset:12288
    ds_read_b64_tr_b16 v[218:219], v7 offset:14336
    ds_read_b64_tr_b16 v[220:221], v8 offset:12288
    ds_read_b64_tr_b16 v[222:223], v8 offset:14336
    ds_read_b64_tr_b16 v[224:225], v9 offset:12288
    ds_read_b64_tr_b16 v[226:227], v9 offset:14336
    s_waitcnt lgkmcnt(6)
    v_mfma_f32_16x16x32_bf16 v[16:19], v[212:215], v[156:159], v[16:19]
    v_mfma_f32_16x16x32_bf16 v[32:35], v[212:215], v[160:163], v[32:35]
    s_add_u32 m0, s57, 8192
    s_add_u32 s60, s55, 239616
    buffer_load_dwordx4 v4, s[32:35], s60 offen lds
    v_mfma_f32_16x16x32_bf16 v[48:51], v[212:215], v[164:167], v[48:51]
    v_mfma_f32_16x16x32_bf16 v[64:67], v[212:215], v[168:171], v[64:67]
    s_add_u32 m0, s57, 9216
    s_add_u32 s60, s55, 248832
    buffer_load_dwordx4 v4, s[32:35], s60 offen lds
    v_mfma_f32_16x16x32_bf16 v[80:83], v[212:215], v[172:175], v[80:83]
    s_waitcnt lgkmcnt(4)
    v_mfma_f32_16x16x32_bf16 v[20:23], v[216:219], v[156:159], v[20:23]
    s_add_u32 m0, s57, 10240
    s_add_u32 s60, s55, 258048
    buffer_load_dwordx4 v4, s[32:35], s60 offen lds
    v_mfma_f32_16x16x32_bf16 v[36:39], v[216:219], v[160:163], v[36:39]
    v_mfma_f32_16x16x32_bf16 v[52:55], v[216:219], v[164:167], v[52:55]
    s_add_u32 m0, s57, 11264
    s_add_u32 s60, s55, 267264
    buffer_load_dwordx4 v4, s[32:35], s60 offen lds
    v_mfma_f32_16x16x32_bf16 v[68:71], v[216:219], v[168:171], v[68:71]
    v_mfma_f32_16x16x32_bf16 v[84:87], v[216:219], v[172:175], v[84:87]
    s_add_u32 s61, s53, 7168
    buffer_load_dwordx4 v[136:139], v3, s[44:47], s61 offen sc1
    s_waitcnt lgkmcnt(2)
    v_mfma_f32_16x16x32_bf16 v[24:27], v[220:223], v[156:159], v[24:27]
    v_mfma_f32_16x16x32_bf16 v[40:43], v[220:223], v[160:163], v[40:43]
    s_add_u32 s61, s53, 7168
    buffer_load_dwordx4 v[140:143], v228, s[44:47], s61 offen sc1
    v_mfma_f32_16x16x32_bf16 v[56:59], v[220:223], v[164:167], v[56:59]
    v_mfma_f32_16x16x32_bf16 v[72:75], v[220:223], v[168:171], v[72:75]
    s_add_u32 s61, s53, 7168
    buffer_load_dwordx4 v[144:147], v229, s[44:47], s61 offen sc1
    v_mfma_f32_16x16x32_bf16 v[88:91], v[220:223], v[172:175], v[88:91]
    s_waitcnt lgkmcnt(0)
    v_mfma_f32_16x16x32_bf16 v[28:31], v[224:227], v[156:159], v[28:31]
    s_add_u32 s61, s53, 7168
    buffer_load_dwordx4 v[148:151], v230, s[44:47], s61 offen sc1
    v_mfma_f32_16x16x32_bf16 v[44:47], v[224:227], v[160:163], v[44:47]
    v_mfma_f32_16x16x32_bf16 v[60:63], v[224:227], v[164:167], v[60:63]
    s_add_u32 s61, s53, 7168
    buffer_load_dwordx4 v[152:155], v231, s[44:47], s61 offen sc1
    v_mfma_f32_16x16x32_bf16 v[76:79], v[224:227], v[168:171], v[76:79]
    v_mfma_f32_16x16x32_bf16 v[92:95], v[224:227], v[172:175], v[92:95]
    s_waitcnt vmcnt(27)
    ds_read_b64_tr_b16 v[196:197], v6 offset:16384
    ds_read_b64_tr_b16 v[198:199], v6 offset:18432
    ds_read_b64_tr_b16 v[200:201], v7 offset:16384
    ds_read_b64_tr_b16 v[202:203], v7 offset:18432
    ds_read_b64_tr_b16 v[204:205], v8 offset:16384
    ds_read_b64_tr_b16 v[206:207], v8 offset:18432
    ds_read_b64_tr_b16 v[208:209], v9 offset:16384
    ds_read_b64_tr_b16 v[210:211], v9 offset:18432
    s_waitcnt lgkmcnt(6)
    v_mfma_f32_16x16x32_bf16 v[16:19], v[196:199], v[176:179], v[16:19]
    v_mfma_f32_16x16x32_bf16 v[32:35], v[196:199], v[180:183], v[32:35]
    s_add_u32 m0, s57, 12288
    s_add_u32 s60, s55, 276480
    buffer_load_dwordx4 v4, s[32:35], s60 offen lds
    v_mfma_f32_16x16x32_bf16 v[48:51], v[196:199], v[184:187], v[48:51]
    v_mfma_f32_16x16x32_bf16 v[64:67], v[196:199], v[188:191], v[64:67]
    s_add_u32 m0, s57, 13312
    s_add_u32 s60, s55, 285696
    buffer_load_dwordx4 v4, s[32:35], s60 offen lds
    v_mfma_f32_16x16x32_bf16 v[80:83], v[196:199], v[192:195], v[80:83]
    s_waitcnt lgkmcnt(4)
    v_mfma_f32_16x16x32_bf16 v[20:23], v[200:203], v[176:179], v[20:23]
    s_add_u32 m0, s57, 14336
    s_add_u32 s60, s55, 294912
    buffer_load_dwordx4 v4, s[32:35], s60 offen lds
    v_mfma_f32_16x16x32_bf16 v[36:39], v[200:203], v[180:183], v[36:39]
    v_mfma_f32_16x16x32_bf16 v[52:55], v[200:203], v[184:187], v[52:55]
    s_add_u32 m0, s57, 15360
    s_add_u32 s60, s55, 304128
    buffer_load_dwordx4 v4, s[32:35], s60 offen lds
    v_mfma_f32_16x16x32_bf16 v[68:71], v[200:203], v[188:191], v[68:71]
    v_mfma_f32_16x16x32_bf16 v[84:87], v[200:203], v[192:195], v[84:87]
    s_add_u32 s61, s53, 8192
    buffer_load_dwordx4 v[156:159], v3, s[44:47], s61 offen sc1
    s_waitcnt lgkmcnt(2)
    v_mfma_f32_16x16x32_bf16 v[24:27], v[204:207], v[176:179], v[24:27]
    v_mfma_f32_16x16x32_bf16 v[40:43], v[204:207], v[180:183], v[40:43]
    s_add_u32 s61, s53, 8192
    buffer_load_dwordx4 v[160:163], v228, s[44:47], s61 offen sc1
    v_mfma_f32_16x16x32_bf16 v[56:59], v[204:207], v[184:187], v[56:59]
    v_mfma_f32_16x16x32_bf16 v[72:75], v[204:207], v[188:191], v[72:75]
    s_add_u32 s61, s53, 8192
    buffer_load_dwordx4 v[164:167], v229, s[44:47], s61 offen sc1
    v_mfma_f32_16x16x32_bf16 v[88:91], v[204:207], v[192:195], v[88:91]
    s_waitcnt lgkmcnt(0)
    v_mfma_f32_16x16x32_bf16 v[28:31], v[208:211], v[176:179], v[28:31]
    s_add_u32 s61, s53, 8192
    buffer_load_dwordx4 v[168:171], v230, s[44:47], s61 offen sc1
    v_mfma_f32_16x16x32_bf16 v[44:47], v[208:211], v[180:183], v[44:47]
    v_mfma_f32_16x16x32_bf16 v[60:63], v[208:211], v[184:187], v[60:63]
    s_add_u32 s61, s53, 8192
    buffer_load_dwordx4 v[172:175], v231, s[44:47], s61 offen sc1
    v_mfma_f32_16x16x32_bf16 v[76:79], v[208:211], v[188:191], v[76:79]
    v_mfma_f32_16x16x32_bf16 v[92:95], v[208:211], v[192:195], v[92:95]
    s_waitcnt vmcnt(27)
    ds_read_b64_tr_b16 v[212:213], v6 offset:0
    ds_read_b64_tr_b16 v[214:215], v6 offset:2048
    ds_read_b64_tr_b16 v[216:217], v7 offset:0
    ds_read_b64_tr_b16 v[218:219], v7 offset:2048
    ds_read_b64_tr_b16 v[220:221], v8 offset:0
    ds_read_b64_tr_b16 v[222:223], v8 offset:2048
    ds_read_b64_tr_b16 v[224:225], v9 offset:0
    ds_read_b64_tr_b16 v[226:227], v9 offset:2048
    s_waitcnt lgkmcnt(6)
    v_mfma_f32_16x16x32_bf16 v[16:19], v[212:215], v[96:99], v[16:19]
    v_mfma_f32_16x16x32_bf16 v[32:35], v[212:215], v[100:103], v[32:35]
    s_add_u32 m0, s57, 16384
    s_add_u32 s60, s55, 331776
    buffer_load_dwordx4 v4, s[32:35], s60 offen lds
    v_mfma_f32_16x16x32_bf16 v[48:51], v[212:215], v[104:107], v[48:51]
    v_mfma_f32_16x16x32_bf16 v[64:67], v[212:215], v[108:111], v[64:67]
    s_add_u32 m0, s57, 17408
    s_add_u32 s60, s55, 340992
    buffer_load_dwordx4 v4, s[32:35], s60 offen lds
    v_mfma_f32_16x16x32_bf16 v[80:83], v[212:215], v[112:115], v[80:83]
    s_waitcnt lgkmcnt(4)
    v_mfma_f32_16x16x32_bf16 v[20:23], v[216:219], v[96:99], v[20:23]
    s_add_u32 m0, s57, 18432
    s_add_u32 s60, s55, 350208
    buffer_load_dwordx4 v4, s[32:35], s60 offen lds
    v_mfma_f32_16x16x32_bf16 v[36:39], v[216:219], v[100:103], v[36:39]
    v_mfma_f32_16x16x32_bf16 v[52:55], v[216:219], v[104:107], v[52:55]
    s_add_u32 m0, s57, 19456
    s_add_u32 s60, s55, 359424
    buffer_load_dwordx4 v4, s[32:35], s60 offen lds
    v_mfma_f32_16x16x32_bf16 v[68:71], v[216:219], v[108:111], v[68:71]
    v_mfma_f32_16x16x32_bf16 v[84:87], v[216:219], v[112:115], v[84:87]
    s_add_u32 s61, s53, 9216
    buffer_load_dwordx4 v[176:179], v3, s[44:47], s61 offen sc1
    s_waitcnt lgkmcnt(2)
    v_mfma_f32_16x16x32_bf16 v[24:27], v[220:223], v[96:99], v[24:27]
    v_mfma_f32_16x16x32_bf16 v[40:43], v[220:223], v[100:103], v[40:43]
    s_add_u32 s61, s53, 9216
    buffer_load_dwordx4 v[180:183], v228, s[44:47], s61 offen sc1
    v_mfma_f32_16x16x32_bf16 v[56:59], v[220:223], v[104:107], v[56:59]
    v_mfma_f32_16x16x32_bf16 v[72:75], v[220:223], v[108:111], v[72:75]
    s_add_u32 s61, s53, 9216
    buffer_load_dwordx4 v[184:187], v229, s[44:47], s61 offen sc1
    v_mfma_f32_16x16x32_bf16 v[88:91], v[220:223], v[112:115], v[88:91]
    s_waitcnt lgkmcnt(0)
    v_mfma_f32_16x16x32_bf16 v[28:31], v[224:227], v[96:99], v[28:31]
    s_add_u32 s61, s53, 9216
    buffer_load_dwordx4 v[188:191], v230, s[44:47], s61 offen sc1
    v_mfma_f32_16x16x32_bf16 v[44:47], v[224:227], v[100:103], v[44:47]
    v_mfma_f32_16x16x32_bf16 v[60:63], v[224:227], v[104:107], v[60:63]
    s_add_u32 s61, s53, 9216
    buffer_load_dwordx4 v[192:195], v231, s[44:47], s61 offen sc1
    v_mfma_f32_16x16x32_bf16 v[76:79], v[224:227], v[108:111], v[76:79]
    v_mfma_f32_16x16x32_bf16 v[92:95], v[224:227], v[112:115], v[92:95]
    s_waitcnt vmcnt(27)
    ds_read_b64_tr_b16 v[196:197], v6 offset:4096
    ds_read_b64_tr_b16 v[198:199], v6 offset:6144
    ds_read_b64_tr_b16 v[200:201], v7 offset:4096
    ds_read_b64_tr_b16 v[202:203], v7 offset:6144
    ds_read_b64_tr_b16 v[204:205], v8 offset:4096
    ds_read_b64_tr_b16 v[206:207], v8 offset:6144
    ds_read_b64_tr_b16 v[208:209], v9 offset:4096
    ds_read_b64_tr_b16 v[210:211], v9 offset:6144
    s_waitcnt lgkmcnt(6)
    v_mfma_f32_16x16x32_bf16 v[16:19], v[196:199], v[116:119], v[16:19]
    v_mfma_f32_16x16x32_bf16 v[32:35], v[196:199], v[120:123], v[32:35]
    s_add_u32 m0, s57, 0
    s_add_u32 s60, s55, 368640
    buffer_load_dwordx4 v4, s[32:35], s60 offen lds
    v_mfma_f32_16x16x32_bf16 v[48:51], v[196:199], v[124:127], v[48:51]
    v_mfma_f32_16x16x32_bf16 v[64:67], v[196:199], v[128:131], v[64:67]
    s_add_u32 m0, s57, 1024
    s_add_u32 s60, s55, 377856
    buffer_load_dwordx4 v4, s[32:35], s60 offen lds
    v_mfma_f32_16x16x32_bf16 v[80:83], v[196:199], v[132:135], v[80:83]
    s_waitcnt lgkmcnt(4)
    v_mfma_f32_16x16x32_bf16 v[20:23], v[200:203], v[116:119], v[20:23]
    s_add_u32 m0, s57, 2048
    s_add_u32 s60, s55, 387072
    buffer_load_dwordx4 v4, s[32:35], s60 offen lds
    v_mfma_f32_16x16x32_bf16 v[36:39], v[200:203], v[120:123], v[36:39]
    v_mfma_f32_16x16x32_bf16 v[52:55], v[200:203], v[124:127], v[52:55]
    s_add_u32 m0, s57, 3072
    s_add_u32 s60, s55, 396288
    buffer_load_dwordx4 v4, s[32:35], s60 offen lds
    v_mfma_f32_16x16x32_bf16 v[68:71], v[200:203], v[128:131], v[68:71]
    v_mfma_f32_16x16x32_bf16 v[84:87], v[200:203], v[132:135], v[84:87]
    s_add_u32 s61, s53, 10240
    buffer_load_dwordx4 v[96:99], v3, s[44:47], s61 offen sc1
    s_waitcnt lgkmcnt(2)
    v_mfma_f32_16x16x32_bf16 v[24:27], v[204:207], v[116:119], v[24:27]
    v_mfma_f32_16x16x32_bf16 v[40:43], v[204:207], v[120:123], v[40:43]
    s_add_u32 s61, s53, 10240
    buffer_load_dwordx4 v[100:103], v228, s[44:47], s61 offen sc1
    v_mfma_f32_16x16x32_bf16 v[56:59], v[204:207], v[124:127], v[56:59]
    v_mfma_f32_16x16x32_bf16 v[72:75], v[204:207], v[128:131], v[72:75]
    s_add_u32 s61, s53, 10240
    buffer_load_dwordx4 v[104:107], v229, s[44:47], s61 offen sc1
    v_mfma_f32_16x16x32_bf16 v[88:91], v[204:207], v[132:135], v[88:91]
    s_waitcnt lgkmcnt(0)
    v_mfma_f32_16x16x32_bf16 v[28:31], v[208:211], v[116:119], v[28:31]
    s_add_u32 s61, s53, 10240
    buffer_load_dwordx4 v[108:111], v230, s[44:47], s61 offen sc1
    v_mfma_f32_16x16x32_bf16 v[44:47], v[208:211], v[120:123], v[44:47]
    v_mfma_f32_16x16x32_bf16 v[60:63], v[208:211], v[124:127], v[60:63]
    s_add_u32 s61, s53, 10240
    buffer_load_dwordx4 v[112:115], v231, s[44:47], s61 offen sc1
    v_mfma_f32_16x16x32_bf16 v[76:79], v[208:211], v[128:131], v[76:79]
    v_mfma_f32_16x16x32_bf16 v[92:95], v[208:211], v[132:135], v[92:95]
    s_waitcnt vmcnt(27)
    ds_read_b64_tr_b16 v[212:213], v6 offset:8192
    ds_read_b64_tr_b16 v[214:215], v6 offset:10240
    ds_read_b64_tr_b16 v[216:217], v7 offset:8192
    ds_read_b64_tr_b16 v[218:219], v7 offset:10240
    ds_read_b64_tr_b16 v[220:221], v8 offset:8192
    ds_read_b64_tr_b16 v[222:223], v8 offset:10240
    ds_read_b64_tr_b16 v[224:225], v9 offset:8192
    ds_read_b64_tr_b16 v[226:227], v9 offset:10240
    s_waitcnt lgkmcnt(6)
    v_mfma_f32_16x16x32_bf16 v[16:19], v[212:215], v[136:139], v[16:19]
    v_mfma_f32_16x16x32_bf16 v[32:35], v[212:215], v[140:143], v[32:35]
    s_add_u32 m0, s57, 4096
    s_add_u32 s60, s55, 405504
    buffer_load_dwordx4 v4, s[32:35], s60 offen lds
    v_mfma_f32_16x16x32_bf16 v[48:51], v[212:215], v[144:147], v[48:51]
    v_mfma_f32_16x16x32_bf16 v[64:67], v[212:215], v[148:151], v[64:67]
    s_add_u32 m0, s57, 5120
    s_add_u32 s60, s55, 414720
    buffer_load_dwordx4 v4, s[32:35], s60 offen lds
    v_mfma_f32_16x16x32_bf16 v[80:83], v[212:215], v[152:155], v[80:83]
    s_waitcnt lgkmcnt(4)
    v_mfma_f32_16x16x32_bf16 v[20:23], v[216:219], v[136:139], v[20:23]
    s_add_u32 m0, s57, 6144
    s_add_u32 s60, s55, 423936
    buffer_load_dwordx4 v4, s[32:35], s60 offen lds
    v_mfma_f32_16x16x32_bf16 v[36:39], v[216:219], v[140:143], v[36:39]
    v_mfma_f32_16x16x32_bf16 v[52:55], v[216:219], v[144:147], v[52:55]
    s_add_u32 m0, s57, 7168
    s_add_u32 s60, s55, 433152
    buffer_load_dwordx4 v4, s[32:35], s60 offen lds
    v_mfma_f32_16x16x32_bf16 v[68:71], v[216:219], v[148:151], v[68:71]
    v_mfma_f32_16x16x32_bf16 v[84:87], v[216:219], v[152:155], v[84:87]
    s_add_u32 s61, s53, 11264
    buffer_load_dwordx4 v[116:119], v3, s[44:47], s61 offen sc1
    s_waitcnt lgkmcnt(2)
    v_mfma_f32_16x16x32_bf16 v[24:27], v[220:223], v[136:139], v[24:27]
    v_mfma_f32_16x16x32_bf16 v[40:43], v[220:223], v[140:143], v[40:43]
    s_add_u32 s61, s53, 11264
    buffer_load_dwordx4 v[120:123], v228, s[44:47], s61 offen sc1
    v_mfma_f32_16x16x32_bf16 v[56:59], v[220:223], v[144:147], v[56:59]
    v_mfma_f32_16x16x32_bf16 v[72:75], v[220:223], v[148:151], v[72:75]
    s_add_u32 s61, s53, 11264
    buffer_load_dwordx4 v[124:127], v229, s[44:47], s61 offen sc1
    v_mfma_f32_16x16x32_bf16 v[88:91], v[220:223], v[152:155], v[88:91]
    s_waitcnt lgkmcnt(0)
    v_mfma_f32_16x16x32_bf16 v[28:31], v[224:227], v[136:139], v[28:31]
    s_add_u32 s61, s53, 11264
    buffer_load_dwordx4 v[128:131], v230, s[44:47], s61 offen sc1
    v_mfma_f32_16x16x32_bf16 v[44:47], v[224:227], v[140:143], v[44:47]
    v_mfma_f32_16x16x32_bf16 v[60:63], v[224:227], v[144:147], v[60:63]
    s_add_u32 s61, s53, 11264
    buffer_load_dwordx4 v[132:135], v231, s[44:47], s61 offen sc1
    v_mfma_f32_16x16x32_bf16 v[76:79], v[224:227], v[148:151], v[76:79]
    v_mfma_f32_16x16x32_bf16 v[92:95], v[224:227], v[152:155], v[92:95]
    s_waitcnt vmcnt(27)
    ds_read_b64_tr_b16 v[196:197], v6 offset:12288
    ds_read_b64_tr_b16 v[198:199], v6 offset:14336
    ds_read_b64_tr_b16 v[200:201], v7 offset:12288
    ds_read_b64_tr_b16 v[202:203], v7 offset:14336
    ds_read_b64_tr_b16 v[204:205], v8 offset:12288
    ds_read_b64_tr_b16 v[206:207], v8 offset:14336
    ds_read_b64_tr_b16 v[208:209], v9 offset:12288
    ds_read_b64_tr_b16 v[210:211], v9 offset:14336
    s_waitcnt lgkmcnt(6)
    v_mfma_f32_16x16x32_bf16 v[16:19], v[196:199], v[156:159], v[16:19]
    v_mfma_f32_16x16x32_bf16 v[32:35], v[196:199], v[160:163], v[32:35]
    s_add_u32 m0, s57, 8192
    s_add_u32 s60, s55, 442368
    buffer_load_dwordx4 v4, s[32:35], s60 offen lds
    v_mfma_f32_16x16x32_bf16 v[48:51], v[196:199], v[164:167], v[48:51]
    v_mfma_f32_16x16x32_bf16 v[64:67], v[196:199], v[168:171], v[64:67]
    s_add_u32 m0, s57, 9216
    s_add_u32 s60, s55, 451584
    buffer_load_dwordx4 v4, s[32:35], s60 offen lds
    v_mfma_f32_16x16x32_bf16 v[80:83], v[196:199], v[172:175], v[80:83]
    s_waitcnt lgkmcnt(4)
    v_mfma_f32_16x16x32_bf16 v[20:23], v[200:203], v[156:159], v[20:23]
    s_add_u32 m0, s57, 10240
    s_add_u32 s60, s55, 460800
    buffer_load_dwordx4 v4, s[32:35], s60 offen lds
    v_mfma_f32_16x16x32_bf16 v[36:39], v[200:203], v[160:163], v[36:39]
    v_mfma_f32_16x16x32_bf16 v[52:55], v[200:203], v[164:167], v[52:55]
    s_add_u32 m0, s57, 11264
    s_add_u32 s60, s55, 470016
    buffer_load_dwordx4 v4, s[32:35], s60 offen lds
    v_mfma_f32_16x16x32_bf16 v[68:71], v[200:203], v[168:171], v[68:71]
    v_mfma_f32_16x16x32_bf16 v[84:87], v[200:203], v[172:175], v[84:87]
    s_add_u32 s61, s53, 12288
    buffer_load_dwordx4 v[136:139], v3, s[44:47], s61 offen sc1
    s_waitcnt lgkmcnt(2)
    v_mfma_f32_16x16x32_bf16 v[24:27], v[204:207], v[156:159], v[24:27]
    v_mfma_f32_16x16x32_bf16 v[40:43], v[204:207], v[160:163], v[40:43]
    s_add_u32 s61, s53, 12288
    buffer_load_dwordx4 v[140:143], v228, s[44:47], s61 offen sc1
    v_mfma_f32_16x16x32_bf16 v[56:59], v[204:207], v[164:167], v[56:59]
    v_mfma_f32_16x16x32_bf16 v[72:75], v[204:207], v[168:171], v[72:75]
    s_add_u32 s61, s53, 12288
    buffer_load_dwordx4 v[144:147], v229, s[44:47], s61 offen sc1
    v_mfma_f32_16x16x32_bf16 v[88:91], v[204:207], v[172:175], v[88:91]
    s_waitcnt lgkmcnt(0)
    v_mfma_f32_16x16x32_bf16 v[28:31], v[208:211], v[156:159], v[28:31]
    s_add_u32 s61, s53, 12288
    buffer_load_dwordx4 v[148:151], v230, s[44:47], s61 offen sc1
    v_mfma_f32_16x16x32_bf16 v[44:47], v[208:211], v[160:163], v[44:47]
    v_mfma_f32_16x16x32_bf16 v[60:63], v[208:211], v[164:167], v[60:63]
    s_add_u32 s61, s53, 12288
    buffer_load_dwordx4 v[152:155], v231, s[44:47], s61 offen sc1
    v_mfma_f32_16x16x32_bf16 v[76:79], v[208:211], v[168:171], v[76:79]
    v_mfma_f32_16x16x32_bf16 v[92:95], v[208:211], v[172:175], v[92:95]
    s_waitcnt vmcnt(27)
    ds_read_b64_tr_b16 v[212:213], v6 offset:16384
    ds_read_b64_tr_b16 v[214:215], v6 offset:18432
    ds_read_b64_tr_b16 v[216:217], v7 offset:16384
    ds_read_b64_tr_b16 v[218:219], v7 offset:18432
    ds_read_b64_tr_b16 v[220:221], v8 offset:16384
    ds_read_b64_tr_b16 v[222:223], v8 offset:18432
    ds_read_b64_tr_b16 v[224:225], v9 offset:16384
    ds_read_b64_tr_b16 v[226:227], v9 offset:18432
    s_waitcnt lgkmcnt(6)
    v_mfma_f32_16x16x32_bf16 v[16:19], v[212:215], v[176:179], v[16:19]
    v_mfma_f32_16x16x32_bf16 v[32:35], v[212:215], v[180:183], v[32:35]
    s_add_u32 m0, s57, 12288
    s_add_u32 s60, s55, 479232
    buffer_load_dwordx4 v14, s[32:35], s60 offen lds
    v_mfma_f32_16x16x32_bf16 v[48:51], v[212:215], v[184:187], v[48:51]
    v_mfma_f32_16x16x32_bf16 v[64:67], v[212:215], v[188:191], v[64:67]
    s_add_u32 m0, s57, 13312
    s_add_u32 s60, s55, 645120
    buffer_load_dwordx4 v14, s[32:35], s60 offen lds
    v_mfma_f32_16x16x32_bf16 v[80:83], v[212:215], v[192:195], v[80:83]
    s_waitcnt lgkmcnt(4)
    v_mfma_f32_16x16x32_bf16 v[20:23], v[216:219], v[176:179], v[20:23]
    s_add_u32 m0, s57, 14336
    s_add_u32 s60, s55, 483840
    buffer_load_dwordx4 v14, s[32:35], s60 offen lds
    v_mfma_f32_16x16x32_bf16 v[36:39], v[216:219], v[180:183], v[36:39]
    v_mfma_f32_16x16x32_bf16 v[52:55], v[216:219], v[184:187], v[52:55]
    s_add_u32 m0, s57, 15360
    s_add_u32 s60, s55, 649728
    buffer_load_dwordx4 v14, s[32:35], s60 offen lds
    v_mfma_f32_16x16x32_bf16 v[68:71], v[216:219], v[188:191], v[68:71]
    v_mfma_f32_16x16x32_bf16 v[84:87], v[216:219], v[192:195], v[84:87]
    s_add_u32 s61, s53, 13312
    buffer_load_dwordx4 v[156:159], v3, s[44:47], s61 offen sc1
    s_waitcnt lgkmcnt(2)
    v_mfma_f32_16x16x32_bf16 v[24:27], v[220:223], v[176:179], v[24:27]
    v_mfma_f32_16x16x32_bf16 v[40:43], v[220:223], v[180:183], v[40:43]
    s_add_u32 s61, s53, 13312
    buffer_load_dwordx4 v[160:163], v228, s[44:47], s61 offen sc1
    v_mfma_f32_16x16x32_bf16 v[56:59], v[220:223], v[184:187], v[56:59]
    v_mfma_f32_16x16x32_bf16 v[72:75], v[220:223], v[188:191], v[72:75]
    s_add_u32 s61, s53, 13312
    buffer_load_dwordx4 v[164:167], v229, s[44:47], s61 offen sc1
    v_mfma_f32_16x16x32_bf16 v[88:91], v[220:223], v[192:195], v[88:91]
    s_waitcnt lgkmcnt(0)
    v_mfma_f32_16x16x32_bf16 v[28:31], v[224:227], v[176:179], v[28:31]
    s_add_u32 s61, s53, 13312
    buffer_load_dwordx4 v[168:171], v230, s[44:47], s61 offen sc1
    v_mfma_f32_16x16x32_bf16 v[44:47], v[224:227], v[180:183], v[44:47]
    v_mfma_f32_16x16x32_bf16 v[60:63], v[224:227], v[184:187], v[60:63]
    s_add_u32 s61, s53, 13312
    buffer_load_dwordx4 v[172:175], v231, s[44:47], s61 offen sc1
    v_mfma_f32_16x16x32_bf16 v[76:79], v[224:227], v[188:191], v[76:79]
    v_mfma_f32_16x16x32_bf16 v[92:95], v[224:227], v[192:195], v[92:95]
    s_waitcnt vmcnt(27)
    ds_read_b64_tr_b16 v[196:197], v6 offset:0
    ds_read_b64_tr_b16 v[198:199], v6 offset:2048
    ds_read_b64_tr_b16 v[200:201], v7 offset:0
    ds_read_b64_tr_b16 v[202:203], v7 offset:2048
    ds_read_b64_tr_b16 v[204:205], v8 offset:0
    ds_read_b64_tr_b16 v[206:207], v8 offset:2048
    ds_read_b64_tr_b16 v[208:209], v9 offset:0
    ds_read_b64_tr_b16 v[210:211], v9 offset:2048
    s_waitcnt lgkmcnt(6)
    v_mfma_f32_16x16x32_bf16 v[16:19], v[196:199], v[96:99], v[16:19]
    v_mfma_f32_16x16x32_bf16 v[32:35], v[196:199], v[100:103], v[32:35]
    s_add_u32 m0, s57, 16384
    s_add_u32 s60, s55, 497664
    buffer_load_dwordx4 v4, s[32:35], s60 offen lds
    v_mfma_f32_16x16x32_bf16 v[48:51], v[196:199], v[104:107], v[48:51]
    v_mfma_f32_16x16x32_bf16 v[64:67], v[196:199], v[108:111], v[64:67]
    s_add_u32 m0, s57, 17408
    s_add_u32 s60, s55, 506880
    buffer_load_dwordx4 v4, s[32:35], s60 offen lds
    v_mfma_f32_16x16x32_bf16 v[80:83], v[196:199], v[112:115], v[80:83]
    s_waitcnt lgkmcnt(4)
    v_mfma_f32_16x16x32_bf16 v[20:23], v[200:203], v[96:99], v[20:23]
    s_add_u32 m0, s57, 18432
    s_add_u32 s60, s55, 516096
    buffer_load_dwordx4 v4, s[32:35], s60 offen lds
    v_mfma_f32_16x16x32_bf16 v[36:39], v[200:203], v[100:103], v[36:39]
    v_mfma_f32_16x16x32_bf16 v[52:55], v[200:203], v[104:107], v[52:55]
    s_add_u32 m0, s57, 19456
    s_add_u32 s60, s55, 525312
    buffer_load_dwordx4 v4, s[32:35], s60 offen lds
    v_mfma_f32_16x16x32_bf16 v[68:71], v[200:203], v[108:111], v[68:71]
    v_mfma_f32_16x16x32_bf16 v[84:87], v[200:203], v[112:115], v[84:87]
    s_add_u32 s61, s53, 14336
    buffer_load_dwordx4 v[176:179], v3, s[44:47], s61 offen sc1
    s_waitcnt lgkmcnt(2)
    v_mfma_f32_16x16x32_bf16 v[24:27], v[204:207], v[96:99], v[24:27]
    v_mfma_f32_16x16x32_bf16 v[40:43], v[204:207], v[100:103], v[40:43]
    s_add_u32 s61, s53, 14336
    buffer_load_dwordx4 v[180:183], v228, s[44:47], s61 offen sc1
    v_mfma_f32_16x16x32_bf16 v[56:59], v[204:207], v[104:107], v[56:59]
    v_mfma_f32_16x16x32_bf16 v[72:75], v[204:207], v[108:111], v[72:75]
    s_add_u32 s61, s53, 14336
    buffer_load_dwordx4 v[184:187], v229, s[44:47], s61 offen sc1
    v_mfma_f32_16x16x32_bf16 v[88:91], v[204:207], v[112:115], v[88:91]
    s_waitcnt lgkmcnt(0)
    v_mfma_f32_16x16x32_bf16 v[28:31], v[208:211], v[96:99], v[28:31]
    s_add_u32 s61, s53, 14336
    buffer_load_dwordx4 v[188:191], v230, s[44:47], s61 offen sc1
    v_mfma_f32_16x16x32_bf16 v[44:47], v[208:211], v[100:103], v[44:47]
    v_mfma_f32_16x16x32_bf16 v[60:63], v[208:211], v[104:107], v[60:63]
    s_add_u32 s61, s53, 14336
    buffer_load_dwordx4 v[192:195], v231, s[44:47], s61 offen sc1
    v_mfma_f32_16x16x32_bf16 v[76:79], v[208:211], v[108:111], v[76:79]
    v_mfma_f32_16x16x32_bf16 v[92:95], v[208:211], v[112:115], v[92:95]
    s_mul_i32 s88, s49, 80
    s_add_u32 s89, s88, 79
    s_min_u32 s89, s89, 2047
    s_lshr_b32 s90, s88, 8
    s_add_u32 s90, s90, 24
    s_lshl_b32 s90, s90, 8
    v_mov_b32 v241, s90
    s_lshr_b32 s90, s89, 8
    s_add_u32 s90, s90, 24
    s_lshl_b32 s90, s90, 8
    v_writelane_b32 v241, s90, 1
    s_mov_b32 s91, 55312384
    buffer_load_dword v240, v241, s[24:27], s91 offen sc1
    s_waitcnt vmcnt(28)
    ds_read_b64_tr_b16 v[212:213], v6 offset:4096
    ds_read_b64_tr_b16 v[214:215], v6 offset:6144
    ds_read_b64_tr_b16 v[216:217], v7 offset:4096
    ds_read_b64_tr_b16 v[218:219], v7 offset:6144
    ds_read_b64_tr_b16 v[220:221], v8 offset:4096
    ds_read_b64_tr_b16 v[222:223], v8 offset:6144
    ds_read_b64_tr_b16 v[224:225], v9 offset:4096
    ds_read_b64_tr_b16 v[226:227], v9 offset:6144
    s_waitcnt lgkmcnt(6)
    v_mfma_f32_16x16x32_bf16 v[16:19], v[212:215], v[116:119], v[16:19]
    v_mfma_f32_16x16x32_bf16 v[32:35], v[212:215], v[120:123], v[32:35]
    s_add_u32 m0, s57, 0
    s_add_u32 s60, s55, 534528
    buffer_load_dwordx4 v4, s[32:35], s60 offen lds
    v_mfma_f32_16x16x32_bf16 v[48:51], v[212:215], v[124:127], v[48:51]
    v_mfma_f32_16x16x32_bf16 v[64:67], v[212:215], v[128:131], v[64:67]
    s_add_u32 m0, s57, 1024
    s_add_u32 s60, s55, 543744
    buffer_load_dwordx4 v4, s[32:35], s60 offen lds
    v_mfma_f32_16x16x32_bf16 v[80:83], v[212:215], v[132:135], v[80:83]
    s_waitcnt lgkmcnt(4)
    v_mfma_f32_16x16x32_bf16 v[20:23], v[216:219], v[116:119], v[20:23]
    s_add_u32 m0, s57, 2048
    s_add_u32 s60, s55, 552960
    buffer_load_dwordx4 v4, s[32:35], s60 offen lds
    v_mfma_f32_16x16x32_bf16 v[36:39], v[216:219], v[120:123], v[36:39]
    v_mfma_f32_16x16x32_bf16 v[52:55], v[216:219], v[124:127], v[52:55]
    s_add_u32 m0, s57, 3072
    s_add_u32 s60, s55, 562176
    buffer_load_dwordx4 v4, s[32:35], s60 offen lds
    v_mfma_f32_16x16x32_bf16 v[68:71], v[216:219], v[128:131], v[68:71]
    v_mfma_f32_16x16x32_bf16 v[84:87], v[216:219], v[132:135], v[84:87]
    s_add_u32 s61, s53, 15360
    buffer_load_dwordx4 v[96:99], v3, s[44:47], s61 offen sc1
    s_waitcnt lgkmcnt(2)
    v_mfma_f32_16x16x32_bf16 v[24:27], v[220:223], v[116:119], v[24:27]
    v_mfma_f32_16x16x32_bf16 v[40:43], v[220:223], v[120:123], v[40:43]
    s_add_u32 s61, s53, 15360
    buffer_load_dwordx4 v[100:103], v228, s[44:47], s61 offen sc1
    v_mfma_f32_16x16x32_bf16 v[56:59], v[220:223], v[124:127], v[56:59]
    v_mfma_f32_16x16x32_bf16 v[72:75], v[220:223], v[128:131], v[72:75]
    s_add_u32 s61, s53, 15360
    buffer_load_dwordx4 v[104:107], v229, s[44:47], s61 offen sc1
    v_mfma_f32_16x16x32_bf16 v[88:91], v[220:223], v[132:135], v[88:91]
    s_waitcnt lgkmcnt(0)
    v_mfma_f32_16x16x32_bf16 v[28:31], v[224:227], v[116:119], v[28:31]
    s_add_u32 s61, s53, 15360
    buffer_load_dwordx4 v[108:111], v230, s[44:47], s61 offen sc1
    v_mfma_f32_16x16x32_bf16 v[44:47], v[224:227], v[120:123], v[44:47]
    v_mfma_f32_16x16x32_bf16 v[60:63], v[224:227], v[124:127], v[60:63]
    s_add_u32 s61, s53, 15360
    buffer_load_dwordx4 v[112:115], v231, s[44:47], s61 offen sc1
    v_mfma_f32_16x16x32_bf16 v[76:79], v[224:227], v[128:131], v[76:79]
    v_mfma_f32_16x16x32_bf16 v[92:95], v[224:227], v[132:135], v[92:95]
    s_waitcnt vmcnt(28)
    ds_read_b64_tr_b16 v[196:197], v6 offset:8192
    ds_read_b64_tr_b16 v[198:199], v6 offset:10240
    ds_read_b64_tr_b16 v[200:201], v7 offset:8192
    ds_read_b64_tr_b16 v[202:203], v7 offset:10240
    ds_read_b64_tr_b16 v[204:205], v8 offset:8192
    ds_read_b64_tr_b16 v[206:207], v8 offset:10240
    ds_read_b64_tr_b16 v[208:209], v9 offset:8192
    ds_read_b64_tr_b16 v[210:211], v9 offset:10240
    s_waitcnt lgkmcnt(6)
    v_mfma_f32_16x16x32_bf16 v[16:19], v[196:199], v[136:139], v[16:19]
    v_mfma_f32_16x16x32_bf16 v[32:35], v[196:199], v[140:143], v[32:35]
    s_add_u32 m0, s57, 4096
    s_add_u32 s60, s55, 571392
    buffer_load_dwordx4 v4, s[32:35], s60 offen lds
    v_mfma_f32_16x16x32_bf16 v[48:51], v[196:199], v[144:147], v[48:51]
    v_mfma_f32_16x16x32_bf16 v[64:67], v[196:199], v[148:151], v[64:67]
    s_add_u32 m0, s57, 5120
    s_add_u32 s60, s55, 580608
    buffer_load_dwordx4 v4, s[32:35], s60 offen lds
    v_mfma_f32_16x16x32_bf16 v[80:83], v[196:199], v[152:155], v[80:83]
    s_waitcnt lgkmcnt(4)
    v_mfma_f32_16x16x32_bf16 v[20:23], v[200:203], v[136:139], v[20:23]
    s_add_u32 m0, s57, 6144
    s_add_u32 s60, s55, 589824
    buffer_load_dwordx4 v4, s[32:35], s60 offen lds
    v_mfma_f32_16x16x32_bf16 v[36:39], v[200:203], v[140:143], v[36:39]
    v_mfma_f32_16x16x32_bf16 v[52:55], v[200:203], v[144:147], v[52:55]
    s_add_u32 m0, s57, 7168
    s_add_u32 s60, s55, 599040
    buffer_load_dwordx4 v4, s[32:35], s60 offen lds
    v_mfma_f32_16x16x32_bf16 v[68:71], v[200:203], v[148:151], v[68:71]
    v_mfma_f32_16x16x32_bf16 v[84:87], v[200:203], v[152:155], v[84:87]
    s_add_u32 s61, s53, 16384
    buffer_load_dwordx4 v[116:119], v3, s[44:47], s61 offen sc1
    s_waitcnt lgkmcnt(2)
    v_mfma_f32_16x16x32_bf16 v[24:27], v[204:207], v[136:139], v[24:27]
    v_mfma_f32_16x16x32_bf16 v[40:43], v[204:207], v[140:143], v[40:43]
    s_add_u32 s61, s53, 16384
    buffer_load_dwordx4 v[120:123], v228, s[44:47], s61 offen sc1
    v_mfma_f32_16x16x32_bf16 v[56:59], v[204:207], v[144:147], v[56:59]
    v_mfma_f32_16x16x32_bf16 v[72:75], v[204:207], v[148:151], v[72:75]
    s_add_u32 s61, s53, 16384
    buffer_load_dwordx4 v[124:127], v229, s[44:47], s61 offen sc1
    v_mfma_f32_16x16x32_bf16 v[88:91], v[204:207], v[152:155], v[88:91]
    s_waitcnt lgkmcnt(0)
    v_mfma_f32_16x16x32_bf16 v[28:31], v[208:211], v[136:139], v[28:31]
    s_add_u32 s61, s53, 16384
    buffer_load_dwordx4 v[128:131], v230, s[44:47], s61 offen sc1
    v_mfma_f32_16x16x32_bf16 v[44:47], v[208:211], v[140:143], v[44:47]
    v_mfma_f32_16x16x32_bf16 v[60:63], v[208:211], v[144:147], v[60:63]
    s_add_u32 s61, s53, 16384
    buffer_load_dwordx4 v[132:135], v231, s[44:47], s61 offen sc1
    v_mfma_f32_16x16x32_bf16 v[76:79], v[208:211], v[148:151], v[76:79]
    v_mfma_f32_16x16x32_bf16 v[92:95], v[208:211], v[152:155], v[92:95]
    s_waitcnt vmcnt(28)
    ds_read_b64_tr_b16 v[212:213], v6 offset:12288
    ds_read_b64_tr_b16 v[214:215], v6 offset:14336
    ds_read_b64_tr_b16 v[216:217], v7 offset:12288
    ds_read_b64_tr_b16 v[218:219], v7 offset:14336
    ds_read_b64_tr_b16 v[220:221], v8 offset:12288
    ds_read_b64_tr_b16 v[222:223], v8 offset:14336
    ds_read_b64_tr_b16 v[224:225], v9 offset:12288
    ds_read_b64_tr_b16 v[226:227], v9 offset:14336
    s_waitcnt lgkmcnt(6)
    v_mfma_f32_16x16x32_bf16 v[16:19], v[212:215], v[156:159], v[16:19]
    v_mfma_f32_16x16x32_bf16 v[32:35], v[212:215], v[160:163], v[32:35]
    s_add_u32 m0, s57, 8192
    s_add_u32 s60, s55, 608256
    buffer_load_dwordx4 v4, s[32:35], s60 offen lds
    v_mfma_f32_16x16x32_bf16 v[48:51], v[212:215], v[164:167], v[48:51]
    v_mfma_f32_16x16x32_bf16 v[64:67], v[212:215], v[168:171], v[64:67]
    s_add_u32 m0, s57, 9216
    s_add_u32 s60, s55, 617472
    buffer_load_dwordx4 v4, s[32:35], s60 offen lds
    v_mfma_f32_16x16x32_bf16 v[80:83], v[212:215], v[172:175], v[80:83]
    s_waitcnt lgkmcnt(4)
    v_mfma_f32_16x16x32_bf16 v[20:23], v[216:219], v[156:159], v[20:23]
    s_add_u32 m0, s57, 10240
    s_add_u32 s60, s55, 626688
    buffer_load_dwordx4 v4, s[32:35], s60 offen lds
    v_mfma_f32_16x16x32_bf16 v[36:39], v[216:219], v[160:163], v[36:39]
    v_mfma_f32_16x16x32_bf16 v[52:55], v[216:219], v[164:167], v[52:55]
    s_add_u32 m0, s57, 11264
    s_add_u32 s60, s55, 635904
    buffer_load_dwordx4 v4, s[32:35], s60 offen lds
    v_mfma_f32_16x16x32_bf16 v[68:71], v[216:219], v[168:171], v[68:71]
    v_mfma_f32_16x16x32_bf16 v[84:87], v[216:219], v[172:175], v[84:87]
    s_add_u32 s61, s53, 17408
    buffer_load_dwordx4 v[136:139], v3, s[44:47], s61 offen sc1
    s_waitcnt lgkmcnt(2)
    v_mfma_f32_16x16x32_bf16 v[24:27], v[220:223], v[156:159], v[24:27]
    v_mfma_f32_16x16x32_bf16 v[40:43], v[220:223], v[160:163], v[40:43]
    s_add_u32 s61, s53, 17408
    buffer_load_dwordx4 v[140:143], v228, s[44:47], s61 offen sc1
    v_mfma_f32_16x16x32_bf16 v[56:59], v[220:223], v[164:167], v[56:59]
    v_mfma_f32_16x16x32_bf16 v[72:75], v[220:223], v[168:171], v[72:75]
    s_add_u32 s61, s53, 17408
    buffer_load_dwordx4 v[144:147], v229, s[44:47], s61 offen sc1
    v_mfma_f32_16x16x32_bf16 v[88:91], v[220:223], v[172:175], v[88:91]
    s_waitcnt lgkmcnt(0)
    v_mfma_f32_16x16x32_bf16 v[28:31], v[224:227], v[156:159], v[28:31]
    s_add_u32 s61, s53, 17408
    buffer_load_dwordx4 v[148:151], v230, s[44:47], s61 offen sc1
    v_mfma_f32_16x16x32_bf16 v[44:47], v[224:227], v[160:163], v[44:47]
    v_mfma_f32_16x16x32_bf16 v[60:63], v[224:227], v[164:167], v[60:63]
    s_add_u32 s61, s53, 17408
    buffer_load_dwordx4 v[152:155], v231, s[44:47], s61 offen sc1
    v_mfma_f32_16x16x32_bf16 v[76:79], v[224:227], v[168:171], v[76:79]
    v_mfma_f32_16x16x32_bf16 v[92:95], v[224:227], v[172:175], v[92:95]
    s_waitcnt vmcnt(28)
    ds_read_b64_tr_b16 v[196:197], v6 offset:16384
    ds_read_b64_tr_b16 v[198:199], v6 offset:18432
    ds_read_b64_tr_b16 v[200:201], v7 offset:16384
    ds_read_b64_tr_b16 v[202:203], v7 offset:18432
    ds_read_b64_tr_b16 v[204:205], v8 offset:16384
    ds_read_b64_tr_b16 v[206:207], v8 offset:18432
    ds_read_b64_tr_b16 v[208:209], v9 offset:16384
    ds_read_b64_tr_b16 v[210:211], v9 offset:18432
    s_waitcnt lgkmcnt(6)
    v_mfma_f32_16x16x32_bf16 v[16:19], v[196:199], v[176:179], v[16:19]
    v_mfma_f32_16x16x32_bf16 v[32:35], v[196:199], v[180:183], v[32:35]
    s_add_u32 m0, s57, 12288
    s_add_u32 s60, s58, 0
    buffer_load_dwordx4 v4, s[28:31], s60 offen lds
    v_mfma_f32_16x16x32_bf16 v[48:51], v[196:199], v[184:187], v[48:51]
    v_mfma_f32_16x16x32_bf16 v[64:67], v[196:199], v[188:191], v[64:67]
    s_add_u32 m0, s57, 13312
    s_add_u32 s60, s58, 20736
    buffer_load_dwordx4 v4, s[28:31], s60 offen lds
    v_mfma_f32_16x16x32_bf16 v[80:83], v[196:199], v[192:195], v[80:83]
    s_waitcnt lgkmcnt(4)
    v_mfma_f32_16x16x32_bf16 v[20:23], v[200:203], v[176:179], v[20:23]
    s_add_u32 m0, s57, 14336
    s_add_u32 s60, s58, 9216
    buffer_load_dwordx4 v4, s[28:31], s60 offen lds
    v_mfma_f32_16x16x32_bf16 v[36:39], v[200:203], v[180:183], v[36:39]
    v_mfma_f32_16x16x32_bf16 v[52:55], v[200:203], v[184:187], v[52:55]
    s_add_u32 m0, s57, 15360
    s_add_u32 s60, s58, 29952
    buffer_load_dwordx4 v4, s[28:31], s60 offen lds
    v_mfma_f32_16x16x32_bf16 v[68:71], v[200:203], v[188:191], v[68:71]
    v_mfma_f32_16x16x32_bf16 v[84:87], v[200:203], v[192:195], v[84:87]
    s_waitcnt lgkmcnt(2)
    v_mfma_f32_16x16x32_bf16 v[24:27], v[204:207], v[176:179], v[24:27]
    v_mfma_f32_16x16x32_bf16 v[40:43], v[204:207], v[180:183], v[40:43]
    v_mfma_f32_16x16x32_bf16 v[56:59], v[204:207], v[184:187], v[56:59]
    v_mfma_f32_16x16x32_bf16 v[72:75], v[204:207], v[188:191], v[72:75]
    v_mfma_f32_16x16x32_bf16 v[88:91], v[204:207], v[192:195], v[88:91]
    s_waitcnt lgkmcnt(0)
    v_mfma_f32_16x16x32_bf16 v[28:31], v[208:211], v[176:179], v[28:31]
    v_mfma_f32_16x16x32_bf16 v[44:47], v[208:211], v[180:183], v[44:47]
    v_mfma_f32_16x16x32_bf16 v[60:63], v[208:211], v[184:187], v[60:63]
    v_mfma_f32_16x16x32_bf16 v[76:79], v[208:211], v[188:191], v[76:79]
    v_mfma_f32_16x16x32_bf16 v[92:95], v[208:211], v[192:195], v[92:95]
    s_waitcnt vmcnt(22)
    ds_read_b64_tr_b16 v[212:213], v6 offset:0
    ds_read_b64_tr_b16 v[214:215], v6 offset:2048
    ds_read_b64_tr_b16 v[216:217], v7 offset:0
    ds_read_b64_tr_b16 v[218:219], v7 offset:2048
    ds_read_b64_tr_b16 v[220:221], v8 offset:0
    ds_read_b64_tr_b16 v[222:223], v8 offset:2048
    ds_read_b64_tr_b16 v[224:225], v9 offset:0
    ds_read_b64_tr_b16 v[226:227], v9 offset:2048
    s_waitcnt lgkmcnt(6)
    v_mfma_f32_16x16x32_bf16 v[16:19], v[212:215], v[96:99], v[16:19]
    v_mfma_f32_16x16x32_bf16 v[32:35], v[212:215], v[100:103], v[32:35]
    s_add_u32 m0, s57, 16384
    s_add_u32 s60, s58, 165888
    buffer_load_dwordx4 v4, s[28:31], s60 offen lds
    v_mfma_f32_16x16x32_bf16 v[48:51], v[212:215], v[104:107], v[48:51]
    v_mfma_f32_16x16x32_bf16 v[64:67], v[212:215], v[108:111], v[64:67]
    s_add_u32 m0, s57, 17408
    s_add_u32 s60, s58, 186624
    buffer_load_dwordx4 v4, s[28:31], s60 offen lds
    v_mfma_f32_16x16x32_bf16 v[80:83], v[212:215], v[112:115], v[80:83]
    s_waitcnt lgkmcnt(4)
    v_mfma_f32_16x16x32_bf16 v[20:23], v[216:219], v[96:99], v[20:23]
    s_add_u32 m0, s57, 18432
    s_add_u32 s60, s58, 175104
    buffer_load_dwordx4 v4, s[28:31], s60 offen lds
    v_mfma_f32_16x16x32_bf16 v[36:39], v[216:219], v[100:103], v[36:39]
    v_mfma_f32_16x16x32_bf16 v[52:55], v[216:219], v[104:107], v[52:55]
    s_add_u32 m0, s57, 19456
    s_add_u32 s60, s58, 195840
    buffer_load_dwordx4 v4, s[28:31], s60 offen lds
    v_mfma_f32_16x16x32_bf16 v[68:71], v[216:219], v[108:111], v[68:71]
    v_mfma_f32_16x16x32_bf16 v[84:87], v[216:219], v[112:115], v[84:87]
    s_waitcnt lgkmcnt(2)
    v_mfma_f32_16x16x32_bf16 v[24:27], v[220:223], v[96:99], v[24:27]
    v_mfma_f32_16x16x32_bf16 v[40:43], v[220:223], v[100:103], v[40:43]
    v_mfma_f32_16x16x32_bf16 v[56:59], v[220:223], v[104:107], v[56:59]
    v_mfma_f32_16x16x32_bf16 v[72:75], v[220:223], v[108:111], v[72:75]
    v_mfma_f32_16x16x32_bf16 v[88:91], v[220:223], v[112:115], v[88:91]
    s_waitcnt lgkmcnt(0)
    v_mfma_f32_16x16x32_bf16 v[28:31], v[224:227], v[96:99], v[28:31]
    v_mfma_f32_16x16x32_bf16 v[44:47], v[224:227], v[100:103], v[44:47]
    v_mfma_f32_16x16x32_bf16 v[60:63], v[224:227], v[104:107], v[60:63]
    v_mfma_f32_16x16x32_bf16 v[76:79], v[224:227], v[108:111], v[76:79]
    v_mfma_f32_16x16x32_bf16 v[92:95], v[224:227], v[112:115], v[92:95]
    s_waitcnt vmcnt(17)
    ds_read_b64_tr_b16 v[196:197], v6 offset:4096
    ds_read_b64_tr_b16 v[198:199], v6 offset:6144
    ds_read_b64_tr_b16 v[200:201], v7 offset:4096
    ds_read_b64_tr_b16 v[202:203], v7 offset:6144
    ds_read_b64_tr_b16 v[204:205], v8 offset:4096
    ds_read_b64_tr_b16 v[206:207], v8 offset:6144
    ds_read_b64_tr_b16 v[208:209], v9 offset:4096
    ds_read_b64_tr_b16 v[210:211], v9 offset:6144
L_k2o_poll_25:
    v_cmp_gt_u32 vcc, 32, v240
    s_nop 1
    s_and_b32 s90, vcc_lo, 3
    s_cmp_eq_u32 s90, 0
    s_cbranch_scc1 L_k2o_poll_25_ok
    s_sleep 16
    buffer_load_dword v240, v241, s[24:27], s91 offen sc1
    s_waitcnt vmcnt(0)
    s_branch L_k2o_poll_25
L_k2o_poll_25_ok:
    s_waitcnt lgkmcnt(6)
    v_mfma_f32_16x16x32_bf16 v[16:19], v[196:199], v[116:119], v[16:19]
    v_mfma_f32_16x16x32_bf16 v[32:35], v[196:199], v[120:123], v[32:35]
    s_add_u32 s61, s54, 0
    buffer_load_dwordx4 v[156:159], v3, s[44:47], s61 offen sc1
    v_mfma_f32_16x16x32_bf16 v[48:51], v[196:199], v[124:127], v[48:51]
    v_mfma_f32_16x16x32_bf16 v[64:67], v[196:199], v[128:131], v[64:67]
    s_add_u32 s61, s54, 0
    buffer_load_dwordx4 v[160:163], v228, s[44:47], s61 offen sc1
    v_mfma_f32_16x16x32_bf16 v[80:83], v[196:199], v[132:135], v[80:83]
    s_waitcnt lgkmcnt(4)
    v_mfma_f32_16x16x32_bf16 v[20:23], v[200:203], v[116:119], v[20:23]
    s_add_u32 s61, s54, 0
    buffer_load_dwordx4 v[164:167], v229, s[44:47], s61 offen sc1
    v_mfma_f32_16x16x32_bf16 v[36:39], v[200:203], v[120:123], v[36:39]
    v_mfma_f32_16x16x32_bf16 v[52:55], v[200:203], v[124:127], v[52:55]
    s_add_u32 s61, s54, 0
    buffer_load_dwordx4 v[168:171], v230, s[44:47], s61 offen sc1
    v_mfma_f32_16x16x32_bf16 v[68:71], v[200:203], v[128:131], v[68:71]
    v_mfma_f32_16x16x32_bf16 v[84:87], v[200:203], v[132:135], v[84:87]
    s_add_u32 s61, s54, 0
    buffer_load_dwordx4 v[172:175], v231, s[44:47], s61 offen sc1
    s_waitcnt lgkmcnt(2)
    v_mfma_f32_16x16x32_bf16 v[24:27], v[204:207], v[116:119], v[24:27]
    v_mfma_f32_16x16x32_bf16 v[40:43], v[204:207], v[120:123], v[40:43]
    s_add_u32 m0, s57, 0
    s_add_u32 s60, s58, 331776
    buffer_load_dwordx4 v4, s[28:31], s60 offen lds
    v_mfma_f32_16x16x32_bf16 v[56:59], v[204:207], v[124:127], v[56:59]
    v_mfma_f32_16x16x32_bf16 v[72:75], v[204:207], v[128:131], v[72:75]
    s_add_u32 m0, s57, 1024
    s_add_u32 s60, s58, 352512
    buffer_load_dwordx4 v4, s[28:31], s60 offen lds
    v_mfma_f32_16x16x32_bf16 v[88:91], v[204:207], v[132:135], v[88:91]
    s_waitcnt lgkmcnt(0)
    v_mfma_f32_16x16x32_bf16 v[28:31], v[208:211], v[116:119], v[28:31]
    s_add_u32 m0, s57, 2048
    s_add_u32 s60, s58, 340992
    buffer_load_dwordx4 v4, s[28:31], s60 offen lds
    v_mfma_f32_16x16x32_bf16 v[44:47], v[208:211], v[120:123], v[44:47]
    v_mfma_f32_16x16x32_bf16 v[60:63], v[208:211], v[124:127], v[60:63]
    s_add_u32 m0, s57, 3072
    s_add_u32 s60, s58, 361728
    buffer_load_dwordx4 v4, s[28:31], s60 offen lds
    v_mfma_f32_16x16x32_bf16 v[76:79], v[208:211], v[128:131], v[76:79]
    v_mfma_f32_16x16x32_bf16 v[92:95], v[208:211], v[132:135], v[92:95]
    s_waitcnt vmcnt(17)
    ds_read_b64_tr_b16 v[212:213], v6 offset:8192
    ds_read_b64_tr_b16 v[214:215], v6 offset:10240
    ds_read_b64_tr_b16 v[216:217], v7 offset:8192
    ds_read_b64_tr_b16 v[218:219], v7 offset:10240
    ds_read_b64_tr_b16 v[220:221], v8 offset:8192
    ds_read_b64_tr_b16 v[222:223], v8 offset:10240
    ds_read_b64_tr_b16 v[224:225], v9 offset:8192
    ds_read_b64_tr_b16 v[226:227], v9 offset:10240
    s_waitcnt lgkmcnt(6)
    v_mfma_f32_16x16x32_bf16 v[16:19], v[212:215], v[136:139], v[16:19]
    v_mfma_f32_16x16x32_bf16 v[32:35], v[212:215], v[140:143], v[32:35]
    s_add_u32 s61, s54, 4096
    buffer_load_dwordx4 v[176:179], v3, s[44:47], s61 offen sc1
    v_mfma_f32_16x16x32_bf16 v[48:51], v[212:215], v[144:147], v[48:51]
    v_mfma_f32_16x16x32_bf16 v[64:67], v[212:215], v[148:151], v[64:67]
    s_add_u32 s61, s54, 4096
    buffer_load_dwordx4 v[180:183], v228, s[44:47], s61 offen sc1
    v_mfma_f32_16x16x32_bf16 v[80:83], v[212:215], v[152:155], v[80:83]
    s_waitcnt lgkmcnt(4)
    v_mfma_f32_16x16x32_bf16 v[20:23], v[216:219], v[136:139], v[20:23]
    s_add_u32 s61, s54, 4096
    buffer_load_dwordx4 v[184:187], v229, s[44:47], s61 offen sc1
    v_mfma_f32_16x16x32_bf16 v[36:39], v[216:219], v[140:143], v[36:39]
    v_mfma_f32_16x16x32_bf16 v[52:55], v[216:219], v[144:147], v[52:55]
    s_add_u32 s61, s54, 4096
    buffer_load_dwordx4 v[188:191], v230, s[44:47], s61 offen sc1
    v_mfma_f32_16x16x32_bf16 v[68:71], v[216:219], v[148:151], v[68:71]
    v_mfma_f32_16x16x32_bf16 v[84:87], v[216:219], v[152:155], v[84:87]
    s_add_u32 s61, s54, 4096
    buffer_load_dwordx4 v[192:195], v231, s[44:47], s61 offen sc1
    s_waitcnt lgkmcnt(2)
    v_mfma_f32_16x16x32_bf16 v[24:27], v[220:223], v[136:139], v[24:27]
    v_mfma_f32_16x16x32_bf16 v[40:43], v[220:223], v[140:143], v[40:43]
    s_add_u32 m0, s57, 4096
    s_add_u32 s60, s58, 497664
    buffer_load_dwordx4 v4, s[28:31], s60 offen lds
    v_mfma_f32_16x16x32_bf16 v[56:59], v[220:223], v[144:147], v[56:59]
    v_mfma_f32_16x16x32_bf16 v[72:75], v[220:223], v[148:151], v[72:75]
    s_add_u32 m0, s57, 5120
    s_add_u32 s60, s58, 518400
    buffer_load_dwordx4 v4, s[28:31], s60 offen lds
    v_mfma_f32_16x16x32_bf16 v[88:91], v[220:223], v[152:155], v[88:91]
    s_waitcnt lgkmcnt(0)
    v_mfma_f32_16x16x32_bf16 v[28:31], v[224:227], v[136:139], v[28:31]
    s_add_u32 m0, s57, 6144
    s_add_u32 s60, s58, 506880
    buffer_load_dwordx4 v4, s[28:31], s60 offen lds
    v_mfma_f32_16x16x32_bf16 v[44:47], v[224:227], v[140:143], v[44:47]
    v_mfma_f32_16x16x32_bf16 v[60:63], v[224:227], v[144:147], v[60:63]
    s_add_u32 m0, s57, 7168
    s_add_u32 s60, s58, 527616
    buffer_load_dwordx4 v4, s[28:31], s60 offen lds
    v_mfma_f32_16x16x32_bf16 v[76:79], v[224:227], v[148:151], v[76:79]
    v_mfma_f32_16x16x32_bf16 v[92:95], v[224:227], v[152:155], v[92:95]
    s_waitcnt vmcnt(13)
    ds_read_b64_tr_b16 v[196:197], v6 offset:12288
    ds_read_b64_tr_b16 v[198:199], v6 offset:14336
    ds_read_b64_tr_b16 v[200:201], v7 offset:12288
    ds_read_b64_tr_b16 v[202:203], v7 offset:14336
    ds_read_b64_tr_b16 v[204:205], v8 offset:12288
    ds_read_b64_tr_b16 v[206:207], v8 offset:14336
    ds_read_b64_tr_b16 v[208:209], v9 offset:12288
    ds_read_b64_tr_b16 v[210:211], v9 offset:14336
    s_waitcnt lgkmcnt(6)
    v_mfma_f32_16x16x32_bf16 v[16:19], v[196:199], v[156:159], v[16:19]
    v_mfma_f32_16x16x32_bf16 v[32:35], v[196:199], v[160:163], v[32:35]
    s_add_u32 s61, s54, 8192
    buffer_load_dwordx4 v[96:99], v3, s[44:47], s61 offen sc1
    v_mfma_f32_16x16x32_bf16 v[48:51], v[196:199], v[164:167], v[48:51]
    v_mfma_f32_16x16x32_bf16 v[64:67], v[196:199], v[168:171], v[64:67]
    s_add_u32 s61, s54, 8192
    buffer_load_dwordx4 v[100:103], v228, s[44:47], s61 offen sc1
    v_mfma_f32_16x16x32_bf16 v[80:83], v[196:199], v[172:175], v[80:83]
    s_waitcnt lgkmcnt(4)
    v_mfma_f32_16x16x32_bf16 v[20:23], v[200:203], v[156:159], v[20:23]
    s_add_u32 s61, s54, 8192
    buffer_load_dwordx4 v[104:107], v229, s[44:47], s61 offen sc1
    v_mfma_f32_16x16x32_bf16 v[36:39], v[200:203], v[160:163], v[36:39]
    v_mfma_f32_16x16x32_bf16 v[52:55], v[200:203], v[164:167], v[52:55]
    s_add_u32 s61, s54, 8192
    buffer_load_dwordx4 v[108:111], v230, s[44:47], s61 offen sc1
    v_mfma_f32_16x16x32_bf16 v[68:71], v[200:203], v[168:171], v[68:71]
    v_mfma_f32_16x16x32_bf16 v[84:87], v[200:203], v[172:175], v[84:87]
    s_add_u32 s61, s54, 8192
    buffer_load_dwordx4 v[112:115], v231, s[44:47], s61 offen sc1
    s_waitcnt lgkmcnt(2)
    v_mfma_f32_16x16x32_bf16 v[24:27], v[204:207], v[156:159], v[24:27]
    v_mfma_f32_16x16x32_bf16 v[40:43], v[204:207], v[160:163], v[40:43]
    s_add_u32 m0, s57, 8192
    s_add_u32 s60, s59, 0
    buffer_load_dwordx4 v5, s[28:31], s60 offen lds
    v_mfma_f32_16x16x32_bf16 v[56:59], v[204:207], v[164:167], v[56:59]
    v_mfma_f32_16x16x32_bf16 v[72:75], v[204:207], v[168:171], v[72:75]
    s_add_u32 m0, s57, 9216
    s_add_u32 s60, s59, 165888
    buffer_load_dwordx4 v5, s[28:31], s60 offen lds
    v_mfma_f32_16x16x32_bf16 v[88:91], v[204:207], v[172:175], v[88:91]
    s_waitcnt lgkmcnt(0)
    v_mfma_f32_16x16x32_bf16 v[28:31], v[208:211], v[156:159], v[28:31]
    s_add_u32 m0, s57, 10240
    s_add_u32 s60, s59, 41472
    buffer_load_dwordx4 v5, s[28:31], s60 offen lds
    v_mfma_f32_16x16x32_bf16 v[44:47], v[208:211], v[160:163], v[44:47]
    v_mfma_f32_16x16x32_bf16 v[60:63], v[208:211], v[164:167], v[60:63]
    s_add_u32 m0, s57, 11264
    s_add_u32 s60, s59, 207360
    buffer_load_dwordx4 v5, s[28:31], s60 offen lds
    v_mfma_f32_16x16x32_bf16 v[76:79], v[208:211], v[168:171], v[76:79]
    v_mfma_f32_16x16x32_bf16 v[92:95], v[208:211], v[172:175], v[92:95]
    s_waitcnt vmcnt(13)
    ds_read_b64_tr_b16 v[212:213], v6 offset:16384
    ds_read_b64_tr_b16 v[214:215], v6 offset:18432
    ds_read_b64_tr_b16 v[216:217], v7 offset:16384
    ds_read_b64_tr_b16 v[218:219], v7 offset:18432
    ds_read_b64_tr_b16 v[220:221], v8 offset:16384
    ds_read_b64_tr_b16 v[222:223], v8 offset:18432
    ds_read_b64_tr_b16 v[224:225], v9 offset:16384
    ds_read_b64_tr_b16 v[226:227], v9 offset:18432
    s_waitcnt lgkmcnt(6)
    v_mfma_f32_16x16x32_bf16 v[16:19], v[212:215], v[176:179], v[16:19]
    v_mfma_f32_16x16x32_bf16 v[32:35], v[212:215], v[180:183], v[32:35]
    s_add_u32 s61, s54, 12288
    buffer_load_dwordx4 v[116:119], v3, s[44:47], s61 offen sc1
    v_mfma_f32_16x16x32_bf16 v[48:51], v[212:215], v[184:187], v[48:51]
    v_mfma_f32_16x16x32_bf16 v[64:67], v[212:215], v[188:191], v[64:67]
    s_add_u32 s61, s54, 12288
    buffer_load_dwordx4 v[120:123], v228, s[44:47], s61 offen sc1
    v_mfma_f32_16x16x32_bf16 v[80:83], v[212:215], v[192:195], v[80:83]
    s_waitcnt lgkmcnt(4)
    v_mfma_f32_16x16x32_bf16 v[20:23], v[216:219], v[176:179], v[20:23]
    s_add_u32 s61, s54, 12288
    buffer_load_dwordx4 v[124:127], v229, s[44:47], s61 offen sc1
    v_mfma_f32_16x16x32_bf16 v[36:39], v[216:219], v[180:183], v[36:39]
    v_mfma_f32_16x16x32_bf16 v[52:55], v[216:219], v[184:187], v[52:55]
    s_add_u32 s61, s54, 12288
    buffer_load_dwordx4 v[128:131], v230, s[44:47], s61 offen sc1
    v_mfma_f32_16x16x32_bf16 v[68:71], v[216:219], v[188:191], v[68:71]
    v_mfma_f32_16x16x32_bf16 v[84:87], v[216:219], v[192:195], v[84:87]
    s_add_u32 s61, s54, 12288
    buffer_load_dwordx4 v[132:135], v231, s[44:47], s61 offen sc1
    s_waitcnt lgkmcnt(2)
    v_mfma_f32_16x16x32_bf16 v[24:27], v[220:223], v[176:179], v[24:27]
    v_mfma_f32_16x16x32_bf16 v[40:43], v[220:223], v[180:183], v[40:43]
    v_mfma_f32_16x16x32_bf16 v[56:59], v[220:223], v[184:187], v[56:59]
    v_mfma_f32_16x16x32_bf16 v[72:75], v[220:223], v[188:191], v[72:75]
    v_mfma_f32_16x16x32_bf16 v[88:91], v[220:223], v[192:195], v[88:91]
    s_waitcnt lgkmcnt(0)
    v_mfma_f32_16x16x32_bf16 v[28:31], v[224:227], v[176:179], v[28:31]
    v_mfma_f32_16x16x32_bf16 v[44:47], v[224:227], v[180:183], v[44:47]
    v_mfma_f32_16x16x32_bf16 v[60:63], v[224:227], v[184:187], v[60:63]
    v_mfma_f32_16x16x32_bf16 v[76:79], v[224:227], v[188:191], v[76:79]
    v_mfma_f32_16x16x32_bf16 v[92:95], v[224:227], v[192:195], v[92:95]
    s_waitcnt vmcnt(9)
    ds_read_b64_tr_b16 v[196:197], v6 offset:0
    ds_read_b64_tr_b16 v[198:199], v6 offset:2048
    ds_read_b64_tr_b16 v[200:201], v7 offset:0
    ds_read_b64_tr_b16 v[202:203], v7 offset:2048
    ds_read_b64_tr_b16 v[204:205], v8 offset:0
    ds_read_b64_tr_b16 v[206:207], v8 offset:2048
    ds_read_b64_tr_b16 v[208:209], v9 offset:0
    ds_read_b64_tr_b16 v[210:211], v9 offset:2048
    s_waitcnt lgkmcnt(6)
    v_mfma_f32_16x16x32_bf16 v[16:19], v[196:199], v[96:99], v[16:19]
    s_add_u32 s61, s62, 0
    buffer_load_dword v136, v232, s[24:27], s61 offen sc1
    s_add_u32 s61, s62, 8192
    buffer_load_dword v137, v232, s[24:27], s61 offen sc1
    v_mfma_f32_16x16x32_bf16 v[32:35], v[196:199], v[100:103], v[32:35]
    s_add_u32 s61, s62, 16384
    buffer_load_dword v138, v232, s[24:27], s61 offen sc1
    s_add_u32 s61, s62, 24576
    buffer_load_dword v139, v232, s[24:27], s61 offen sc1
    v_mfma_f32_16x16x32_bf16 v[48:51], v[196:199], v[104:107], v[48:51]
    s_add_u32 s61, s62, 0
    buffer_load_dword v140, v233, s[24:27], s61 offen sc1
    s_add_u32 s61, s62, 8192
    buffer_load_dword v141, v233, s[24:27], s61 offen sc1
    v_mfma_f32_16x16x32_bf16 v[64:67], v[196:199], v[108:111], v[64:67]
    s_add_u32 s61, s62, 16384
    buffer_load_dword v142, v233, s[24:27], s61 offen sc1
    s_add_u32 s61, s62, 24576
    buffer_load_dword v143, v233, s[24:27], s61 offen sc1
    v_mfma_f32_16x16x32_bf16 v[80:83], v[196:199], v[112:115], v[80:83]
    s_add_u32 s61, s62, 0
    buffer_load_dword v144, v234, s[24:27], s61 offen sc1
    s_add_u32 s61, s62, 8192
    buffer_load_dword v145, v234, s[24:27], s61 offen sc1
    s_waitcnt lgkmcnt(4)
    v_mfma_f32_16x16x32_bf16 v[20:23], v[200:203], v[96:99], v[20:23]
    s_add_u32 s61, s62, 16384
    buffer_load_dword v146, v234, s[24:27], s61 offen sc1
    s_add_u32 s61, s62, 24576
    buffer_load_dword v147, v234, s[24:27], s61 offen sc1
    v_mfma_f32_16x16x32_bf16 v[36:39], v[200:203], v[100:103], v[36:39]
    v_mfma_f32_16x16x32_bf16 v[52:55], v[200:203], v[104:107], v[52:55]
    s_add_u32 s61, s62, 0
    buffer_load_dword v148, v235, s[24:27], s61 offen sc1
    s_add_u32 s61, s62, 8192
    buffer_load_dword v149, v235, s[24:27], s61 offen sc1
    v_mfma_f32_16x16x32_bf16 v[68:71], v[200:203], v[108:111], v[68:71]
    v_mfma_f32_16x16x32_bf16 v[84:87], v[200:203], v[112:115], v[84:87]
    s_add_u32 s61, s62, 16384
    buffer_load_dword v150, v235, s[24:27], s61 offen sc1
    s_add_u32 s61, s62, 24576
    buffer_load_dword v151, v235, s[24:27], s61 offen sc1
    s_waitcnt lgkmcnt(2)
    v_mfma_f32_16x16x32_bf16 v[24:27], v[204:207], v[96:99], v[24:27]
    v_mfma_f32_16x16x32_bf16 v[40:43], v[204:207], v[100:103], v[40:43]
    s_add_u32 s61, s62, 0
    buffer_load_dword v152, v236, s[24:27], s61 offen sc1
    s_add_u32 s61, s62, 8192
    buffer_load_dword v153, v236, s[24:27], s61 offen sc1
    v_mfma_f32_16x16x32_bf16 v[56:59], v[204:207], v[104:107], v[56:59]
    v_mfma_f32_16x16x32_bf16 v[72:75], v[204:207], v[108:111], v[72:75]
    s_add_u32 s61, s62, 16384
    buffer_load_dword v154, v236, s[24:27], s61 offen sc1
    s_add_u32 s61, s62, 24576
    buffer_load_dword v155, v236, s[24:27], s61 offen sc1
    v_mfma_f32_16x16x32_bf16 v[88:91], v[204:207], v[112:115], v[88:91]
    s_waitcnt lgkmcnt(0)
    v_mfma_f32_16x16x32_bf16 v[28:31], v[208:211], v[96:99], v[28:31]
    v_mfma_f32_16x16x32_bf16 v[44:47], v[208:211], v[100:103], v[44:47]
    v_mfma_f32_16x16x32_bf16 v[60:63], v[208:211], v[104:107], v[60:63]
    v_mfma_f32_16x16x32_bf16 v[76:79], v[208:211], v[108:111], v[76:79]
    v_mfma_f32_16x16x32_bf16 v[92:95], v[208:211], v[112:115], v[92:95]
    s_waitcnt vmcnt(20)
    ds_read_b64_tr_b16 v[212:213], v6 offset:4096
    ds_read_b64_tr_b16 v[214:215], v6 offset:6144
    ds_read_b64_tr_b16 v[216:217], v7 offset:4096
    ds_read_b64_tr_b16 v[218:219], v7 offset:6144
    ds_read_b64_tr_b16 v[220:221], v8 offset:4096
    ds_read_b64_tr_b16 v[222:223], v8 offset:6144
    ds_read_b64_tr_b16 v[224:225], v9 offset:4096
    ds_read_b64_tr_b16 v[226:227], v9 offset:6144
    s_waitcnt lgkmcnt(6)
    v_mfma_f32_16x16x32_bf16 v[16:19], v[212:215], v[116:119], v[16:19]
    v_mfma_f32_16x16x32_bf16 v[32:35], v[212:215], v[120:123], v[32:35]
    v_mfma_f32_16x16x32_bf16 v[48:51], v[212:215], v[124:127], v[48:51]
    v_mfma_f32_16x16x32_bf16 v[64:67], v[212:215], v[128:131], v[64:67]
    v_mfma_f32_16x16x32_bf16 v[80:83], v[212:215], v[132:135], v[80:83]
    s_waitcnt lgkmcnt(4)
    v_mfma_f32_16x16x32_bf16 v[20:23], v[216:219], v[116:119], v[20:23]
    v_mfma_f32_16x16x32_bf16 v[36:39], v[216:219], v[120:123], v[36:39]
    v_mfma_f32_16x16x32_bf16 v[52:55], v[216:219], v[124:127], v[52:55]
    v_mfma_f32_16x16x32_bf16 v[68:71], v[216:219], v[128:131], v[68:71]
    v_mfma_f32_16x16x32_bf16 v[84:87], v[216:219], v[132:135], v[84:87]
    s_waitcnt lgkmcnt(2)
    v_mfma_f32_16x16x32_bf16 v[24:27], v[220:223], v[116:119], v[24:27]
    v_mfma_f32_16x16x32_bf16 v[40:43], v[220:223], v[120:123], v[40:43]
    v_mfma_f32_16x16x32_bf16 v[56:59], v[220:223], v[124:127], v[56:59]
    v_mfma_f32_16x16x32_bf16 v[72:75], v[220:223], v[128:131], v[72:75]
    v_mfma_f32_16x16x32_bf16 v[88:91], v[220:223], v[132:135], v[88:91]
    s_waitcnt lgkmcnt(0)
    v_mfma_f32_16x16x32_bf16 v[28:31], v[224:227], v[116:119], v[28:31]
    v_mfma_f32_16x16x32_bf16 v[44:47], v[224:227], v[120:123], v[44:47]
    v_mfma_f32_16x16x32_bf16 v[60:63], v[224:227], v[124:127], v[60:63]
    v_mfma_f32_16x16x32_bf16 v[76:79], v[224:227], v[128:131], v[76:79]
    v_mfma_f32_16x16x32_bf16 v[92:95], v[224:227], v[132:135], v[92:95]
    s_waitcnt vmcnt(0)
    ds_read_b64_tr_b16 v[196:197], v6 offset:8192
    ds_read_b64_tr_b16 v[198:199], v6 offset:10240
    ds_read_b64_tr_b16 v[200:201], v7 offset:8192
    ds_read_b64_tr_b16 v[202:203], v7 offset:10240
    ds_read_b64_tr_b16 v[204:205], v8 offset:8192
    ds_read_b64_tr_b16 v[206:207], v8 offset:10240
    ds_read_b64_tr_b16 v[208:209], v9 offset:8192
    ds_read_b64_tr_b16 v[210:211], v9 offset:10240
    s_waitcnt lgkmcnt(6)
    v_mfma_f32_16x16x32_bf16 v[16:19], v[196:199], v[136:139], v[16:19]
    v_mfma_f32_16x16x32_bf16 v[32:35], v[196:199], v[140:143], v[32:35]
    v_mfma_f32_16x16x32_bf16 v[48:51], v[196:199], v[144:147], v[48:51]
    v_mfma_f32_16x16x32_bf16 v[64:67], v[196:199], v[148:151], v[64:67]
    v_mfma_f32_16x16x32_bf16 v[80:83], v[196:199], v[152:155], v[80:83]
    s_waitcnt lgkmcnt(4)
    v_mfma_f32_16x16x32_bf16 v[20:23], v[200:203], v[136:139], v[20:23]
    v_mfma_f32_16x16x32_bf16 v[36:39], v[200:203], v[140:143], v[36:39]
    v_mfma_f32_16x16x32_bf16 v[52:55], v[200:203], v[144:147], v[52:55]
    v_mfma_f32_16x16x32_bf16 v[68:71], v[200:203], v[148:151], v[68:71]
    v_mfma_f32_16x16x32_bf16 v[84:87], v[200:203], v[152:155], v[84:87]
    s_waitcnt lgkmcnt(2)
    v_mfma_f32_16x16x32_bf16 v[24:27], v[204:207], v[136:139], v[24:27]
    v_mfma_f32_16x16x32_bf16 v[40:43], v[204:207], v[140:143], v[40:43]
    v_mfma_f32_16x16x32_bf16 v[56:59], v[204:207], v[144:147], v[56:59]
    v_mfma_f32_16x16x32_bf16 v[72:75], v[204:207], v[148:151], v[72:75]
    v_mfma_f32_16x16x32_bf16 v[88:91], v[204:207], v[152:155], v[88:91]
    s_waitcnt lgkmcnt(0)
    v_mfma_f32_16x16x32_bf16 v[28:31], v[208:211], v[136:139], v[28:31]
    v_mfma_f32_16x16x32_bf16 v[44:47], v[208:211], v[140:143], v[44:47]
    v_mfma_f32_16x16x32_bf16 v[60:63], v[208:211], v[144:147], v[60:63]
    v_mfma_f32_16x16x32_bf16 v[76:79], v[208:211], v[148:151], v[76:79]
    v_mfma_f32_16x16x32_bf16 v[92:95], v[208:211], v[152:155], v[92:95]
    s_waitcnt lgkmcnt(0)
    s_barrier
    s_mul_i32 s58, s36, 20480
    v_add_u32 v10, s58, v3
    ds_write_b128 v10, v[16:19] offset:0
    ds_write_b128 v10, v[20:23] offset:1024
    ds_write_b128 v10, v[24:27] offset:2048
    ds_write_b128 v10, v[28:31] offset:3072
    ds_write_b128 v10, v[32:35] offset:4096
    ds_write_b128 v10, v[36:39] offset:5120
    ds_write_b128 v10, v[40:43] offset:6144
    ds_write_b128 v10, v[44:47] offset:7168
    ds_write_b128 v10, v[48:51] offset:8192
    ds_write_b128 v10, v[52:55] offset:9216
    ds_write_b128 v10, v[56:59] offset:10240
    ds_write_b128 v10, v[60:63] offset:11264
    ds_write_b128 v10, v[64:67] offset:12288
    ds_write_b128 v10, v[68:71] offset:13312
    ds_write_b128 v10, v[72:75] offset:14336
    ds_write_b128 v10, v[76:79] offset:15360
    ds_write_b128 v10, v[80:83] offset:16384
    ds_write_b128 v10, v[84:87] offset:17408
    ds_write_b128 v10, v[88:91] offset:18432
    ds_write_b128 v10, v[92:95] offset:19456
    s_lshl_b32 s58, s36, 10
    v_add_u32 v10, s58, v3
    v_add_u32 v11, 40960, v10
    s_waitcnt lgkmcnt(0)
    s_barrier
    ds_read_b128 v[96:99], v10 offset:0
    ds_read_b128 v[100:103], v10 offset:4096
    ds_read_b128 v[104:107], v10 offset:8192
    ds_read_b128 v[108:111], v10 offset:12288
    ds_read_b128 v[112:115], v10 offset:16384
    ds_read_b128 v[116:119], v10 offset:20480
    ds_read_b128 v[120:123], v10 offset:24576
    ds_read_b128 v[124:127], v10 offset:28672
    ds_read_b128 v[128:131], v10 offset:32768
    ds_read_b128 v[132:135], v10 offset:36864
    ds_read_b128 v[136:139], v11 offset:0
    ds_read_b128 v[140:143], v11 offset:4096
    ds_read_b128 v[144:147], v11 offset:8192
    ds_read_b128 v[148:151], v11 offset:12288
    ds_read_b128 v[152:155], v11 offset:16384
    ds_read_b128 v[156:159], v11 offset:20480
    ds_read_b128 v[160:163], v11 offset:24576
    ds_read_b128 v[164:167], v11 offset:28672
    ds_read_b128 v[168:171], v11 offset:32768
    ds_read_b128 v[172:175], v11 offset:36864
    v_and_b32 v12, 15, v2
    v_lshrrev_b32 v13, 4, v2
    s_mul_i32 s58, s49, 80
    v_add_u32 v12, s58, v12
    v_mul_u32_u24 v12, 1152, v12
    v_lshl_add_u32 v12, v13, 3, v12
    s_lshl_b32 s58, s50, 7
    s_lshl_b32 s59, s36, 5
    s_add_u32 s58, s58, s59
    s_waitcnt lgkmcnt(0)
    v_pk_add_f32 v[96:97], v[96:97], v[116:117]
    v_pk_add_f32 v[98:99], v[98:99], v[118:119]
    v_pk_add_f32 v[96:97], v[96:97], v[136:137]
    v_pk_add_f32 v[98:99], v[98:99], v[138:139]
    v_pk_add_f32 v[96:97], v[96:97], v[156:157]
    v_pk_add_f32 v[98:99], v[98:99], v[158:159]
    v_cvt_pk_bf16_f32 v96, v96, v97
    v_cvt_pk_bf16_f32 v97, v98, v99
    v_add_u32 v13, 0, v12
    buffer_store_dwordx2 v[96:97], v13, s[40:43], s58 offen
    v_pk_add_f32 v[100:101], v[100:101], v[120:121]
    v_pk_add_f32 v[102:103], v[102:103], v[122:123]
    v_pk_add_f32 v[100:101], v[100:101], v[140:141]
    v_pk_add_f32 v[102:103], v[102:103], v[142:143]
    v_pk_add_f32 v[100:101], v[100:101], v[160:161]
    v_pk_add_f32 v[102:103], v[102:103], v[162:163]
    v_cvt_pk_bf16_f32 v100, v100, v101
    v_cvt_pk_bf16_f32 v101, v102, v103
    v_add_u32 v13, 18432, v12
    buffer_store_dwordx2 v[100:101], v13, s[40:43], s58 offen
    v_pk_add_f32 v[104:105], v[104:105], v[124:125]
    v_pk_add_f32 v[106:107], v[106:107], v[126:127]
    v_pk_add_f32 v[104:105], v[104:105], v[144:145]
    v_pk_add_f32 v[106:107], v[106:107], v[146:147]
    v_pk_add_f32 v[104:105], v[104:105], v[164:165]
    v_pk_add_f32 v[106:107], v[106:107], v[166:167]
    v_cvt_pk_bf16_f32 v104, v104, v105
    v_cvt_pk_bf16_f32 v105, v106, v107
    v_add_u32 v13, 36864, v12
    buffer_store_dwordx2 v[104:105], v13, s[40:43], s58 offen
    v_pk_add_f32 v[108:109], v[108:109], v[128:129]
    v_pk_add_f32 v[110:111], v[110:111], v[130:131]
    v_pk_add_f32 v[108:109], v[108:109], v[148:149]
    v_pk_add_f32 v[110:111], v[110:111], v[150:151]
    v_pk_add_f32 v[108:109], v[108:109], v[168:169]
    v_pk_add_f32 v[110:111], v[110:111], v[170:171]
    v_cvt_pk_bf16_f32 v108, v108, v109
    v_cvt_pk_bf16_f32 v109, v110, v111
    v_add_u32 v13, 55296, v12
    buffer_store_dwordx2 v[108:109], v13, s[40:43], s58 offen
    v_pk_add_f32 v[112:113], v[112:113], v[132:133]
    v_pk_add_f32 v[114:115], v[114:115], v[134:135]
    v_pk_add_f32 v[112:113], v[112:113], v[152:153]
    v_pk_add_f32 v[114:115], v[114:115], v[154:155]
    v_pk_add_f32 v[112:113], v[112:113], v[172:173]
    v_pk_add_f32 v[114:115], v[114:115], v[174:175]
    v_cvt_pk_bf16_f32 v112, v112, v113
    v_cvt_pk_bf16_f32 v113, v114, v115
    v_add_u32 v13, 73728, v12
    buffer_store_dwordx2 v[112:113], v13, s[40:43], s58 offen
    s_branch L_k2fi_done
L_k2fi_skip:
    s_add_u32 s89, s37, 8
    s_waitcnt vmcnt(0)
    s_barrier
    s_cmp_lg_u32 s36, 0
    s_cbranch_scc1 L_k2ub_arr_26
    s_lshl_b32 s90, s89, 8
    s_add_u32 s90, s90, 55312384
    v_mov_b32 v237, 1
    v_mov_b32 v238, 0
    v_mov_b32 v239, 1073741824
    v_cmp_eq_u32 vcc, 0, v2
    s_nop 1
    v_cndmask_b32 v238, v239, v238, vcc
    buffer_atomic_add v237, v238, s[24:27], s90 offen sc1
L_k2ub_arr_26:
L_k2fi_done:
    s_endpgm
L_k2_A:
    s_sub_u32 s3, s2, 256
    v_mov_b32 v249, 0
    s_getpc_b64 s[60:61]
L_k2_pc:
    s_add_u32 s60, s60, k2_kernel-L_k2_pc
    s_addc_u32 s61, s61, -1
    v_lshrrev_b32 v1, 6, v0
    v_and_b32 v4, 63, v0
    s_lshr_b32 s62, s3, 3
    v_lshl_add_u32 v1, s62, 2, v1
    v_lshlrev_b32 v1, 10, v1
    v_lshl_add_u32 v1, v4, 4, v1
    v_mov_b32 v5, L_k2_codeend-k2_kernel-16
    v_min_u32 v1, v1, v5
    global_load_dwordx4 v[244:247], v1, s[60:61]
    s_load_dwordx2 s[8:9], s[0:1], 88
    v_lshrrev_b32 v1, 6, v0
    v_and_b32 v2, 63, v0
    s_and_b32 s42, s3, 7
    s_lshr_b32 s43, s3, 3
    v_readfirstlane_b32 s36, v1
    s_and_b32 s44, s43, 3
    s_lshl_b32 s42, s42, 2
    s_add_u32 s37, s42, s44
    s_lshr_b32 s38, s43, 2
    s_waitcnt lgkmcnt(0)
    s_setprio 1
    s_mov_b32 s24, s8
    s_and_b32 s25, s9, 0xffff
    s_mov_b32 s26, 0x3d00000
    s_mov_b32 s27, 0x20000
    v_lshlrev_b32 v3, 4, v2
    s_mul_i32 s41, s37, 155648
    s_lshl_b32 s44, s36, 10
    s_add_u32 s41, s41, s44
    s_add_u32 s41, s41, 0
    s_mov_b32 s40, s44
    s_add_u32 m0, s40, 0
    s_add_u32 s45, s41, 0
    buffer_load_dwordx4 v3, s[24:27], s45 offen lds
    s_add_u32 m0, s40, 4096
    s_add_u32 s45, s41, 4096
    buffer_load_dwordx4 v3, s[24:27], s45 offen lds
    s_add_u32 m0, s40, 8192
    s_add_u32 s45, s41, 8192
    buffer_load_dwordx4 v3, s[24:27], s45 offen lds
    s_add_u32 m0, s40, 12288
    s_add_u32 s45, s41, 12288
    buffer_load_dwordx4 v3, s[24:27], s45 offen lds
    s_cmp_eq_u32 s36, 3
    s_cbranch_scc1 L_k2at_sk_27
    s_add_u32 m0, s40, 16384
    s_add_u32 s45, s41, 16384
    buffer_load_dwordx4 v3, s[24:27], s45 offen lds
L_k2at_sk_27:
    s_add_u32 s41, s41, 19456
    s_add_u32 s40, s40, 19456
    s_lshl_b32 s45, s36, 10
    s_add_u32 s45, s45, 77824
    s_cmp_ge_u32 s40, s45
    s_cselect_b32 s46, 77824, 0
    s_sub_u32 s40, s40, s46
    s_mul_i32 s44, s37, 73728
    s_lshl_b32 s45, s38, 3
    s_lshl_b32 s46, s36, 1
    s_add_u32 s45, s45, s46
    s_mul_i32 s46, s45, 1152
    s_add_u32 s44, s44, s46
    s_add_u32 s44, s44, 5242880
    v_and_b32 v60, 31, v2
    v_lshrrev_b32 v61, 5, v2
    v_lshlrev_b32 v62, 9, v61
    v_lshl_add_u32 v4, v60, 4, v62
    v_lshlrev_b32 v5, 2, v60
    v_add_u32 v5, 1024, v5
    v_mov_b32 v63, 1073741824
    v_cmp_eq_u32 vcc, 0, v61
    s_nop 1
    v_cndmask_b32 v63, v63, v5, vcc
    buffer_load_dwordx4 v[8:11], v4, s[24:27], s44 offen offset:0
    buffer_load_dword v12, v63, s[24:27], s44 offen offset:0
    buffer_load_dwordx4 v[16:19], v4, s[24:27], s44 offen offset:1152
    buffer_load_dword v20, v63, s[24:27], s44 offen offset:1152
    s_lshl_b32 s46, s45, 7
    s_add_u32 s46, s46, 31457280
    v_lshlrev_b32 v62, 2, v60
    buffer_load_dword v160, v62, s[24:27], s46 offen
    buffer_load_dword v161, v62, s[24:27], s46 offen offset:128
    v_mov_b32 v62, 4
    v_cmp_gt_u32 vcc, 19, v60
    s_nop 1
    v_cndmask_b32 v62, v62, v60, vcc
    v_subrev_u32 v63, 20, v60
    v_cmp_gt_u32 vcc, 8, v63
    s_nop 1
    v_cndmask_b32 v62, v62, 0, vcc
    v_mul_u32_u24 v63, 304, v61
    v_lshl_add_u32 v62, v62, 4, v63
    v_add_u32 v6, 1152, v62
    v_mov_b32 v13, 0
    v_mov_b32 v14, 0
    v_mov_b32 v15, 0
    v_mov_b32 v21, 0
    v_mov_b32 v22, 0
    v_mov_b32 v23, 0
    v_mov_b32 v29, 0
    v_mov_b32 v30, 0
    v_mov_b32 v31, 0
    v_mov_b32 v37, 0
    v_mov_b32 v38, 0
    v_mov_b32 v39, 0
    v_mov_b64 v[96:97], 0
    v_mov_b64 v[98:99], 0
    v_mov_b64 v[100:101], 0
    v_mov_b64 v[102:103], 0
    v_mov_b64 v[104:105], 0
    v_mov_b64 v[106:107], 0
    v_mov_b64 v[108:109], 0
    v_mov_b64 v[110:111], 0
    v_mov_b64 v[112:113], 0
    v_mov_b64 v[114:115], 0
    v_mov_b64 v[116:117], 0
    v_mov_b64 v[118:119], 0
    v_mov_b64 v[120:121], 0
    v_mov_b64 v[122:123], 0
    v_mov_b64 v[124:125], 0
    v_mov_b64 v[126:127], 0
    v_mov_b64 v[40:41], 0
    v_mov_b64 v[42:43], 0
    v_mov_b64 v[44:45], 0
    v_mov_b64 v[46:47], 0
    v_mov_b64 v[48:49], 0
    v_mov_b64 v[50:51], 0
    v_mov_b64 v[52:53], 0
    v_mov_b64 v[54:55], 0
    s_mov_b32 s54, 0x7ffff
    s_mov_b32 s55, 0x7ffff
    s_mov_b32 s78, -1
    s_mov_b32 s79, 0
    v_mov_b32 v28, 0
    v_mov_b32 v36, 0
    v_mov_b32 v162, v4
    v_mov_b32 v163, v5
    v_mov_b32 v164, v6
    s_waitcnt vmcnt(0)
    s_barrier
    s_add_u32 m0, s40, 0
    s_add_u32 s45, s41, 0
    buffer_load_dwordx4 v3, s[24:27], s45 offen lds
    s_add_u32 m0, s40, 4096
    s_add_u32 s45, s41, 4096
    buffer_load_dwordx4 v3, s[24:27], s45 offen lds
    s_add_u32 m0, s40, 8192
    s_add_u32 s45, s41, 8192
    buffer_load_dwordx4 v3, s[24:27], s45 offen lds
    s_add_u32 m0, s40, 12288
    s_add_u32 s45, s41, 12288
    buffer_load_dwordx4 v3, s[24:27], s45 offen lds
    s_cmp_eq_u32 s36, 3
    s_cbranch_scc1 L_k2at_sk_28
    s_add_u32 m0, s40, 16384
    s_add_u32 s45, s41, 16384
    buffer_load_dwordx4 v3, s[24:27], s45 offen lds
L_k2at_sk_28:
    s_add_u32 s41, s41, 19456
    s_add_u32 s40, s40, 19456
    s_lshl_b32 s45, s36, 10
    s_add_u32 s45, s45, 77824
    s_cmp_ge_u32 s40, s45
    s_cselect_b32 s46, 77824, 0
    s_sub_u32 s40, s40, s46
    s_add_u32 m0, s40, 0
    s_add_u32 s45, s41, 0
    buffer_load_dwordx4 v3, s[24:27], s45 offen lds
    s_add_u32 m0, s40, 4096
    s_add_u32 s45, s41, 4096
    buffer_load_dwordx4 v3, s[24:27], s45 offen lds
    s_add_u32 m0, s40, 8192
    s_add_u32 s45, s41, 8192
    buffer_load_dwordx4 v3, s[24:27], s45 offen lds
    s_add_u32 m0, s40, 12288
    s_add_u32 s45, s41, 12288
    buffer_load_dwordx4 v3, s[24:27], s45 offen lds
    s_cmp_eq_u32 s36, 3
    s_cbranch_scc1 L_k2at_sk_29
    s_add_u32 m0, s40, 16384
    s_add_u32 s45, s41, 16384
    buffer_load_dwordx4 v3, s[24:27], s45 offen lds
L_k2at_sk_29:
    s_add_u32 s41, s41, 19456
    s_add_u32 s40, s40, 19456
    s_lshl_b32 s45, s36, 10
    s_add_u32 s45, s45, 77824
    s_cmp_ge_u32 s40, s45
    s_cselect_b32 s46, 77824, 0
    s_sub_u32 s40, s40, s46
    ds_read_b128 v[24:27], v4 offset:0
    s_mov_b64 exec, s[78:79]
    ds_read_b32 v28, v5 offset:0
    s_mov_b64 exec, -1
    s_mov_b64 exec, s[54:55]
    ds_read_b128 v[40:43], v6 offset:0
    ds_read_b128 v[44:47], v6 offset:608
    s_mov_b64 exec, -1
    s_waitcnt lgkmcnt(0)
    v_mfma_f32_32x32x16_bf16 v[64:79], v[24:27], v[8:11], 0
    v_mfma_f32_32x32x16_bf16 v[64:79], v[28:31], v[12:15], v[64:79]
    v_mfma_f32_32x32x16_bf16 v[80:95], v[24:27], v[16:19], 0
    v_mfma_f32_32x32x16_bf16 v[80:95], v[28:31], v[20:23], v[80:95]
    s_nop 9
    v_max3_f32 v60, v64, v65, v66
    v_max3_f32 v60, v60, v67, v68
    v_max3_f32 v60, v60, v69, v70
    v_max3_f32 v60, v60, v71, v72
    v_max3_f32 v60, v60, v73, v74
    v_max3_f32 v60, v60, v75, v76
    v_max3_f32 v60, v60, v77, v78
    v_max_f32 v60, v60, v79
    v_mov_b32 v62, v60
    v_mov_b32 v63, v60
    s_nop 1
    v_permlane32_swap_b32 v62, v63
    v_max_f32 v62, v62, v63
    v_sub_f32 v62, 0, v62
    v_mov_b32 v63, v62
    v_mov_b64 v[128:129], v[62:63]
    v_mov_b64 v[130:131], v[62:63]
    v_mov_b64 v[132:133], v[62:63]
    v_mov_b64 v[134:135], v[62:63]
    v_mov_b64 v[136:137], v[62:63]
    v_mov_b64 v[138:139], v[62:63]
    v_mov_b64 v[140:141], v[62:63]
    v_mov_b64 v[142:143], v[62:63]
    v_max3_f32 v60, v80, v81, v82
    v_max3_f32 v60, v60, v83, v84
    v_max3_f32 v60, v60, v85, v86
    v_max3_f32 v60, v60, v87, v88
    v_max3_f32 v60, v60, v89, v90
    v_max3_f32 v60, v60, v91, v92
    v_max3_f32 v60, v60, v93, v94
    v_max_f32 v60, v60, v95
    v_mov_b32 v62, v60
    v_mov_b32 v63, v60
    s_nop 1
    v_permlane32_swap_b32 v62, v63
    v_max_f32 v62, v62, v63
    v_sub_f32 v62, 0, v62
    v_mov_b32 v63, v62
    v_mov_b64 v[144:145], v[62:63]
    v_mov_b64 v[146:147], v[62:63]
    v_mov_b64 v[148:149], v[62:63]
    v_mov_b64 v[150:151], v[62:63]
    v_mov_b64 v[152:153], v[62:63]
    v_mov_b64 v[154:155], v[62:63]
    v_mov_b64 v[156:157], v[62:63]
    v_mov_b64 v[158:159], v[62:63]
    v_mfma_f32_32x32x16_bf16 v[64:79], v[24:27], v[8:11], v[128:143]
    v_mfma_f32_32x32x16_bf16 v[64:79], v[28:31], v[12:15], v[64:79]
    v_mov_b32 v60, 0
    v_mov_b32 v52, 0
    v_mov_b32 v61, 0
    v_mov_b32 v53, 0
    v_mov_b32 v62, 0
    v_mov_b32 v54, 0
    v_mov_b32 v63, 0
    v_mov_b32 v55, 0
    s_mov_b32 s39, 0
    s_mov_b32 s47, 0
.p2align 6
L_k2at_loop:
    v_mfma_f32_32x32x16_bf16 v[80:95], v[24:27], v[16:19], v[144:159]
    s_nop 0
    v_exp_f32 v64, v64
    v_exp_f32 v65, v65
    v_exp_f32 v66, v66
    v_mfma_f32_32x32x16_bf16 v[112:127], v[52:55], v[60:63], v[112:127]
    s_mov_b64 exec, s[78:79]
    ds_read_b32 v36, v5 offset:2432
    s_mov_b64 exec, s[54:55]
    ds_read_b128 v[48:51], v6 offset:2432
    ds_read_b128 v[52:55], v6 offset:3040
    s_mov_b64 exec, -1
    ds_read_b128 v[32:35], v4 offset:2432
    v_exp_f32 v67, v67
    v_exp_f32 v68, v68
    v_exp_f32 v69, v69
    v_mfma_f32_32x32x16_bf16 v[80:95], v[28:31], v[20:23], v[80:95]
    v_exp_f32 v70, v70
    v_exp_f32 v71, v71
    v_exp_f32 v72, v72
    v_cvt_pk_bf16_f32 v56, v64, v65
    v_cvt_pk_bf16_f32 v57, v66, v67
    v_exp_f32 v73, v73
    v_cvt_pk_bf16_f32 v58, v68, v69
    v_cvt_pk_bf16_f32 v59, v70, v71
    v_exp_f32 v74, v74
    v_exp_f32 v75, v75
    v_mfma_f32_32x32x16_bf16 v[96:111], v[40:43], v[56:59], v[96:111]
    v_exp_f32 v76, v76
    v_exp_f32 v77, v77
    v_exp_f32 v78, v78
    v_exp_f32 v79, v79
    v_cvt_pk_bf16_f32 v60, v72, v73
    v_cvt_pk_bf16_f32 v61, v74, v75
    v_cvt_pk_bf16_f32 v62, v76, v77
    v_cvt_pk_bf16_f32 v63, v78, v79
    s_waitcnt lgkmcnt(0)
    v_mfma_f32_32x32x16_bf16 v[64:79], v[32:35], v[8:11], v[128:143]
    v_exp_f32 v80, v80
    v_exp_f32 v81, v81
    v_exp_f32 v82, v82
    v_mfma_f32_32x32x16_bf16 v[96:111], v[44:47], v[60:63], v[96:111]
    v_exp_f32 v83, v83
    v_exp_f32 v84, v84
    v_exp_f32 v85, v85
    v_mfma_f32_32x32x16_bf16 v[64:79], v[36:39], v[12:15], v[64:79]
    v_exp_f32 v86, v86
    v_exp_f32 v87, v87
    v_exp_f32 v88, v88
    v_cvt_pk_bf16_f32 v56, v80, v81
    v_cvt_pk_bf16_f32 v57, v82, v83
    v_exp_f32 v89, v89
    v_cvt_pk_bf16_f32 v58, v84, v85
    v_cvt_pk_bf16_f32 v59, v86, v87
    v_exp_f32 v90, v90
    v_exp_f32 v91, v91
    v_mfma_f32_32x32x16_bf16 v[112:127], v[40:43], v[56:59], v[112:127]
    v_exp_f32 v92, v92
    v_exp_f32 v93, v93
    v_exp_f32 v94, v94
    v_exp_f32 v95, v95
    v_cvt_pk_bf16_f32 v60, v88, v89
    v_cvt_pk_bf16_f32 v61, v90, v91
    v_cvt_pk_bf16_f32 v62, v92, v93
    v_cvt_pk_bf16_f32 v63, v94, v95
    v_mfma_f32_32x32x16_bf16 v[80:95], v[32:35], v[16:19], v[144:159]
    v_exp_f32 v64, v64
    v_exp_f32 v65, v65
    v_exp_f32 v66, v66
    v_mfma_f32_32x32x16_bf16 v[112:127], v[44:47], v[60:63], v[112:127]
    s_mov_b64 exec, s[78:79]
    ds_read_b32 v28, v5 offset:4864
    s_mov_b64 exec, s[54:55]
    ds_read_b128 v[40:43], v6 offset:4864
    ds_read_b128 v[44:47], v6 offset:5472
    s_mov_b64 exec, -1
    ds_read_b128 v[24:27], v4 offset:4864
    v_exp_f32 v67, v67
    v_exp_f32 v68, v68
    v_exp_f32 v69, v69
    v_mfma_f32_32x32x16_bf16 v[80:95], v[36:39], v[20:23], v[80:95]
    v_exp_f32 v70, v70
    v_exp_f32 v71, v71
    v_exp_f32 v72, v72
    v_cvt_pk_bf16_f32 v56, v64, v65
    v_cvt_pk_bf16_f32 v57, v66, v67
    v_exp_f32 v73, v73
    v_cvt_pk_bf16_f32 v58, v68, v69
    v_cvt_pk_bf16_f32 v59, v70, v71
    v_exp_f32 v74, v74
    v_exp_f32 v75, v75
    v_mfma_f32_32x32x16_bf16 v[96:111], v[48:51], v[56:59], v[96:111]
    v_exp_f32 v76, v76
    v_exp_f32 v77, v77
    v_exp_f32 v78, v78
    v_exp_f32 v79, v79
    v_cvt_pk_bf16_f32 v60, v72, v73
    v_cvt_pk_bf16_f32 v61, v74, v75
    v_cvt_pk_bf16_f32 v62, v76, v77
    v_cvt_pk_bf16_f32 v63, v78, v79
    s_waitcnt lgkmcnt(0)
    v_mfma_f32_32x32x16_bf16 v[64:79], v[24:27], v[8:11], v[128:143]
    v_exp_f32 v80, v80
    v_exp_f32 v81, v81
    v_exp_f32 v82, v82
    v_mfma_f32_32x32x16_bf16 v[96:111], v[52:55], v[60:63], v[96:111]
    v_exp_f32 v83, v83
    v_exp_f32 v84, v84
    v_exp_f32 v85, v85
    v_mfma_f32_32x32x16_bf16 v[64:79], v[28:31], v[12:15], v[64:79]
    v_exp_f32 v86, v86
    v_exp_f32 v87, v87
    v_exp_f32 v88, v88
    v_cvt_pk_bf16_f32 v56, v80, v81
    v_cvt_pk_bf16_f32 v57, v82, v83
    v_exp_f32 v89, v89
    v_cvt_pk_bf16_f32 v58, v84, v85
    v_cvt_pk_bf16_f32 v59, v86, v87
    v_exp_f32 v90, v90
    v_exp_f32 v91, v91
    v_mfma_f32_32x32x16_bf16 v[112:127], v[48:51], v[56:59], v[112:127]
    v_exp_f32 v92, v92
    v_exp_f32 v93, v93
    v_exp_f32 v94, v94
    v_exp_f32 v95, v95
    v_cvt_pk_bf16_f32 v60, v88, v89
    v_cvt_pk_bf16_f32 v61, v90, v91
    v_cvt_pk_bf16_f32 v62, v92, v93
    v_cvt_pk_bf16_f32 v63, v94, v95
    v_mfma_f32_32x32x16_bf16 v[80:95], v[24:27], v[16:19], v[144:159]
    v_exp_f32 v64, v64
    v_exp_f32 v65, v65
    v_exp_f32 v66, v66
    v_mfma_f32_32x32x16_bf16 v[112:127], v[52:55], v[60:63], v[112:127]
    s_mov_b64 exec, s[78:79]
    ds_read_b32 v36, v5 offset:7296
    s_mov_b64 exec, s[54:55]
    ds_read_b128 v[48:51], v6 offset:7296
    ds_read_b128 v[52:55], v6 offset:7904
    s_mov_b64 exec, -1
    ds_read_b128 v[32:35], v4 offset:7296
    v_exp_f32 v67, v67
    v_exp_f32 v68, v68
    v_exp_f32 v69, v69
    v_mfma_f32_32x32x16_bf16 v[80:95], v[28:31], v[20:23], v[80:95]
    v_exp_f32 v70, v70
    v_exp_f32 v71, v71
    v_exp_f32 v72, v72
    v_cvt_pk_bf16_f32 v56, v64, v65
    v_cvt_pk_bf16_f32 v57, v66, v67
    v_exp_f32 v73, v73
    v_cvt_pk_bf16_f32 v58, v68, v69
    v_cvt_pk_bf16_f32 v59, v70, v71
    v_exp_f32 v74, v74
    v_exp_f32 v75, v75
    v_mfma_f32_32x32x16_bf16 v[96:111], v[40:43], v[56:59], v[96:111]
    v_exp_f32 v76, v76
    v_exp_f32 v77, v77
    v_exp_f32 v78, v78
    v_exp_f32 v79, v79
    v_cvt_pk_bf16_f32 v60, v72, v73
    v_cvt_pk_bf16_f32 v61, v74, v75
    v_cvt_pk_bf16_f32 v62, v76, v77
    v_cvt_pk_bf16_f32 v63, v78, v79
    s_waitcnt lgkmcnt(0)
    v_mfma_f32_32x32x16_bf16 v[64:79], v[32:35], v[8:11], v[128:143]
    v_exp_f32 v80, v80
    v_exp_f32 v81, v81
    v_exp_f32 v82, v82
    v_mfma_f32_32x32x16_bf16 v[96:111], v[44:47], v[60:63], v[96:111]
    v_exp_f32 v83, v83
    v_exp_f32 v84, v84
    v_exp_f32 v85, v85
    v_mfma_f32_32x32x16_bf16 v[64:79], v[36:39], v[12:15], v[64:79]
    v_exp_f32 v86, v86
    v_exp_f32 v87, v87
    v_exp_f32 v88, v88
    v_cvt_pk_bf16_f32 v56, v80, v81
    v_cvt_pk_bf16_f32 v57, v82, v83
    v_exp_f32 v89, v89
    v_cvt_pk_bf16_f32 v58, v84, v85
    v_cvt_pk_bf16_f32 v59, v86, v87
    v_exp_f32 v90, v90
    v_exp_f32 v91, v91
    v_mfma_f32_32x32x16_bf16 v[112:127], v[40:43], v[56:59], v[112:127]
    v_exp_f32 v92, v92
    v_exp_f32 v93, v93
    v_exp_f32 v94, v94
    v_exp_f32 v95, v95
    v_cvt_pk_bf16_f32 v60, v88, v89
    v_cvt_pk_bf16_f32 v61, v90, v91
    v_cvt_pk_bf16_f32 v62, v92, v93
    v_cvt_pk_bf16_f32 v63, v94, v95
    v_mfma_f32_32x32x16_bf16 v[80:95], v[32:35], v[16:19], v[144:159]
    v_exp_f32 v64, v64
    v_exp_f32 v65, v65
    v_exp_f32 v66, v66
    v_mfma_f32_32x32x16_bf16 v[112:127], v[44:47], v[60:63], v[112:127]
    s_mov_b64 exec, s[78:79]
    ds_read_b32 v28, v5 offset:9728
    s_mov_b64 exec, s[54:55]
    ds_read_b128 v[40:43], v6 offset:9728
    ds_read_b128 v[44:47], v6 offset:10336
    s_mov_b64 exec, -1
    ds_read_b128 v[24:27], v4 offset:9728
    v_exp_f32 v67, v67
    v_exp_f32 v68, v68
    v_exp_f32 v69, v69
    v_mfma_f32_32x32x16_bf16 v[80:95], v[36:39], v[20:23], v[80:95]
    v_exp_f32 v70, v70
    v_exp_f32 v71, v71
    v_exp_f32 v72, v72
    v_cvt_pk_bf16_f32 v56, v64, v65
    v_cvt_pk_bf16_f32 v57, v66, v67
    v_exp_f32 v73, v73
    v_cvt_pk_bf16_f32 v58, v68, v69
    v_cvt_pk_bf16_f32 v59, v70, v71
    v_exp_f32 v74, v74
    v_exp_f32 v75, v75
    v_mfma_f32_32x32x16_bf16 v[96:111], v[48:51], v[56:59], v[96:111]
    v_exp_f32 v76, v76
    v_exp_f32 v77, v77
    v_exp_f32 v78, v78
    v_exp_f32 v79, v79
    v_cvt_pk_bf16_f32 v60, v72, v73
    v_cvt_pk_bf16_f32 v61, v74, v75
    v_cvt_pk_bf16_f32 v62, v76, v77
    v_cvt_pk_bf16_f32 v63, v78, v79
    s_waitcnt lgkmcnt(0)
    v_mfma_f32_32x32x16_bf16 v[64:79], v[24:27], v[8:11], v[128:143]
    v_exp_f32 v80, v80
    v_exp_f32 v81, v81
    v_exp_f32 v82, v82
    v_mfma_f32_32x32x16_bf16 v[96:111], v[52:55], v[60:63], v[96:111]
    v_exp_f32 v83, v83
    v_exp_f32 v84, v84
    v_exp_f32 v85, v85
    v_mfma_f32_32x32x16_bf16 v[64:79], v[28:31], v[12:15], v[64:79]
    v_exp_f32 v86, v86
    v_exp_f32 v87, v87
    v_exp_f32 v88, v88
    v_cvt_pk_bf16_f32 v56, v80, v81
    v_cvt_pk_bf16_f32 v57, v82, v83
    v_exp_f32 v89, v89
    v_cvt_pk_bf16_f32 v58, v84, v85
    v_cvt_pk_bf16_f32 v59, v86, v87
    v_exp_f32 v90, v90
    v_exp_f32 v91, v91
    v_mfma_f32_32x32x16_bf16 v[112:127], v[48:51], v[56:59], v[112:127]
    v_exp_f32 v92, v92
    v_exp_f32 v93, v93
    v_exp_f32 v94, v94
    v_exp_f32 v95, v95
    v_cvt_pk_bf16_f32 v60, v88, v89
    v_cvt_pk_bf16_f32 v61, v90, v91
    v_cvt_pk_bf16_f32 v62, v92, v93
    v_cvt_pk_bf16_f32 v63, v94, v95
    v_mfma_f32_32x32x16_bf16 v[80:95], v[24:27], v[16:19], v[144:159]
    v_exp_f32 v64, v64
    v_exp_f32 v65, v65
    v_exp_f32 v66, v66
    v_mfma_f32_32x32x16_bf16 v[112:127], v[52:55], v[60:63], v[112:127]
    s_mov_b64 exec, s[78:79]
    ds_read_b32 v36, v5 offset:12160
    s_mov_b64 exec, s[54:55]
    ds_read_b128 v[48:51], v6 offset:12160
    ds_read_b128 v[52:55], v6 offset:12768
    s_mov_b64 exec, -1
    ds_read_b128 v[32:35], v4 offset:12160
    v_exp_f32 v67, v67
    v_exp_f32 v68, v68
    v_exp_f32 v69, v69
    v_mfma_f32_32x32x16_bf16 v[80:95], v[28:31], v[20:23], v[80:95]
    v_exp_f32 v70, v70
    v_exp_f32 v71, v71
    v_exp_f32 v72, v72
    v_cvt_pk_bf16_f32 v56, v64, v65
    v_cvt_pk_bf16_f32 v57, v66, v67
    v_exp_f32 v73, v73
    v_cvt_pk_bf16_f32 v58, v68, v69
    v_cvt_pk_bf16_f32 v59, v70, v71
    v_exp_f32 v74, v74
    v_exp_f32 v75, v75
    v_mfma_f32_32x32x16_bf16 v[96:111], v[40:43], v[56:59], v[96:111]
    v_exp_f32 v76, v76
    v_exp_f32 v77, v77
    v_exp_f32 v78, v78
    v_exp_f32 v79, v79
    v_cvt_pk_bf16_f32 v60, v72, v73
    v_cvt_pk_bf16_f32 v61, v74, v75
    v_cvt_pk_bf16_f32 v62, v76, v77
    v_cvt_pk_bf16_f32 v63, v78, v79
    s_waitcnt lgkmcnt(0)
    v_mfma_f32_32x32x16_bf16 v[64:79], v[32:35], v[8:11], v[128:143]
    v_exp_f32 v80, v80
    v_exp_f32 v81, v81
    v_exp_f32 v82, v82
    v_mfma_f32_32x32x16_bf16 v[96:111], v[44:47], v[60:63], v[96:111]
    v_exp_f32 v83, v83
    v_exp_f32 v84, v84
    v_exp_f32 v85, v85
    v_mfma_f32_32x32x16_bf16 v[64:79], v[36:39], v[12:15], v[64:79]
    v_exp_f32 v86, v86
    v_exp_f32 v87, v87
    v_exp_f32 v88, v88
    v_cvt_pk_bf16_f32 v56, v80, v81
    v_cvt_pk_bf16_f32 v57, v82, v83
    v_exp_f32 v89, v89
    v_cvt_pk_bf16_f32 v58, v84, v85
    v_cvt_pk_bf16_f32 v59, v86, v87
    v_exp_f32 v90, v90
    v_exp_f32 v91, v91
    v_mfma_f32_32x32x16_bf16 v[112:127], v[40:43], v[56:59], v[112:127]
    v_exp_f32 v92, v92
    v_exp_f32 v93, v93
    v_exp_f32 v94, v94
    v_exp_f32 v95, v95
    v_cvt_pk_bf16_f32 v60, v88, v89
    v_cvt_pk_bf16_f32 v61, v90, v91
    v_cvt_pk_bf16_f32 v62, v92, v93
    v_cvt_pk_bf16_f32 v63, v94, v95
    v_mfma_f32_32x32x16_bf16 v[80:95], v[32:35], v[16:19], v[144:159]
    v_exp_f32 v64, v64
    v_exp_f32 v65, v65
    v_exp_f32 v66, v66
    v_mfma_f32_32x32x16_bf16 v[112:127], v[44:47], v[60:63], v[112:127]
    s_mov_b64 exec, s[78:79]
    ds_read_b32 v28, v5 offset:14592
    s_mov_b64 exec, s[54:55]
    ds_read_b128 v[40:43], v6 offset:14592
    ds_read_b128 v[44:47], v6 offset:15200
    s_mov_b64 exec, -1
    ds_read_b128 v[24:27], v4 offset:14592
    v_exp_f32 v67, v67
    v_exp_f32 v68, v68
    v_exp_f32 v69, v69
    v_mfma_f32_32x32x16_bf16 v[80:95], v[36:39], v[20:23], v[80:95]
    v_exp_f32 v70, v70
    v_exp_f32 v71, v71
    v_exp_f32 v72, v72
    v_cvt_pk_bf16_f32 v56, v64, v65
    v_cvt_pk_bf16_f32 v57, v66, v67
    v_exp_f32 v73, v73
    v_cvt_pk_bf16_f32 v58, v68, v69
    v_cvt_pk_bf16_f32 v59, v70, v71
    v_exp_f32 v74, v74
    v_exp_f32 v75, v75
    v_mfma_f32_32x32x16_bf16 v[96:111], v[48:51], v[56:59], v[96:111]
    v_exp_f32 v76, v76
    v_exp_f32 v77, v77
    v_exp_f32 v78, v78
    v_exp_f32 v79, v79
    v_cvt_pk_bf16_f32 v60, v72, v73
    v_cvt_pk_bf16_f32 v61, v74, v75
    v_cvt_pk_bf16_f32 v62, v76, v77
    v_cvt_pk_bf16_f32 v63, v78, v79
    s_waitcnt lgkmcnt(0)
    v_mfma_f32_32x32x16_bf16 v[64:79], v[24:27], v[8:11], v[128:143]
    v_exp_f32 v80, v80
    v_exp_f32 v81, v81
    v_exp_f32 v82, v82
    v_mfma_f32_32x32x16_bf16 v[96:111], v[52:55], v[60:63], v[96:111]
    v_exp_f32 v83, v83
    v_exp_f32 v84, v84
    v_exp_f32 v85, v85
    v_mfma_f32_32x32x16_bf16 v[64:79], v[28:31], v[12:15], v[64:79]
    v_exp_f32 v86, v86
    v_exp_f32 v87, v87
    v_exp_f32 v88, v88
    v_cvt_pk_bf16_f32 v56, v80, v81
    v_cvt_pk_bf16_f32 v57, v82, v83
    v_exp_f32 v89, v89
    v_cvt_pk_bf16_f32 v58, v84, v85
    v_cvt_pk_bf16_f32 v59, v86, v87
    v_exp_f32 v90, v90
    v_exp_f32 v91, v91
    v_mfma_f32_32x32x16_bf16 v[112:127], v[48:51], v[56:59], v[112:127]
    v_exp_f32 v92, v92
    v_exp_f32 v93, v93
    v_exp_f32 v94, v94
    v_exp_f32 v95, v95
    v_cvt_pk_bf16_f32 v60, v88, v89
    v_cvt_pk_bf16_f32 v61, v90, v91
    v_cvt_pk_bf16_f32 v62, v92, v93
    v_cvt_pk_bf16_f32 v63, v94, v95
    v_mfma_f32_32x32x16_bf16 v[80:95], v[24:27], v[16:19], v[144:159]
    v_exp_f32 v64, v64
    v_exp_f32 v65, v65
    v_exp_f32 v66, v66
    v_mfma_f32_32x32x16_bf16 v[112:127], v[52:55], v[60:63], v[112:127]
    s_mov_b64 exec, s[78:79]
    ds_read_b32 v36, v5 offset:17024
    s_mov_b64 exec, s[54:55]
    ds_read_b128 v[48:51], v6 offset:17024
    ds_read_b128 v[52:55], v6 offset:17632
    s_mov_b64 exec, -1
    ds_read_b128 v[32:35], v4 offset:17024
    v_exp_f32 v67, v67
    v_exp_f32 v68, v68
    v_exp_f32 v69, v69
    v_mfma_f32_32x32x16_bf16 v[80:95], v[28:31], v[20:23], v[80:95]
    v_exp_f32 v70, v70
    v_exp_f32 v71, v71
    v_exp_f32 v72, v72
    v_cvt_pk_bf16_f32 v56, v64, v65
    v_cvt_pk_bf16_f32 v57, v66, v67
    v_exp_f32 v73, v73
    v_cvt_pk_bf16_f32 v58, v68, v69
    v_cvt_pk_bf16_f32 v59, v70, v71
    v_exp_f32 v74, v74
    v_exp_f32 v75, v75
    v_mfma_f32_32x32x16_bf16 v[96:111], v[40:43], v[56:59], v[96:111]
    v_exp_f32 v76, v76
    v_exp_f32 v77, v77
    v_exp_f32 v78, v78
    v_exp_f32 v79, v79
    v_cvt_pk_bf16_f32 v60, v72, v73
    v_cvt_pk_bf16_f32 v61, v74, v75
    v_cvt_pk_bf16_f32 v62, v76, v77
    v_cvt_pk_bf16_f32 v63, v78, v79
    s_waitcnt lgkmcnt(0)
    v_mfma_f32_32x32x16_bf16 v[64:79], v[32:35], v[8:11], v[128:143]
    v_exp_f32 v80, v80
    v_exp_f32 v81, v81
    v_exp_f32 v82, v82
    v_mfma_f32_32x32x16_bf16 v[96:111], v[44:47], v[60:63], v[96:111]
    v_exp_f32 v83, v83
    v_exp_f32 v84, v84
    v_exp_f32 v85, v85
    v_mfma_f32_32x32x16_bf16 v[64:79], v[36:39], v[12:15], v[64:79]
    v_exp_f32 v86, v86
    v_exp_f32 v87, v87
    v_exp_f32 v88, v88
    v_cvt_pk_bf16_f32 v56, v80, v81
    v_cvt_pk_bf16_f32 v57, v82, v83
    v_exp_f32 v89, v89
    v_cvt_pk_bf16_f32 v58, v84, v85
    v_cvt_pk_bf16_f32 v59, v86, v87
    v_exp_f32 v90, v90
    v_exp_f32 v91, v91
    v_mfma_f32_32x32x16_bf16 v[112:127], v[40:43], v[56:59], v[112:127]
    v_exp_f32 v92, v92
    v_exp_f32 v93, v93
    v_exp_f32 v94, v94
    v_exp_f32 v95, v95
    v_cvt_pk_bf16_f32 v60, v88, v89
    v_cvt_pk_bf16_f32 v61, v90, v91
    v_cvt_pk_bf16_f32 v62, v92, v93
    v_cvt_pk_bf16_f32 v63, v94, v95
    s_cmp_eq_u32 s39, 7
    s_cbranch_scc1 L_k2at_nl_32
    s_cmp_eq_u32 s39, 6
    s_cbranch_scc1 L_k2at_w0_30
    s_waitcnt vmcnt(4)
    s_branch L_k2at_w1_31
L_k2at_w0_30:
    s_waitcnt vmcnt(0)
L_k2at_w1_31:
    s_barrier
    s_cmp_lg_u32 s39, 2
    s_cbranch_scc1 L_k2pf_33
    s_load_dwordx2 s[56:57], s[0:1], 16
    s_load_dwordx2 s[60:61], s[0:1], 56
    s_lshl_b32 s64, s3, 2
    s_add_u32 s64, s64, s36
    s_waitcnt lgkmcnt(0)
    s_and_b32 s57, s57, 0xffff
    s_mov_b32 s58, 663552
    s_mov_b32 s59, 0x20000
    s_and_b32 s61, s61, 0xffff
    s_mov_b32 s62, 2654208
    s_mov_b32 s63, 0x20000
    s_add_u32 s65, s64, 0
    s_min_u32 s65, s65, 2591
    s_lshl_b32 s65, s65, 10
    buffer_load_dwordx4 v[244:247], v3, s[60:63], s65 offen
    s_add_u32 s65, s64, 1024
    s_min_u32 s65, s65, 2591
    s_lshl_b32 s65, s65, 10
    buffer_load_dwordx4 v[244:247], v3, s[60:63], s65 offen
    s_add_u32 s65, s64, 2048
    s_min_u32 s65, s65, 2591
    s_lshl_b32 s65, s65, 10
    buffer_load_dwordx4 v[244:247], v3, s[60:63], s65 offen
    s_add_u32 s65, s64, 0
    s_min_u32 s65, s65, 647
    s_lshl_b32 s65, s65, 10
    buffer_load_dwordx4 v[244:247], v3, s[56:59], s65 offen
L_k2pf_33:
    s_cmp_ge_u32 s39, 5
    s_cbranch_scc1 L_k2at_ni_34
    s_add_u32 m0, s40, 0
    s_add_u32 s45, s41, 0
    buffer_load_dwordx4 v3, s[24:27], s45 offen lds
    s_add_u32 m0, s40, 4096
    s_add_u32 s45, s41, 4096
    buffer_load_dwordx4 v3, s[24:27], s45 offen lds
    s_add_u32 m0, s40, 8192
    s_add_u32 s45, s41, 8192
    buffer_load_dwordx4 v3, s[24:27], s45 offen lds
    s_add_u32 m0, s40, 12288
    s_add_u32 s45, s41, 12288
    buffer_load_dwordx4 v3, s[24:27], s45 offen lds
    s_cmp_eq_u32 s36, 3
    s_cbranch_scc1 L_k2at_sk_35
    s_add_u32 m0, s40, 16384
    s_add_u32 s45, s41, 16384
    buffer_load_dwordx4 v3, s[24:27], s45 offen lds
L_k2at_sk_35:
    s_add_u32 s41, s41, 19456
    s_add_u32 s40, s40, 19456
    s_lshl_b32 s45, s36, 10
    s_add_u32 s45, s45, 77824
    s_cmp_ge_u32 s40, s45
    s_cselect_b32 s46, 77824, 0
    s_sub_u32 s40, s40, s46
L_k2at_ni_34:
    s_add_u32 s47, s47, 19456
    s_cmp_ge_u32 s47, 77824
    s_mov_b32 s45, 19456
    s_cselect_b32 s45, 4294908928, s45
    s_cselect_b32 s47, 0, s47
L_k2at_nl_32:
    v_mfma_f32_32x32x16_bf16 v[80:95], v[32:35], v[16:19], v[144:159]
    v_exp_f32 v64, v64
    v_exp_f32 v65, v65
    v_exp_f32 v66, v66
    v_mfma_f32_32x32x16_bf16 v[112:127], v[44:47], v[60:63], v[112:127]
    s_cmp_eq_u32 s39, 7
    s_cselect_b32 s45, 0, s45
    v_add_u32 v4, s45, v4
    v_add_u32 v5, s45, v5
    v_add_u32 v6, s45, v6
    s_mov_b64 exec, s[78:79]
    ds_read_b32 v28, v5 offset:0
    s_mov_b64 exec, s[54:55]
    ds_read_b128 v[40:43], v6 offset:0
    ds_read_b128 v[44:47], v6 offset:608
    s_mov_b64 exec, -1
    ds_read_b128 v[24:27], v4 offset:0
    v_exp_f32 v67, v67
    v_exp_f32 v68, v68
    v_exp_f32 v69, v69
    v_mfma_f32_32x32x16_bf16 v[80:95], v[36:39], v[20:23], v[80:95]
    v_exp_f32 v70, v70
    v_exp_f32 v71, v71
    v_exp_f32 v72, v72
    v_cvt_pk_bf16_f32 v56, v64, v65
    v_cvt_pk_bf16_f32 v57, v66, v67
    v_exp_f32 v73, v73
    v_cvt_pk_bf16_f32 v58, v68, v69
    v_cvt_pk_bf16_f32 v59, v70, v71
    v_exp_f32 v74, v74
    v_exp_f32 v75, v75
    v_mfma_f32_32x32x16_bf16 v[96:111], v[48:51], v[56:59], v[96:111]
    v_exp_f32 v76, v76
    v_exp_f32 v77, v77
    v_exp_f32 v78, v78
    v_exp_f32 v79, v79
    v_cvt_pk_bf16_f32 v60, v72, v73
    v_cvt_pk_bf16_f32 v61, v74, v75
    v_cvt_pk_bf16_f32 v62, v76, v77
    v_cvt_pk_bf16_f32 v63, v78, v79
    s_waitcnt lgkmcnt(0)
    v_mfma_f32_32x32x16_bf16 v[64:79], v[24:27], v[8:11], v[128:143]
    v_exp_f32 v80, v80
    v_exp_f32 v81, v81
    v_exp_f32 v82, v82
    v_mfma_f32_32x32x16_bf16 v[96:111], v[52:55], v[60:63], v[96:111]
    v_exp_f32 v83, v83
    v_exp_f32 v84, v84
    v_exp_f32 v85, v85
    v_mfma_f32_32x32x16_bf16 v[64:79], v[28:31], v[12:15], v[64:79]
    v_exp_f32 v86, v86
    v_exp_f32 v87, v87
    v_exp_f32 v88, v88
    v_cvt_pk_bf16_f32 v56, v80, v81
    v_cvt_pk_bf16_f32 v57, v82, v83
    v_exp_f32 v89, v89
    v_cvt_pk_bf16_f32 v58, v84, v85
    v_cvt_pk_bf16_f32 v59, v86, v87
    v_exp_f32 v90, v90
    v_exp_f32 v91, v91
    v_mfma_f32_32x32x16_bf16 v[112:127], v[48:51], v[56:59], v[112:127]
    v_exp_f32 v92, v92
    v_exp_f32 v93, v93
    v_exp_f32 v94, v94
    v_exp_f32 v95, v95
    v_cvt_pk_bf16_f32 v60, v88, v89
    v_cvt_pk_bf16_f32 v61, v90, v91
    v_cvt_pk_bf16_f32 v62, v92, v93
    v_cvt_pk_bf16_f32 v63, v94, v95
    s_waitcnt lgkmcnt(0)
    s_add_u32 s39, s39, 1
    s_cmp_lt_u32 s39, 8
    s_cbranch_scc1 L_k2at_loop
    v_mfma_f32_32x32x16_bf16 v[112:127], v[52:55], v[60:63], v[112:127]
L_k2at_epi:
    v_mov_b32 v62, v106
    v_mov_b32 v63, v106
    s_nop 1
    v_permlane32_swap_b32 v62, v63
    v_mov_b32 v165, v62
    s_nop 5
    v_mov_b32 v62, v122
    v_mov_b32 v63, v122
    s_nop 1
    v_permlane32_swap_b32 v62, v63
    v_mov_b32 v166, v62
    s_mov_b32 s45, 0x53800000
    v_mov_b32 v60, s45
    v_cmp_nle_f32 s[50:51], v165, v60
    v_cmp_nle_f32 s[52:53], v166, v60
    s_nop 1
    s_or_b64 s[50:51], s[50:51], s[52:53]
    v_mov_b32 v60, 0
    v_mov_b32 v61, 0
    v_max_f32 v61, v61, abs(v96)
    v_max_f32 v61, v61, abs(v97)
    v_max_f32 v61, v61, abs(v98)
    v_max_f32 v61, v61, abs(v99)
    v_max_f32 v61, v61, abs(v100)
    v_max_f32 v61, v61, abs(v101)
    v_max_f32 v61, v61, abs(v102)
    v_max_f32 v61, v61, abs(v103)
    v_max_f32 v61, v61, abs(v112)
    v_max_f32 v61, v61, abs(v113)
    v_max_f32 v61, v61, abs(v114)
    v_max_f32 v61, v61, abs(v115)
    v_max_f32 v61, v61, abs(v116)
    v_max_f32 v61, v61, abs(v117)
    v_max_f32 v61, v61, abs(v118)
    v_max_f32 v61, v61, abs(v119)
    s_mov_b32 s45, 0x7f000000
    v_mov_b32 v60, s45
    v_cmp_nle_f32 s[52:53], v61, v60
    s_nop 1
    s_or_b64 s[50:51], s[50:51], s[52:53]
    s_cmp_lg_u64 s[50:51], 0
    s_cbranch_scc1 L_k2at_fallback
L_k2at_store:
    v_and_b32 v60, 31, v2
    v_lshrrev_b32 v61, 5, v2
    s_lshl_b32 s44, s38, 4
    s_lshl_b32 s45, s36, 2
    s_add_u32 s44, s44, s45
    s_mul_i32 s44, s44, 92160
    s_add_u32 s44, s44, 42991616
    v_lshrrev_b32 v62, 4, v60
    v_mul_u32_u24 v62, 92160, v62
    v_and_b32 v63, 15, v60
    v_lshl_add_u32 v62, v63, 4, v62
    s_and_b32 s45, s37, 1
    s_lshl_b32 s45, s45, 9
    s_lshr_b32 s46, s37, 1
    s_lshl_b32 s46, s46, 10
    s_add_u32 s45, s45, s46
    v_lshl_add_u32 v56, v61, 8, v62
    v_add_u32 v56, s45, v56
    s_lshl_b32 s46, s37, 13
    s_lshl_b32 s45, s38, 10
    s_add_u32 s46, s46, s45
    s_lshl_b32 s45, s36, 8
    s_add_u32 s46, s46, s45
    s_add_u32 s46, s46, 55050240
    v_lshlrev_b32 v57, 2, v60
    v_mov_b32 v58, 1073741824
    v_cmp_eq_u32 vcc, 0, v61
    s_nop 1
    v_cndmask_b32 v57, v58, v57, vcc
    v_rcp_f32 v60, v165
    s_nop 0
    v_mul_f32 v60, v60, v160
    v_mul_f32 v96, v60, v96
    v_mul_f32 v97, v60, v97
    v_mul_f32 v98, v60, v98
    v_mul_f32 v99, v60, v99
    v_mul_f32 v100, v60, v100
    v_mul_f32 v101, v60, v101
    v_mul_f32 v102, v60, v102
    v_mul_f32 v103, v60, v103
    v_mul_f32 v104, v60, v104
    v_mul_f32 v105, v60, v105
    v_cvt_pk_bf16_f32 v40, v96, v97
    v_cvt_pk_bf16_f32 v41, v98, v99
    v_cvt_pk_bf16_f32 v42, v100, v101
    v_cvt_pk_bf16_f32 v43, v102, v103
    v_cvt_pk_bf16_f32 v44, v104, v105
    s_add_u32 s45, s44, 0
    buffer_store_dwordx4 v[40:43], v56, s[24:27], s45 offen sc1
    buffer_store_dword v44, v57, s[24:27], s46 offen offset:0 sc1
    v_rcp_f32 v60, v166
    s_nop 0
    v_mul_f32 v60, v60, v161
    v_mul_f32 v112, v60, v112
    v_mul_f32 v113, v60, v113
    v_mul_f32 v114, v60, v114
    v_mul_f32 v115, v60, v115
    v_mul_f32 v116, v60, v116
    v_mul_f32 v117, v60, v117
    v_mul_f32 v118, v60, v118
    v_mul_f32 v119, v60, v119
    v_mul_f32 v120, v60, v120
    v_mul_f32 v121, v60, v121
    v_cvt_pk_bf16_f32 v48, v112, v113
    v_cvt_pk_bf16_f32 v49, v114, v115
    v_cvt_pk_bf16_f32 v50, v116, v117
    v_cvt_pk_bf16_f32 v51, v118, v119
    v_cvt_pk_bf16_f32 v52, v120, v121
    s_add_u32 s45, s44, 184320
    buffer_store_dwordx4 v[48:51], v56, s[24:27], s45 offen sc1
    buffer_store_dword v52, v57, s[24:27], s46 offen offset:128 sc1
    s_branch L_k2_Afin
L_k2at_fallback:
    s_mul_i32 s49, s37, 155648
    s_add_u32 s49, s49, 0
    v_mov_b32 v167, 0xff800000
    v_mov_b32 v168, 0xff800000
    s_mov_b32 s50, 0
L_k2at_fb1:
    s_add_u32 s51, s49, s50
    buffer_load_dwordx4 v[24:27], v162, s[24:27], s51 offen
    buffer_load_dword v28, v163, s[24:27], s51 offen
    s_waitcnt vmcnt(0)
    v_mfma_f32_32x32x16_bf16 v[64:79], v[24:27], v[8:11], 0
    v_mfma_f32_32x32x16_bf16 v[64:79], v[28:31], v[12:15], v[64:79]
    v_mfma_f32_32x32x16_bf16 v[80:95], v[24:27], v[16:19], 0
    v_mfma_f32_32x32x16_bf16 v[80:95], v[28:31], v[20:23], v[80:95]
    s_nop 9
    v_max3_f32 v60, v64, v65, v66
    v_max3_f32 v60, v60, v67, v68
    v_max3_f32 v60, v60, v69, v70
    v_max3_f32 v60, v60, v71, v72
    v_max3_f32 v60, v60, v73, v74
    v_max3_f32 v60, v60, v75, v76
    v_max3_f32 v60, v60, v77, v78
    v_max_f32 v60, v60, v79
    v_max_f32 v167, v167, v60
    v_max3_f32 v60, v80, v81, v82
    v_max3_f32 v60, v60, v83, v84
    v_max3_f32 v60, v60, v85, v86
    v_max3_f32 v60, v60, v87, v88
    v_max3_f32 v60, v60, v89, v90
    v_max3_f32 v60, v60, v91, v92
    v_max3_f32 v60, v60, v93, v94
    v_max_f32 v60, v60, v95
    v_max_f32 v168, v168, v60
    s_add_u32 s50, s50, 2432
    s_cmp_lt_u32 s50, 155648
    s_cbranch_scc1 L_k2at_fb1
    v_mov_b32 v62, v167
    v_mov_b32 v63, v167
    s_nop 1
    v_permlane32_swap_b32 v62, v63
    v_max_f32 v62, v62, v63
    v_sub_f32 v62, 0, v62
    v_mov_b32 v63, v62
    v_mov_b64 v[128:129], v[62:63]
    v_mov_b64 v[130:131], v[62:63]
    v_mov_b64 v[132:133], v[62:63]
    v_mov_b64 v[134:135], v[62:63]
    v_mov_b64 v[136:137], v[62:63]
    v_mov_b64 v[138:139], v[62:63]
    v_mov_b64 v[140:141], v[62:63]
    v_mov_b64 v[142:143], v[62:63]
    v_mov_b32 v62, v168
    v_mov_b32 v63, v168
    s_nop 1
    v_permlane32_swap_b32 v62, v63
    v_max_f32 v62, v62, v63
    v_sub_f32 v62, 0, v62
    v_mov_b32 v63, v62
    v_mov_b64 v[144:145], v[62:63]
    v_mov_b64 v[146:147], v[62:63]
    v_mov_b64 v[148:149], v[62:63]
    v_mov_b64 v[150:151], v[62:63]
    v_mov_b64 v[152:153], v[62:63]
    v_mov_b64 v[154:155], v[62:63]
    v_mov_b64 v[156:157], v[62:63]
    v_mov_b64 v[158:159], v[62:63]
    v_mov_b32 v96, 0
    v_mov_b32 v97, 0
    v_mov_b32 v98, 0
    v_mov_b32 v99, 0
    v_mov_b32 v100, 0
    v_mov_b32 v101, 0
    v_mov_b32 v102, 0
    v_mov_b32 v103, 0
    v_mov_b32 v104, 0
    v_mov_b32 v105, 0
    v_mov_b32 v106, 0
    v_mov_b32 v107, 0
    v_mov_b32 v108, 0
    v_mov_b32 v109, 0
    v_mov_b32 v110, 0
    v_mov_b32 v111, 0
    v_mov_b32 v112, 0
    v_mov_b32 v113, 0
    v_mov_b32 v114, 0
    v_mov_b32 v115, 0
    v_mov_b32 v116, 0
    v_mov_b32 v117, 0
    v_mov_b32 v118, 0
    v_mov_b32 v119, 0
    v_mov_b32 v120, 0
    v_mov_b32 v121, 0
    v_mov_b32 v122, 0
    v_mov_b32 v123, 0
    v_mov_b32 v124, 0
    v_mov_b32 v125, 0
    v_mov_b32 v126, 0
    v_mov_b32 v127, 0
    s_mov_b32 s50, 0
L_k2at_fb2:
    s_add_u32 s51, s49, s50
    buffer_load_dwordx4 v[24:27], v162, s[24:27], s51 offen
    buffer_load_dword v28, v163, s[24:27], s51 offen
    buffer_load_dwordx4 v[40:43], v164, s[24:27], s51 offen
    buffer_load_dwordx4 v[44:47], v164, s[24:27], s51 offen offset:608
    s_waitcnt vmcnt(0)
    v_mfma_f32_32x32x16_bf16 v[64:79], v[24:27], v[8:11], v[128:143]
    v_mfma_f32_32x32x16_bf16 v[64:79], v[28:31], v[12:15], v[64:79]
    v_mfma_f32_32x32x16_bf16 v[80:95], v[24:27], v[16:19], v[144:159]
    v_mfma_f32_32x32x16_bf16 v[80:95], v[28:31], v[20:23], v[80:95]
    s_nop 9
    v_exp_f32 v64, v64
    v_exp_f32 v65, v65
    v_exp_f32 v66, v66
    v_exp_f32 v67, v67
    v_exp_f32 v68, v68
    v_exp_f32 v69, v69
    v_exp_f32 v70, v70
    v_exp_f32 v71, v71
    v_exp_f32 v72, v72
    v_exp_f32 v73, v73
    v_exp_f32 v74, v74
    v_exp_f32 v75, v75
    v_exp_f32 v76, v76
    v_exp_f32 v77, v77
    v_exp_f32 v78, v78
    v_exp_f32 v79, v79
    v_cvt_pk_bf16_f32 v56, v64, v65
    v_cvt_pk_bf16_f32 v57, v66, v67
    v_cvt_pk_bf16_f32 v58, v68, v69
    v_cvt_pk_bf16_f32 v59, v70, v71
    v_cvt_pk_bf16_f32 v60, v72, v73
    v_cvt_pk_bf16_f32 v61, v74, v75
    v_cvt_pk_bf16_f32 v62, v76, v77
    v_cvt_pk_bf16_f32 v63, v78, v79
    v_mfma_f32_32x32x16_bf16 v[96:111], v[40:43], v[56:59], v[96:111]
    s_nop 0
    v_mfma_f32_32x32x16_bf16 v[96:111], v[44:47], v[60:63], v[96:111]
    v_exp_f32 v80, v80
    v_exp_f32 v81, v81
    v_exp_f32 v82, v82
    v_exp_f32 v83, v83
    v_exp_f32 v84, v84
    v_exp_f32 v85, v85
    v_exp_f32 v86, v86
    v_exp_f32 v87, v87
    v_exp_f32 v88, v88
    v_exp_f32 v89, v89
    v_exp_f32 v90, v90
    v_exp_f32 v91, v91
    v_exp_f32 v92, v92
    v_exp_f32 v93, v93
    v_exp_f32 v94, v94
    v_exp_f32 v95, v95
    v_cvt_pk_bf16_f32 v56, v80, v81
    v_cvt_pk_bf16_f32 v57, v82, v83
    v_cvt_pk_bf16_f32 v58, v84, v85
    v_cvt_pk_bf16_f32 v59, v86, v87
    v_cvt_pk_bf16_f32 v60, v88, v89
    v_cvt_pk_bf16_f32 v61, v90, v91
    v_cvt_pk_bf16_f32 v62, v92, v93
    v_cvt_pk_bf16_f32 v63, v94, v95
    v_mfma_f32_32x32x16_bf16 v[112:127], v[40:43], v[56:59], v[112:127]
    s_nop 0
    v_mfma_f32_32x32x16_bf16 v[112:127], v[44:47], v[60:63], v[112:127]
    s_add_u32 s50, s50, 2432
    s_cmp_lt_u32 s50, 155648
    s_cbranch_scc1 L_k2at_fb2
    v_mov_b32 v62, v106
    v_mov_b32 v63, v106
    s_nop 1
    v_permlane32_swap_b32 v62, v63
    v_mov_b32 v165, v62
    s_nop 2
    v_mov_b32 v62, v122
    v_mov_b32 v63, v122
    s_nop 1
    v_permlane32_swap_b32 v62, v63
    v_mov_b32 v166, v62
    s_branch L_k2at_store
L_k2_Afin:
    s_add_u32 s89, s38, 24
    s_waitcnt vmcnt(0)
    s_barrier
    s_cmp_lg_u32 s36, 0
    s_cbranch_scc1 L_k2o_arr_36
    s_lshl_b32 s90, s89, 8
    s_add_u32 s90, s90, 55312384
    v_mov_b32 v240, 1
    v_mov_b32 v241, 0
    v_mov_b32 v242, 1073741824
    v_cmp_eq_u32 vcc, 0, v2
    s_nop 1
    v_cndmask_b32 v241, v242, v241, vcc
    buffer_atomic_add v240, v241, s[24:27], s90 offen sc1
L_k2o_arr_36:
L_k2_end:
    s_endpgm
L_k2_codeend:
.section .rodata,"a"
.p2align 6
.amdhsa_kernel k2_kernel
.amdhsa_next_free_vgpr 256
.amdhsa_next_free_sgpr 96
.amdhsa_accum_offset 256
.amdhsa_group_segment_fixed_size 0
.amdhsa_kernarg_size 96
.amdhsa_user_sgpr_count 2
.amdhsa_user_sgpr_kernarg_segment_ptr 1
.amdhsa_system_sgpr_workgroup_id_x 1
.amdhsa_float_denorm_mode_32 3
.end_amdhsa_kernel
```
